```python
import torch

def _softmax(x, axis=-1):
    return torch.softmax(x, dim=axis)
def _gelu(x):
    return torch.nn.functional.gelu(x, approximate="tanh")
def _silu(x):
    return torch.nn.functional.silu(x)
def _sigmoid(x):
    return torch.sigmoid(x)
def _layernorm(x, axis=-1, eps=1e-5):
    m = x.mean(dim=axis, keepdim=True)
    v = x.var(dim=axis, keepdim=True, unbiased=False)
    return (x - m) / torch.sqrt(v + eps)
def _scatter_add(tgt, idx, src, axis=0):
    return tgt.clone().index_add_(axis, idx, src)
def _segment_sum(src, seg, n):
    out = torch.zeros((n,) + src.shape[1:], dtype=src.dtype)
    return out.index_add_(0, seg, src)
def _pad(x, pw):
    flat = tuple(v for pair in reversed(pw) for v in pair)
    return torch.nn.functional.pad(x, flat)

kernel_name = 'standalone__gqa_softmax__near_ridge'

def setup_inputs():

    _w = (lambda a: (lambda t: t.to(torch.bfloat16) if t.is_floating_point() else t)(torch.as_tensor(a)))
    B, Hq, Hkv, Sq, Sk, D = 16, 32, 8, 288, 512, 128
    return {
        "q": _w((lambda *s: torch.randn(*s, dtype=torch.bfloat16) * 0.8)(B, Hq, Sq, D)),
        "k": _w((lambda *s: torch.randn(*s, dtype=torch.bfloat16) * 0.8)(B, Hkv, Sk, D)),
        "v": _w((lambda *s: torch.randn(*s, dtype=torch.bfloat16) * 0.05)(B, Hkv, Sk, D)),
    }

def reference(q, k, v):
    B, Hq, Sq, D = q.shape
    Hkv = k.shape[1]
    rep = Hq // Hkv
    k = (lambda x, n, axis: torch.repeat_interleave(x, n, dim=axis))(k, rep, axis=1)
    v = (lambda x, n, axis: torch.repeat_interleave(x, n, dim=axis))(v, rep, axis=1)
    scale = D ** -0.5
    scores = torch.einsum("bhqd,bhkd->bhqk", q, k) * scale
    p = _softmax(scores, axis=-1)
    return torch.einsum("bhqk,bhkd->bhqd", p, v)
```

```asm
; @launch grid=(256,1,1) block=(256,1,1) lds=163840
.amdgcn_target "amdgcn-amd-amdhsa--gfx950"
.text
.globl standalone__gqa_softmax__near_ridge_kernel
.p2align 8
.type standalone__gqa_softmax__near_ridge_kernel,@function
standalone__gqa_softmax__near_ridge_kernel:
    s_cmp_ge_u32 s2, 256
    s_cbranch_scc1 END
    s_load_dwordx4 s[36:39], s[0:1], 0
    s_load_dwordx4 s[52:55], s[0:1], 16
    v_and_b32 v3, 63, v0
    v_lshrrev_b32 v4, 6, v0
    s_nop 0
    v_readfirstlane_b32 s21, v4
    s_getpc_b64 s[60:61]
PFL:
    s_lshr_b32 s62, s2, 3
    s_and_b32 s62, s62, 3
    s_lshl_b32 s62, s62, 2
    s_add_u32 s62, s62, s21
    s_mul_i32 s62, s62, 4096
    s_min_u32 s62, s62, END-PFL-4096
    s_add_u32 s60, s60, s62
    s_addc_u32 s61, s61, 0
    v_lshlrev_b32 v60, 4, v3
    global_load_dwordx4 v[128:131], v60, s[60:61] offset:0
    global_load_dwordx4 v[128:131], v60, s[60:61] offset:1024
    global_load_dwordx4 v[128:131], v60, s[60:61] offset:2048
    global_load_dwordx4 v[128:131], v60, s[60:61] offset:3072
    s_lshr_b32 s3, s2, 4
    s_lshl_b32 s3, s3, 3
    s_and_b32 s34, s2, 7
    s_add_u32 s3, s3, s34
    s_lshr_b32 s34, s2, 3
    s_and_b32 s34, s34, 1
    s_mul_i32 s35, s3, 294912
    s_mul_i32 s34, s34, 147456
    s_add_u32 s35, s35, s34
    s_lshl_b32 s3, s3, 17
    s_lshl_b32 s22, s21, 12
    s_lshl_b32 s24, s21, 13
    s_lshl_b32 s25, s21, 14
    s_add_u32 s26, s25, 8192
    s_add_u32 s27, s25, 65536
    s_add_u32 s28, s27, 8192
    s_lshr_b32 s29, s21, 1
    s_lshl_b32 s29, s29, 13
    s_add_u32 s29, s29, 131072
    s_and_b32 s31, s21, 1
    s_add_u32 s68, s25, 4096
    s_add_u32 s69, s26, 4096
    s_add_u32 s70, s27, 4096
    s_add_u32 s71, s28, 4096
    s_add_u32 s59, s29, 4096
    s_mov_b32 s20, 0x3e0293ee
    s_mov_b32 s32, 0xbe0293ee
    s_mov_b32 s30, 0x4e800000
    v_and_b32 v5, 31, v3
    v_lshrrev_b32 v6, 5, v3
    v_and_b32 v7, 15, v3
    v_lshrrev_b32 v8, 4, v3
    v_lshlrev_b32 v1, 8, v5
    v_lshl_add_u32 v1, v6, 4, v1
    v_xor_b32 v9, v7, v8
    v_lshlrev_b32 v9, 4, v9
    v_lshl_add_u32 v14, v8, 8, v9
    v_xor_b32 v15, 64, v14
    v_xor_b32 v16, 0x80, v14
    v_xor_b32 v17, 0xc0, v14
    v_lshlrev_b32 v9, 2, v8
    v_xor_b32 v9, v7, v9
    v_lshlrev_b32 v9, 4, v9
    v_lshl_add_u32 v18, v8, 8, v9
    s_waitcnt lgkmcnt(0)
    s_add_u32 s4, s36, s35
    s_addc_u32 s5, s37, 0
    s_mov_b32 s6, 147456
    s_mov_b32 s7, 0x00020000
    s_add_u32 s8, s38, s3
    s_addc_u32 s9, s39, 0
    s_mov_b32 s10, 131072
    s_mov_b32 s11, 0x00020000
    s_add_u32 s12, s52, s3
    s_addc_u32 s13, s53, 0
    s_mov_b32 s14, 131072
    s_mov_b32 s15, 0x00020000
    s_add_u32 s16, s54, s35
    s_addc_u32 s17, s55, 0
    s_mov_b32 s18, 147456
    s_mov_b32 s19, 0x00020000
    s_mov_b32 s38, s20
    s_mov_b32 s39, s20
    s_add_u32 m0, s22, 0
    s_add_u32 s23, s22, 0
    buffer_load_dwordx4 v14, s[8:11], s23 offen offset:0 lds
    buffer_load_dwordx4 v15, s[8:11], s23 offen offset:1024 lds
    buffer_load_dwordx4 v16, s[8:11], s23 offen offset:2048 lds
    buffer_load_dwordx4 v17, s[8:11], s23 offen offset:3072 lds
    s_add_u32 m0, s24, 131072
    s_nop 0
    buffer_load_dwordx4 v14, s[4:7], s25 offen offset:0 lds
    buffer_load_dwordx4 v15, s[4:7], s25 offen offset:1024 lds
    buffer_load_dwordx4 v16, s[4:7], s25 offen offset:2048 lds
    buffer_load_dwordx4 v17, s[4:7], s25 offen offset:3072 lds
    s_add_u32 m0, s24, 135168
    s_nop 0
    buffer_load_dwordx4 v14, s[4:7], s68 offen offset:0 lds
    buffer_load_dwordx4 v15, s[4:7], s68 offen offset:1024 lds
    buffer_load_dwordx4 v16, s[4:7], s68 offen offset:2048 lds
    buffer_load_dwordx4 v17, s[4:7], s68 offen offset:3072 lds
    s_add_u32 m0, s24, 98304
    s_nop 0
    buffer_load_dwordx4 v14, s[4:7], s26 offen offset:0 lds
    buffer_load_dwordx4 v15, s[4:7], s26 offen offset:1024 lds
    buffer_load_dwordx4 v16, s[4:7], s26 offen offset:2048 lds
    buffer_load_dwordx4 v17, s[4:7], s26 offen offset:3072 lds
    s_add_u32 m0, s24, 102400
    s_nop 0
    buffer_load_dwordx4 v14, s[4:7], s69 offen offset:0 lds
    buffer_load_dwordx4 v15, s[4:7], s69 offen offset:1024 lds
    buffer_load_dwordx4 v16, s[4:7], s69 offen offset:2048 lds
    buffer_load_dwordx4 v17, s[4:7], s69 offen offset:3072 lds
    v_xor_b32 v28, v6, v7
    v_lshlrev_b32 v28, 4, v28
    v_lshl_add_u32 v28, v5, 8, v28
    v_lshrrev_b32 v29, 2, v7
    v_and_b32 v30, 3, v7
    v_lshl_add_u32 v31, v6, 2, v29
    v_lshlrev_b32 v31, 8, v31
    v_and_b32 v46, 1, v8
    v_lshlrev_b32 v46, 5, v46
    v_add_u32 v31, v31, v46
    v_lshrrev_b32 v46, 1, v30
    v_lshl_add_u32 v31, v46, 4, v31
    v_and_b32 v46, 1, v30
    v_lshl_add_u32 v31, v46, 3, v31
    v_add_u32 v31, 0x10000, v31
    v_lshlrev_b32 v29, 6, v29
    s_lshl_b32 s34, s21, 13
    s_add_u32 s34, s34, 131072
    v_add_u32 v19, s34, v28
    v_lshlrev_b32 v46, 4, v3
    v_add_u32 v0, s34, v46
    s_add_u32 s68, s25, 4096
    s_add_u32 s69, s26, 4096
    s_add_u32 s70, s27, 4096
    s_add_u32 s71, s28, 4096
    s_lshl_b32 s34, s31, 13
    v_xor_b32 v46, 0, v29
    v_add_u32 v47, v31, v46
    v_add_u32 v40, s34, v47
    v_mov_b32 v48, v47
    v_xor_b32 v46, 64, v29
    v_add_u32 v47, v31, v46
    v_add_u32 v41, s34, v47
    v_mov_b32 v49, v47
    v_xor_b32 v46, 128, v29
    v_add_u32 v47, v31, v46
    v_add_u32 v42, s34, v47
    v_mov_b32 v50, v47
    v_xor_b32 v46, 192, v29
    v_add_u32 v47, v31, v46
    v_add_u32 v43, s34, v47
    v_mov_b32 v51, v47
    v_xor_b32 v52, 0, v28
    v_add_u32 v32, s34, v52
    v_xor_b32 v53, 32, v28
    v_add_u32 v33, s34, v53
    v_xor_b32 v54, 64, v28
    v_add_u32 v34, s34, v54
    v_xor_b32 v55, 96, v28
    v_add_u32 v35, s34, v55
    v_xor_b32 v56, 128, v28
    v_add_u32 v36, s34, v56
    v_xor_b32 v57, 160, v28
    v_add_u32 v37, s34, v57
    v_xor_b32 v58, 192, v28
    v_add_u32 v38, s34, v58
    v_xor_b32 v59, 224, v28
    v_add_u32 v39, s34, v59
    v_mov_b32 v2, v52
    v_mov_b32 v3, v53
    v_mov_b32 v4, v54
    v_mov_b32 v5, v55
    v_mov_b32 v6, v56
    v_mov_b32 v7, v57
    v_mov_b32 v8, v58
    v_mov_b32 v9, v59
    v_mov_b32 v10, v48
    v_mov_b32 v11, v49
    v_mov_b32 v12, v50
    v_mov_b32 v13, v51
    s_sub_u32 s34, 32768, 0
    v_subrev_u32 v46, s34, v19
    v_xor_b32 v48, 0, v46
    v_xor_b32 v49, 32, v46
    v_xor_b32 v50, 64, v46
    v_xor_b32 v51, 96, v46
    v_xor_b32 v52, 128, v46
    v_xor_b32 v53, 160, v46
    v_xor_b32 v54, 192, v46
    v_xor_b32 v55, 224, v46
    s_waitcnt vmcnt(16)
    s_barrier
    s_waitcnt vmcnt(8)
    s_add_u32 m0, s22, 65536
    s_add_u32 s33, s22, 0
    buffer_load_dwordx4 v18, s[12:15], s33 offen offset:0 lds
    buffer_load_dwordx4 v18, s[12:15], s33 offen offset:1024 lds
    buffer_load_dwordx4 v18, s[12:15], s33 offen offset:2048 lds
    buffer_load_dwordx4 v18, s[12:15], s33 offen offset:3072 lds
    ds_read_b128 a[0:3], v48 offset:32768
    ds_read_b128 a[4:7], v49 offset:32768
    ds_read_b128 a[8:11], v50 offset:32768
    ds_read_b128 a[12:15], v51 offset:32768
    ds_read_b128 a[16:19], v52 offset:32768
    ds_read_b128 a[20:23], v53 offset:32768
    ds_read_b128 a[24:27], v54 offset:32768
    ds_read_b128 a[28:31], v55 offset:32768
    s_waitcnt vmcnt(4)
    s_add_u32 m0, s22, 16384
    s_add_u32 s23, s22, 16384
    buffer_load_dwordx4 v14, s[8:11], s23 offen offset:0 lds
    buffer_load_dwordx4 v15, s[8:11], s23 offen offset:1024 lds
    buffer_load_dwordx4 v16, s[8:11], s23 offen offset:2048 lds
    buffer_load_dwordx4 v17, s[8:11], s23 offen offset:3072 lds
    ds_read_b128 a[32:35], v48 offset:0
    ds_read_b128 a[36:39], v49 offset:0
    ds_read_b128 a[40:43], v50 offset:0
    ds_read_b128 a[44:47], v51 offset:0
    ds_read_b128 a[48:51], v52 offset:0
    ds_read_b128 a[52:55], v53 offset:0
    ds_read_b128 a[56:59], v54 offset:0
    ds_read_b128 a[60:63], v55 offset:0
    ds_read_b128 a[64:67], v2 offset:0
    ds_read_b128 a[68:71], v3 offset:0
    ds_read_b128 a[72:75], v4 offset:0
    ds_read_b128 a[76:79], v5 offset:0
    s_waitcnt lgkmcnt(3)
    v_mfma_f32_32x32x16_bf16 v[64:79], a[64:67], a[0:3], 0
    v_mfma_f32_32x32x16_bf16 v[80:95], a[64:67], a[32:35], 0
    s_waitcnt lgkmcnt(0)
    ds_read_b128 a[80:83], v6 offset:0
    v_mfma_f32_32x32x16_bf16 v[64:79], a[68:71], a[4:7], v[64:79]
    v_mfma_f32_32x32x16_bf16 v[80:95], a[68:71], a[36:39], v[80:95]
    ds_read_b128 a[84:87], v7 offset:0
    v_mfma_f32_32x32x16_bf16 v[64:79], a[72:75], a[8:11], v[64:79]
    s_add_u32 m0, s22, 81920
    s_add_u32 s33, s22, 16384
    v_mfma_f32_32x32x16_bf16 v[80:95], a[72:75], a[40:43], v[80:95]
    buffer_load_dwordx4 v18, s[12:15], s33 offen offset:0 lds
    ds_read_b128 a[88:91], v8 offset:0
    v_mfma_f32_32x32x16_bf16 v[64:79], a[76:79], a[12:15], v[64:79]
    buffer_load_dwordx4 v18, s[12:15], s33 offen offset:1024 lds
    v_mfma_f32_32x32x16_bf16 v[80:95], a[76:79], a[44:47], v[80:95]
    s_waitcnt lgkmcnt(1)
    buffer_load_dwordx4 v18, s[12:15], s33 offen offset:2048 lds
    ds_read_b128 a[92:95], v9 offset:0
    v_mfma_f32_32x32x16_bf16 v[64:79], a[80:83], a[16:19], v[64:79]
    buffer_load_dwordx4 v18, s[12:15], s33 offen offset:3072 lds
    v_mfma_f32_32x32x16_bf16 v[80:95], a[80:83], a[48:51], v[80:95]
    s_add_u32 m0, s22, 32768
    s_add_u32 s23, s22, 32768
    ds_read_b128 a[64:67], v2 offset:8192
    v_mfma_f32_32x32x16_bf16 v[64:79], a[84:87], a[20:23], v[64:79]
    buffer_load_dwordx4 v14, s[8:11], s23 offen offset:0 lds
    v_mfma_f32_32x32x16_bf16 v[80:95], a[84:87], a[52:55], v[80:95]
    s_waitcnt lgkmcnt(1)
    buffer_load_dwordx4 v15, s[8:11], s23 offen offset:1024 lds
    ds_read_b128 a[68:71], v3 offset:8192
    v_mfma_f32_32x32x16_bf16 v[64:79], a[88:91], a[24:27], v[64:79]
    buffer_load_dwordx4 v16, s[8:11], s23 offen offset:2048 lds
    v_mfma_f32_32x32x16_bf16 v[80:95], a[88:91], a[56:59], v[80:95]
    buffer_load_dwordx4 v17, s[8:11], s23 offen offset:3072 lds
    ds_read_b128 a[72:75], v4 offset:8192
    v_mfma_f32_32x32x16_bf16 v[64:79], a[92:95], a[28:31], v[64:79]
    v_mfma_f32_32x32x16_bf16 v[80:95], a[92:95], a[60:63], v[80:95]
    s_waitcnt lgkmcnt(1)
    ds_read_b128 a[76:79], v5 offset:8192
    v_mfma_f32_32x32x16_bf16 v[96:111], a[64:67], a[0:3], 0
    v_mfma_f32_32x32x16_bf16 v[112:127], a[64:67], a[32:35], 0
    s_waitcnt vmcnt(8)
    ds_read_b128 a[80:83], v6 offset:8192
    v_max3_f32 v28, v64, v65, v66
    v_max3_f32 v28, v28, v67, v68
    v_max3_f32 v28, v28, v69, v70
    v_max3_f32 v28, v28, v71, v72
    v_max3_f32 v28, v28, v73, v74
    v_mfma_f32_32x32x16_bf16 v[96:111], a[68:71], a[4:7], v[96:111]
    s_barrier
    v_max3_f32 v28, v28, v75, v76
    v_max3_f32 v28, v28, v77, v78
    v_max_f32 v28, v28, v79
    v_mov_b32 v29, v28
    s_nop 1
    v_permlane32_swap_b32 v28, v29
    v_mfma_f32_32x32x16_bf16 v[112:127], a[68:71], a[36:39], v[112:127]
    s_waitcnt lgkmcnt(1)
    ds_read_b128 a[84:87], v7 offset:8192
    v_max_f32 v28, v28, v29
    v_mul_f32 v22, s32, v28
    v_max3_f32 v30, v80, v81, v82
    v_max3_f32 v30, v30, v83, v84
    v_max3_f32 v30, v30, v85, v86
    v_mfma_f32_32x32x16_bf16 v[96:111], a[72:75], a[8:11], v[96:111]
    s_add_u32 m0, s22, 49152
    s_add_u32 s23, s22, 49152
    v_max3_f32 v30, v30, v87, v88
    v_max3_f32 v30, v30, v89, v90
    v_max3_f32 v30, v30, v91, v92
    v_max3_f32 v30, v30, v93, v94
    v_max_f32 v30, v30, v95
    v_mfma_f32_32x32x16_bf16 v[112:127], a[72:75], a[40:43], v[112:127]
    ds_read_b128 a[88:91], v8 offset:8192
    v_mov_b32 v31, v30
    s_nop 1
    v_permlane32_swap_b32 v30, v31
    v_max_f32 v30, v30, v31
    v_mul_f32 v23, s32, v30
    v_mfma_f32_32x32x16_bf16 v[96:111], a[76:79], a[12:15], v[96:111]
    buffer_load_dwordx4 v14, s[8:11], s23 offen offset:0 lds
    v_mfma_f32_32x32x16_bf16 v[112:127], a[76:79], a[44:47], v[112:127]
    s_waitcnt lgkmcnt(1)
    ds_read_b128 a[92:95], v9 offset:8192
    v_fma_f32 v64, v64, s20, v22
    v_exp_f32 v64, v64
    v_fma_f32 v65, v65, s20, v22
    v_mfma_f32_32x32x16_bf16 v[96:111], a[80:83], a[16:19], v[96:111]
    buffer_load_dwordx4 v15, s[8:11], s23 offen offset:1024 lds
    v_exp_f32 v65, v65
    v_fma_f32 v66, v66, s20, v22
    v_mov_b32 v20, v64
    v_mfma_f32_32x32x16_bf16 v[112:127], a[80:83], a[48:51], v[112:127]
    ds_read_b64_tr_b16 a[64:65], v10 offset:0
    ds_read_b64_tr_b16 a[66:67], v10 offset:2048
    v_exp_f32 v66, v66
    v_fma_f32 v67, v67, s20, v22
    v_add_f32 v20, v20, v65
    v_cvt_pk_bf16_f32 v64, v64, v65
    v_mfma_f32_32x32x16_bf16 v[96:111], a[84:87], a[20:23], v[96:111]
    buffer_load_dwordx4 v16, s[8:11], s23 offen offset:2048 lds
    v_exp_f32 v67, v67
    v_fma_f32 v68, v68, s20, v22
    v_add_f32 v20, v20, v66
    v_mfma_f32_32x32x16_bf16 v[112:127], a[84:87], a[52:55], v[112:127]
    s_waitcnt lgkmcnt(2)
    ds_read_b64_tr_b16 a[68:69], v11 offset:0
    ds_read_b64_tr_b16 a[70:71], v11 offset:2048
    v_exp_f32 v68, v68
    v_fma_f32 v69, v69, s20, v22
    v_add_f32 v20, v20, v67
    v_cvt_pk_bf16_f32 v65, v66, v67
    v_mfma_f32_32x32x16_bf16 v[96:111], a[88:91], a[24:27], v[96:111]
    buffer_load_dwordx4 v17, s[8:11], s23 offen offset:3072 lds
    v_exp_f32 v69, v69
    v_fma_f32 v70, v70, s20, v22
    v_add_f32 v20, v20, v68
    v_mfma_f32_32x32x16_bf16 v[112:127], a[88:91], a[56:59], v[112:127]
    ds_read_b64_tr_b16 a[72:73], v12 offset:0
    ds_read_b64_tr_b16 a[74:75], v12 offset:2048
    v_exp_f32 v70, v70
    v_fma_f32 v71, v71, s20, v22
    v_add_f32 v20, v20, v69
    v_cvt_pk_bf16_f32 v66, v68, v69
    v_exp_f32 v71, v71
    v_fma_f32 v80, v80, s20, v23
    v_add_f32 v20, v20, v70
    v_mfma_f32_32x32x16_bf16 v[96:111], a[92:95], a[28:31], v[96:111]
    v_exp_f32 v80, v80
    v_fma_f32 v81, v81, s20, v23
    v_add_f32 v20, v20, v71
    v_cvt_pk_bf16_f32 v67, v70, v71
    v_exp_f32 v81, v81
    v_fma_f32 v82, v82, s20, v23
    v_mov_b32 v21, v80
    v_exp_f32 v82, v82
    v_fma_f32 v83, v83, s20, v23
    v_add_f32 v21, v21, v81
    v_cvt_pk_bf16_f32 v80, v80, v81
    v_exp_f32 v83, v83
    v_fma_f32 v84, v84, s20, v23
    v_add_f32 v21, v21, v82
    v_exp_f32 v84, v84
    v_fma_f32 v85, v85, s20, v23
    v_add_f32 v21, v21, v83
    v_cvt_pk_bf16_f32 v81, v82, v83
    v_exp_f32 v85, v85
    v_fma_f32 v86, v86, s20, v23
    v_add_f32 v21, v21, v84
    v_exp_f32 v86, v86
    v_fma_f32 v87, v87, s20, v23
    v_add_f32 v21, v21, v85
    v_cvt_pk_bf16_f32 v82, v84, v85
    v_exp_f32 v87, v87
    v_fma_f32 v72, v72, s20, v22
    v_add_f32 v21, v21, v86
    v_mfma_f32_32x32x16_bf16 v[112:127], a[92:95], a[60:63], v[112:127]
    s_waitcnt lgkmcnt(2)
    ds_read_b64_tr_b16 a[76:77], v13 offset:0
    ds_read_b64_tr_b16 a[78:79], v13 offset:2048
    v_exp_f32 v72, v72
    v_fma_f32 v73, v73, s20, v22
    v_add_f32 v21, v21, v87
    v_cvt_pk_bf16_f32 v83, v86, v87
    v_mfma_f32_32x32x16_bf16 a[128:143], a[64:67], v[64:67], 0
    s_add_u32 m0, s22, 98304
    s_add_u32 s33, s22, 32768
    v_exp_f32 v73, v73
    v_fma_f32 v74, v74, s20, v22
    v_add_f32 v20, v20, v72
    v_mfma_f32_32x32x16_bf16 a[192:207], a[64:67], v[80:83], 0
    ds_read_b64_tr_b16 a[80:81], v10 offset:4096
    ds_read_b64_tr_b16 a[82:83], v10 offset:6144
    v_exp_f32 v74, v74
    v_fma_f32 v75, v75, s20, v22
    v_add_f32 v20, v20, v73
    v_cvt_pk_bf16_f32 v72, v72, v73
    v_mfma_f32_32x32x16_bf16 a[144:159], a[68:71], v[64:67], 0
    buffer_load_dwordx4 v18, s[12:15], s33 offen offset:0 lds
    v_exp_f32 v75, v75
    v_fma_f32 v76, v76, s20, v22
    v_add_f32 v20, v20, v74
    v_mfma_f32_32x32x16_bf16 a[208:223], a[68:71], v[80:83], 0
    s_waitcnt lgkmcnt(2)
    ds_read_b64_tr_b16 a[84:85], v11 offset:4096
    ds_read_b64_tr_b16 a[86:87], v11 offset:6144
    v_exp_f32 v76, v76
    v_fma_f32 v77, v77, s20, v22
    v_add_f32 v20, v20, v75
    v_cvt_pk_bf16_f32 v73, v74, v75
    v_mfma_f32_32x32x16_bf16 a[160:175], a[72:75], v[64:67], 0
    buffer_load_dwordx4 v18, s[12:15], s33 offen offset:1024 lds
    v_exp_f32 v77, v77
    v_fma_f32 v78, v78, s20, v22
    v_add_f32 v20, v20, v76
    v_mfma_f32_32x32x16_bf16 a[224:239], a[72:75], v[80:83], 0
    ds_read_b64_tr_b16 a[88:89], v12 offset:4096
    ds_read_b64_tr_b16 a[90:91], v12 offset:6144
    v_exp_f32 v78, v78
    v_fma_f32 v79, v79, s20, v22
    v_add_f32 v20, v20, v77
    v_cvt_pk_bf16_f32 v74, v76, v77
    v_exp_f32 v79, v79
    v_fma_f32 v88, v88, s20, v23
    v_add_f32 v20, v20, v78
    v_mfma_f32_32x32x16_bf16 a[176:191], a[76:79], v[64:67], 0
    buffer_load_dwordx4 v18, s[12:15], s33 offen offset:2048 lds
    v_exp_f32 v88, v88
    v_fma_f32 v89, v89, s20, v23
    v_add_f32 v20, v20, v79
    v_cvt_pk_bf16_f32 v75, v78, v79
    v_exp_f32 v89, v89
    v_fma_f32 v90, v90, s20, v23
    v_add_f32 v21, v21, v88
    v_exp_f32 v90, v90
    v_fma_f32 v91, v91, s20, v23
    v_add_f32 v21, v21, v89
    v_cvt_pk_bf16_f32 v88, v88, v89
    v_exp_f32 v91, v91
    v_fma_f32 v92, v92, s20, v23
    v_add_f32 v21, v21, v90
    v_exp_f32 v92, v92
    v_fma_f32 v93, v93, s20, v23
    v_add_f32 v21, v21, v91
    v_cvt_pk_bf16_f32 v89, v90, v91
    v_exp_f32 v93, v93
    v_fma_f32 v94, v94, s20, v23
    v_add_f32 v21, v21, v92
    v_exp_f32 v94, v94
    v_fma_f32 v95, v95, s20, v23
    v_add_f32 v21, v21, v93
    v_cvt_pk_bf16_f32 v90, v92, v93
    v_exp_f32 v95, v95
    v_add_f32 v21, v21, v94
    v_add_f32 v21, v21, v95
    v_cvt_pk_bf16_f32 v91, v94, v95
    v_mfma_f32_32x32x16_bf16 a[240:255], a[76:79], v[80:83], 0
    s_waitcnt lgkmcnt(2)
    ds_read_b64_tr_b16 a[92:93], v13 offset:4096
    ds_read_b64_tr_b16 a[94:95], v13 offset:6144
    v_fma_f32 v96, v96, s20, v22
    v_exp_f32 v96, v96
    v_fma_f32 v97, v97, s20, v22
    v_mfma_f32_32x32x16_bf16 a[128:143], a[80:83], v[72:75], a[128:143]
    buffer_load_dwordx4 v18, s[12:15], s33 offen offset:3072 lds
    v_exp_f32 v97, v97
    v_fma_f32 v98, v98, s20, v22
    v_add_f32 v20, v20, v96
    v_mfma_f32_32x32x16_bf16 a[192:207], a[80:83], v[88:91], a[192:207]
    ds_read_b128 a[64:67], v2 offset:16384
    v_exp_f32 v98, v98
    v_fma_f32 v99, v99, s20, v22
    v_add_f32 v20, v20, v97
    v_cvt_pk_bf16_f32 v96, v96, v97
    v_mfma_f32_32x32x16_bf16 a[144:159], a[84:87], v[72:75], a[144:159]
    v_exp_f32 v99, v99
    v_fma_f32 v100, v100, s20, v22
    v_add_f32 v20, v20, v98
    v_mfma_f32_32x32x16_bf16 a[208:223], a[84:87], v[88:91], a[208:223]
    s_waitcnt lgkmcnt(1)
    ds_read_b128 a[68:71], v3 offset:16384
    v_exp_f32 v100, v100
    v_fma_f32 v101, v101, s20, v22
    v_add_f32 v20, v20, v99
    v_cvt_pk_bf16_f32 v97, v98, v99
    v_mfma_f32_32x32x16_bf16 a[160:175], a[88:91], v[72:75], a[160:175]
    v_exp_f32 v101, v101
    v_fma_f32 v102, v102, s20, v22
    v_add_f32 v20, v20, v100
    v_mfma_f32_32x32x16_bf16 a[224:239], a[88:91], v[88:91], a[224:239]
    ds_read_b128 a[72:75], v4 offset:16384
    v_exp_f32 v102, v102
    v_fma_f32 v103, v103, s20, v22
    v_add_f32 v20, v20, v101
    v_cvt_pk_bf16_f32 v98, v100, v101
    v_mfma_f32_32x32x16_bf16 a[176:191], a[92:95], v[72:75], a[176:191]
    v_exp_f32 v103, v103
    v_fma_f32 v112, v112, s20, v23
    v_add_f32 v20, v20, v102
    v_mfma_f32_32x32x16_bf16 a[240:255], a[92:95], v[88:91], a[240:255]
    s_waitcnt lgkmcnt(1)
    ds_read_b128 a[76:79], v5 offset:16384
    v_exp_f32 v112, v112
    v_fma_f32 v113, v113, s20, v23
    v_add_f32 v20, v20, v103
    v_cvt_pk_bf16_f32 v99, v102, v103
    v_mfma_f32_32x32x16_bf16 v[64:79], a[64:67], a[0:3], 0
    v_exp_f32 v113, v113
    v_fma_f32 v114, v114, s20, v23
    v_add_f32 v21, v21, v112
    v_mfma_f32_32x32x16_bf16 v[80:95], a[64:67], a[32:35], 0
    ds_read_b128 a[80:83], v6 offset:16384
    v_exp_f32 v114, v114
    v_fma_f32 v115, v115, s20, v23
    v_add_f32 v21, v21, v113
    v_cvt_pk_bf16_f32 v112, v112, v113
    v_mfma_f32_32x32x16_bf16 v[64:79], a[68:71], a[4:7], v[64:79]
    s_add_u32 m0, s22, 114688
    s_add_u32 s33, s22, 49152
    v_exp_f32 v115, v115
    v_fma_f32 v116, v116, s20, v23
    v_add_f32 v21, v21, v114
    v_mfma_f32_32x32x16_bf16 v[80:95], a[68:71], a[36:39], v[80:95]
    s_waitcnt lgkmcnt(1)
    ds_read_b128 a[84:87], v7 offset:16384
    v_exp_f32 v116, v116
    v_fma_f32 v117, v117, s20, v23
    v_add_f32 v21, v21, v115
    v_cvt_pk_bf16_f32 v113, v114, v115
    v_mfma_f32_32x32x16_bf16 v[64:79], a[72:75], a[8:11], v[64:79]
    buffer_load_dwordx4 v18, s[12:15], s33 offen offset:0 lds
    v_exp_f32 v117, v117
    v_fma_f32 v118, v118, s20, v23
    v_add_f32 v21, v21, v116
    v_mfma_f32_32x32x16_bf16 v[80:95], a[72:75], a[40:43], v[80:95]
    ds_read_b128 a[88:91], v8 offset:16384
    v_exp_f32 v118, v118
    v_fma_f32 v119, v119, s20, v23
    v_add_f32 v21, v21, v117
    v_cvt_pk_bf16_f32 v114, v116, v117
    v_mfma_f32_32x32x16_bf16 v[64:79], a[76:79], a[12:15], v[64:79]
    buffer_load_dwordx4 v18, s[12:15], s33 offen offset:1024 lds
    v_exp_f32 v119, v119
    v_fma_f32 v104, v104, s20, v22
    v_add_f32 v21, v21, v118
    v_mfma_f32_32x32x16_bf16 v[80:95], a[76:79], a[44:47], v[80:95]
    s_waitcnt lgkmcnt(1)
    ds_read_b128 a[92:95], v9 offset:16384
    v_exp_f32 v104, v104
    v_fma_f32 v105, v105, s20, v22
    v_add_f32 v21, v21, v119
    v_cvt_pk_bf16_f32 v115, v118, v119
    v_mfma_f32_32x32x16_bf16 v[64:79], a[80:83], a[16:19], v[64:79]
    buffer_load_dwordx4 v18, s[12:15], s33 offen offset:2048 lds
    v_exp_f32 v105, v105
    v_fma_f32 v106, v106, s20, v22
    v_add_f32 v20, v20, v104
    v_mfma_f32_32x32x16_bf16 v[80:95], a[80:83], a[48:51], v[80:95]
    ds_read_b64_tr_b16 a[64:65], v10 offset:8192
    ds_read_b64_tr_b16 a[66:67], v10 offset:10240
    v_exp_f32 v106, v106
    v_fma_f32 v107, v107, s20, v22
    v_add_f32 v20, v20, v105
    v_cvt_pk_bf16_f32 v104, v104, v105
    v_mfma_f32_32x32x16_bf16 v[64:79], a[84:87], a[20:23], v[64:79]
    buffer_load_dwordx4 v18, s[12:15], s33 offen offset:3072 lds
    v_exp_f32 v107, v107
    v_fma_f32 v108, v108, s20, v22
    v_add_f32 v20, v20, v106
    v_mfma_f32_32x32x16_bf16 v[80:95], a[84:87], a[52:55], v[80:95]
    s_waitcnt lgkmcnt(2)
    ds_read_b64_tr_b16 a[68:69], v11 offset:8192
    ds_read_b64_tr_b16 a[70:71], v11 offset:10240
    v_exp_f32 v108, v108
    v_fma_f32 v109, v109, s20, v22
    v_add_f32 v20, v20, v107
    v_cvt_pk_bf16_f32 v105, v106, v107
    v_mfma_f32_32x32x16_bf16 v[64:79], a[88:91], a[24:27], v[64:79]
    v_exp_f32 v109, v109
    v_fma_f32 v110, v110, s20, v22
    v_add_f32 v20, v20, v108
    v_mfma_f32_32x32x16_bf16 v[80:95], a[88:91], a[56:59], v[80:95]
    ds_read_b64_tr_b16 a[72:73], v12 offset:8192
    ds_read_b64_tr_b16 a[74:75], v12 offset:10240
    v_exp_f32 v110, v110
    v_fma_f32 v111, v111, s20, v22
    v_add_f32 v20, v20, v109
    v_cvt_pk_bf16_f32 v106, v108, v109
    v_mfma_f32_32x32x16_bf16 v[64:79], a[92:95], a[28:31], v[64:79]
    v_exp_f32 v111, v111
    v_fma_f32 v120, v120, s20, v23
    v_add_f32 v20, v20, v110
    v_mfma_f32_32x32x16_bf16 v[80:95], a[92:95], a[60:63], v[80:95]
    s_waitcnt lgkmcnt(2)
    ds_read_b64_tr_b16 a[76:77], v13 offset:8192
    ds_read_b64_tr_b16 a[78:79], v13 offset:10240
    v_exp_f32 v120, v120
    v_fma_f32 v121, v121, s20, v23
    v_add_f32 v20, v20, v111
    v_cvt_pk_bf16_f32 v107, v110, v111
    v_mfma_f32_32x32x16_bf16 a[128:143], a[64:67], v[96:99], a[128:143]
    v_exp_f32 v121, v121
    v_fma_f32 v122, v122, s20, v23
    v_add_f32 v21, v21, v120
    v_mfma_f32_32x32x16_bf16 a[192:207], a[64:67], v[112:115], a[192:207]
    ds_read_b64_tr_b16 a[80:81], v10 offset:12288
    ds_read_b64_tr_b16 a[82:83], v10 offset:14336
    v_exp_f32 v122, v122
    v_fma_f32 v123, v123, s20, v23
    v_add_f32 v21, v21, v121
    v_cvt_pk_bf16_f32 v120, v120, v121
    v_mfma_f32_32x32x16_bf16 a[144:159], a[68:71], v[96:99], a[144:159]
    v_exp_f32 v123, v123
    v_fma_f32 v124, v124, s20, v23
    v_add_f32 v21, v21, v122
    v_mfma_f32_32x32x16_bf16 a[208:223], a[68:71], v[112:115], a[208:223]
    s_waitcnt lgkmcnt(2)
    ds_read_b64_tr_b16 a[84:85], v11 offset:12288
    ds_read_b64_tr_b16 a[86:87], v11 offset:14336
    v_exp_f32 v124, v124
    v_fma_f32 v125, v125, s20, v23
    v_add_f32 v21, v21, v123
    v_cvt_pk_bf16_f32 v121, v122, v123
    v_mfma_f32_32x32x16_bf16 a[160:175], a[72:75], v[96:99], a[160:175]
    v_exp_f32 v125, v125
    v_fma_f32 v126, v126, s20, v23
    v_add_f32 v21, v21, v124
    v_mfma_f32_32x32x16_bf16 a[224:239], a[72:75], v[112:115], a[224:239]
    ds_read_b64_tr_b16 a[88:89], v12 offset:12288
    ds_read_b64_tr_b16 a[90:91], v12 offset:14336
    v_exp_f32 v126, v126
    v_fma_f32 v127, v127, s20, v23
    v_add_f32 v21, v21, v125
    v_cvt_pk_bf16_f32 v122, v124, v125
    v_mfma_f32_32x32x16_bf16 a[176:191], a[76:79], v[96:99], a[176:191]
    v_exp_f32 v127, v127
    v_add_f32 v21, v21, v126
    v_add_f32 v21, v21, v127
    v_cvt_pk_bf16_f32 v123, v126, v127
    v_mfma_f32_32x32x16_bf16 a[240:255], a[76:79], v[112:115], a[240:255]
    s_waitcnt lgkmcnt(2)
    ds_read_b64_tr_b16 a[92:93], v13 offset:12288
    ds_read_b64_tr_b16 a[94:95], v13 offset:14336
    v_fma_f32 v64, v64, s20, v22
    v_exp_f32 v64, v64
    v_fma_f32 v65, v65, s20, v22
    v_mfma_f32_32x32x16_bf16 a[128:143], a[80:83], v[104:107], a[128:143]
    v_exp_f32 v65, v65
    v_fma_f32 v66, v66, s20, v22
    v_add_f32 v20, v20, v64
    v_mfma_f32_32x32x16_bf16 a[192:207], a[80:83], v[120:123], a[192:207]
    ds_read_b128 a[64:67], v2 offset:24576
    v_exp_f32 v66, v66
    v_fma_f32 v67, v67, s20, v22
    v_add_f32 v20, v20, v65
    v_cvt_pk_bf16_f32 v64, v64, v65
    v_mfma_f32_32x32x16_bf16 a[144:159], a[84:87], v[104:107], a[144:159]
    v_exp_f32 v67, v67
    v_fma_f32 v68, v68, s20, v22
    v_add_f32 v20, v20, v66
    v_mfma_f32_32x32x16_bf16 a[208:223], a[84:87], v[120:123], a[208:223]
    s_waitcnt lgkmcnt(1)
    ds_read_b128 a[68:71], v3 offset:24576
    v_exp_f32 v68, v68
    v_fma_f32 v69, v69, s20, v22
    v_add_f32 v20, v20, v67
    v_cvt_pk_bf16_f32 v65, v66, v67
    v_mfma_f32_32x32x16_bf16 a[160:175], a[88:91], v[104:107], a[160:175]
    v_exp_f32 v69, v69
    v_fma_f32 v70, v70, s20, v22
    v_add_f32 v20, v20, v68
    v_mfma_f32_32x32x16_bf16 a[224:239], a[88:91], v[120:123], a[224:239]
    ds_read_b128 a[72:75], v4 offset:24576
    v_exp_f32 v70, v70
    v_fma_f32 v71, v71, s20, v22
    v_add_f32 v20, v20, v69
    v_cvt_pk_bf16_f32 v66, v68, v69
    v_mfma_f32_32x32x16_bf16 a[176:191], a[92:95], v[104:107], a[176:191]
    v_exp_f32 v71, v71
    v_fma_f32 v80, v80, s20, v23
    v_add_f32 v20, v20, v70
    v_mfma_f32_32x32x16_bf16 a[240:255], a[92:95], v[120:123], a[240:255]
    s_waitcnt lgkmcnt(1)
    ds_read_b128 a[76:79], v5 offset:24576
    v_exp_f32 v80, v80
    v_fma_f32 v81, v81, s20, v23
    v_add_f32 v20, v20, v71
    v_cvt_pk_bf16_f32 v67, v70, v71
    v_mfma_f32_32x32x16_bf16 v[96:111], a[64:67], a[0:3], 0
    v_exp_f32 v81, v81
    v_fma_f32 v82, v82, s20, v23
    v_add_f32 v21, v21, v80
    v_mfma_f32_32x32x16_bf16 v[112:127], a[64:67], a[32:35], 0
    s_waitcnt vmcnt(12)
    ds_read_b128 a[80:83], v6 offset:24576
    v_exp_f32 v82, v82
    v_fma_f32 v83, v83, s20, v23
    v_add_f32 v21, v21, v81
    v_cvt_pk_bf16_f32 v80, v80, v81
    v_mfma_f32_32x32x16_bf16 v[96:111], a[68:71], a[4:7], v[96:111]
    s_barrier
    v_exp_f32 v83, v83
    v_fma_f32 v84, v84, s20, v23
    v_add_f32 v21, v21, v82
    v_mfma_f32_32x32x16_bf16 v[112:127], a[68:71], a[36:39], v[112:127]
    s_waitcnt lgkmcnt(1)
    ds_read_b128 a[84:87], v7 offset:24576
    v_exp_f32 v84, v84
    v_fma_f32 v85, v85, s20, v23
    v_add_f32 v21, v21, v83
    v_cvt_pk_bf16_f32 v81, v82, v83
    v_mfma_f32_32x32x16_bf16 v[96:111], a[72:75], a[8:11], v[96:111]
    s_add_u32 m0, s22, 0
    s_add_u32 s23, s22, 65536
    v_exp_f32 v85, v85
    v_fma_f32 v86, v86, s20, v23
    v_add_f32 v21, v21, v84
    v_mfma_f32_32x32x16_bf16 v[112:127], a[72:75], a[40:43], v[112:127]
    ds_read_b128 a[88:91], v8 offset:24576
    v_exp_f32 v86, v86
    v_fma_f32 v87, v87, s20, v23
    v_add_f32 v21, v21, v85
    v_cvt_pk_bf16_f32 v82, v84, v85
    v_mfma_f32_32x32x16_bf16 v[96:111], a[76:79], a[12:15], v[96:111]
    buffer_load_dwordx4 v14, s[8:11], s23 offen offset:0 lds
    v_exp_f32 v87, v87
    v_fma_f32 v72, v72, s20, v22
    v_add_f32 v21, v21, v86
    v_mfma_f32_32x32x16_bf16 v[112:127], a[76:79], a[44:47], v[112:127]
    s_waitcnt lgkmcnt(1)
    ds_read_b128 a[92:95], v9 offset:24576
    v_exp_f32 v72, v72
    v_fma_f32 v73, v73, s20, v22
    v_add_f32 v21, v21, v87
    v_cvt_pk_bf16_f32 v83, v86, v87
    v_mfma_f32_32x32x16_bf16 v[96:111], a[80:83], a[16:19], v[96:111]
    buffer_load_dwordx4 v15, s[8:11], s23 offen offset:1024 lds
    v_exp_f32 v73, v73
    v_fma_f32 v74, v74, s20, v22
    v_add_f32 v20, v20, v72
    v_mfma_f32_32x32x16_bf16 v[112:127], a[80:83], a[48:51], v[112:127]
    ds_read_b64_tr_b16 a[64:65], v10 offset:16384
    ds_read_b64_tr_b16 a[66:67], v10 offset:18432
    v_exp_f32 v74, v74
    v_fma_f32 v75, v75, s20, v22
    v_add_f32 v20, v20, v73
    v_cvt_pk_bf16_f32 v72, v72, v73
    v_mfma_f32_32x32x16_bf16 v[96:111], a[84:87], a[20:23], v[96:111]
    buffer_load_dwordx4 v16, s[8:11], s23 offen offset:2048 lds
    v_exp_f32 v75, v75
    v_fma_f32 v76, v76, s20, v22
    v_add_f32 v20, v20, v74
    v_mfma_f32_32x32x16_bf16 v[112:127], a[84:87], a[52:55], v[112:127]
    s_waitcnt lgkmcnt(2)
    ds_read_b64_tr_b16 a[68:69], v11 offset:16384
    ds_read_b64_tr_b16 a[70:71], v11 offset:18432
    v_exp_f32 v76, v76
    v_fma_f32 v77, v77, s20, v22
    v_add_f32 v20, v20, v75
    v_cvt_pk_bf16_f32 v73, v74, v75
    v_mfma_f32_32x32x16_bf16 v[96:111], a[88:91], a[24:27], v[96:111]
    buffer_load_dwordx4 v17, s[8:11], s23 offen offset:3072 lds
    v_exp_f32 v77, v77
    v_fma_f32 v78, v78, s20, v22
    v_add_f32 v20, v20, v76
    v_mfma_f32_32x32x16_bf16 v[112:127], a[88:91], a[56:59], v[112:127]
    ds_read_b64_tr_b16 a[72:73], v12 offset:16384
    ds_read_b64_tr_b16 a[74:75], v12 offset:18432
    v_exp_f32 v78, v78
    v_fma_f32 v79, v79, s20, v22
    v_add_f32 v20, v20, v77
    v_cvt_pk_bf16_f32 v74, v76, v77
    v_mfma_f32_32x32x16_bf16 v[96:111], a[92:95], a[28:31], v[96:111]
    v_exp_f32 v79, v79
    v_fma_f32 v88, v88, s20, v23
    v_add_f32 v20, v20, v78
    v_mfma_f32_32x32x16_bf16 v[112:127], a[92:95], a[60:63], v[112:127]
    s_waitcnt lgkmcnt(2)
    ds_read_b64_tr_b16 a[76:77], v13 offset:16384
    ds_read_b64_tr_b16 a[78:79], v13 offset:18432
    v_exp_f32 v88, v88
    v_fma_f32 v89, v89, s20, v23
    v_add_f32 v20, v20, v79
    v_cvt_pk_bf16_f32 v75, v78, v79
    v_mfma_f32_32x32x16_bf16 a[128:143], a[64:67], v[64:67], a[128:143]
    v_exp_f32 v89, v89
    v_fma_f32 v90, v90, s20, v23
    v_add_f32 v21, v21, v88
    v_mfma_f32_32x32x16_bf16 a[192:207], a[64:67], v[80:83], a[192:207]
    ds_read_b64_tr_b16 a[80:81], v10 offset:20480
    ds_read_b64_tr_b16 a[82:83], v10 offset:22528
    v_exp_f32 v90, v90
    v_fma_f32 v91, v91, s20, v23
    v_add_f32 v21, v21, v89
    v_cvt_pk_bf16_f32 v88, v88, v89
    v_mfma_f32_32x32x16_bf16 a[144:159], a[68:71], v[64:67], a[144:159]
    v_exp_f32 v91, v91
    v_fma_f32 v92, v92, s20, v23
    v_add_f32 v21, v21, v90
    v_mfma_f32_32x32x16_bf16 a[208:223], a[68:71], v[80:83], a[208:223]
    s_waitcnt lgkmcnt(2)
    ds_read_b64_tr_b16 a[84:85], v11 offset:20480
    ds_read_b64_tr_b16 a[86:87], v11 offset:22528
    v_exp_f32 v92, v92
    v_fma_f32 v93, v93, s20, v23
    v_add_f32 v21, v21, v91
    v_cvt_pk_bf16_f32 v89, v90, v91
    v_mfma_f32_32x32x16_bf16 a[160:175], a[72:75], v[64:67], a[160:175]
    v_exp_f32 v93, v93
    v_fma_f32 v94, v94, s20, v23
    v_add_f32 v21, v21, v92
    v_mfma_f32_32x32x16_bf16 a[224:239], a[72:75], v[80:83], a[224:239]
    ds_read_b64_tr_b16 a[88:89], v12 offset:20480
    ds_read_b64_tr_b16 a[90:91], v12 offset:22528
    v_exp_f32 v94, v94
    v_fma_f32 v95, v95, s20, v23
    v_add_f32 v21, v21, v93
    v_cvt_pk_bf16_f32 v90, v92, v93
    v_mfma_f32_32x32x16_bf16 a[176:191], a[76:79], v[64:67], a[176:191]
    v_exp_f32 v95, v95
    v_add_f32 v21, v21, v94
    v_add_f32 v21, v21, v95
    v_cvt_pk_bf16_f32 v91, v94, v95
    v_mfma_f32_32x32x16_bf16 a[240:255], a[76:79], v[80:83], a[240:255]
    s_waitcnt lgkmcnt(2)
    ds_read_b64_tr_b16 a[92:93], v13 offset:20480
    ds_read_b64_tr_b16 a[94:95], v13 offset:22528
    v_fma_f32 v96, v96, s20, v22
    v_exp_f32 v96, v96
    v_fma_f32 v97, v97, s20, v22
    v_mfma_f32_32x32x16_bf16 a[128:143], a[80:83], v[72:75], a[128:143]
    v_exp_f32 v97, v97
    v_fma_f32 v98, v98, s20, v22
    v_add_f32 v20, v20, v96
    v_mfma_f32_32x32x16_bf16 a[192:207], a[80:83], v[88:91], a[192:207]
    ds_read_b128 a[64:67], v2 offset:32768
    v_exp_f32 v98, v98
    v_fma_f32 v99, v99, s20, v22
    v_add_f32 v20, v20, v97
    v_cvt_pk_bf16_f32 v96, v96, v97
    v_mfma_f32_32x32x16_bf16 a[144:159], a[84:87], v[72:75], a[144:159]
    v_exp_f32 v99, v99
    v_fma_f32 v100, v100, s20, v22
    v_add_f32 v20, v20, v98
    v_mfma_f32_32x32x16_bf16 a[208:223], a[84:87], v[88:91], a[208:223]
    s_waitcnt lgkmcnt(1)
    ds_read_b128 a[68:71], v3 offset:32768
    v_exp_f32 v100, v100
    v_fma_f32 v101, v101, s20, v22
    v_add_f32 v20, v20, v99
    v_cvt_pk_bf16_f32 v97, v98, v99
    v_mfma_f32_32x32x16_bf16 a[160:175], a[88:91], v[72:75], a[160:175]
    v_exp_f32 v101, v101
    v_fma_f32 v102, v102, s20, v22
    v_add_f32 v20, v20, v100
    v_mfma_f32_32x32x16_bf16 a[224:239], a[88:91], v[88:91], a[224:239]
    ds_read_b128 a[72:75], v4 offset:32768
    v_exp_f32 v102, v102
    v_fma_f32 v103, v103, s20, v22
    v_add_f32 v20, v20, v101
    v_cvt_pk_bf16_f32 v98, v100, v101
    v_mfma_f32_32x32x16_bf16 a[176:191], a[92:95], v[72:75], a[176:191]
    v_exp_f32 v103, v103
    v_fma_f32 v112, v112, s20, v23
    v_add_f32 v20, v20, v102
    v_mfma_f32_32x32x16_bf16 a[240:255], a[92:95], v[88:91], a[240:255]
    s_waitcnt lgkmcnt(1)
    ds_read_b128 a[76:79], v5 offset:32768
    v_exp_f32 v112, v112
    v_fma_f32 v113, v113, s20, v23
    v_add_f32 v20, v20, v103
    v_cvt_pk_bf16_f32 v99, v102, v103
    v_mfma_f32_32x32x16_bf16 v[64:79], a[64:67], a[0:3], 0
    v_exp_f32 v113, v113
    v_fma_f32 v114, v114, s20, v23
    v_add_f32 v21, v21, v112
    v_mfma_f32_32x32x16_bf16 v[80:95], a[64:67], a[32:35], 0
    ds_read_b128 a[80:83], v6 offset:32768
    v_exp_f32 v114, v114
    v_fma_f32 v115, v115, s20, v23
    v_add_f32 v21, v21, v113
    v_cvt_pk_bf16_f32 v112, v112, v113
    v_mfma_f32_32x32x16_bf16 v[64:79], a[68:71], a[4:7], v[64:79]
    s_add_u32 m0, s22, 65536
    s_add_u32 s33, s22, 65536
    v_exp_f32 v115, v115
    v_fma_f32 v116, v116, s20, v23
    v_add_f32 v21, v21, v114
    v_mfma_f32_32x32x16_bf16 v[80:95], a[68:71], a[36:39], v[80:95]
    s_waitcnt lgkmcnt(1)
    ds_read_b128 a[84:87], v7 offset:32768
    v_exp_f32 v116, v116
    v_fma_f32 v117, v117, s20, v23
    v_add_f32 v21, v21, v115
    v_cvt_pk_bf16_f32 v113, v114, v115
    v_mfma_f32_32x32x16_bf16 v[64:79], a[72:75], a[8:11], v[64:79]
    buffer_load_dwordx4 v18, s[12:15], s33 offen offset:0 lds
    v_exp_f32 v117, v117
    v_fma_f32 v118, v118, s20, v23
    v_add_f32 v21, v21, v116
    v_mfma_f32_32x32x16_bf16 v[80:95], a[72:75], a[40:43], v[80:95]
    ds_read_b128 a[88:91], v8 offset:32768
    v_exp_f32 v118, v118
    v_fma_f32 v119, v119, s20, v23
    v_add_f32 v21, v21, v117
    v_cvt_pk_bf16_f32 v114, v116, v117
    v_mfma_f32_32x32x16_bf16 v[64:79], a[76:79], a[12:15], v[64:79]
    buffer_load_dwordx4 v18, s[12:15], s33 offen offset:1024 lds
    v_exp_f32 v119, v119
    v_fma_f32 v104, v104, s20, v22
    v_add_f32 v21, v21, v118
    v_mfma_f32_32x32x16_bf16 v[80:95], a[76:79], a[44:47], v[80:95]
    s_waitcnt lgkmcnt(1)
    ds_read_b128 a[92:95], v9 offset:32768
    v_exp_f32 v104, v104
    v_fma_f32 v105, v105, s20, v22
    v_add_f32 v21, v21, v119
    v_cvt_pk_bf16_f32 v115, v118, v119
    v_mfma_f32_32x32x16_bf16 v[64:79], a[80:83], a[16:19], v[64:79]
    buffer_load_dwordx4 v18, s[12:15], s33 offen offset:2048 lds
    v_exp_f32 v105, v105
    v_fma_f32 v106, v106, s20, v22
    v_add_f32 v20, v20, v104
    v_mfma_f32_32x32x16_bf16 v[80:95], a[80:83], a[48:51], v[80:95]
    ds_read_b64_tr_b16 a[64:65], v10 offset:24576
    ds_read_b64_tr_b16 a[66:67], v10 offset:26624
    v_exp_f32 v106, v106
    v_fma_f32 v107, v107, s20, v22
    v_add_f32 v20, v20, v105
    v_cvt_pk_bf16_f32 v104, v104, v105
    v_mfma_f32_32x32x16_bf16 v[64:79], a[84:87], a[20:23], v[64:79]
    buffer_load_dwordx4 v18, s[12:15], s33 offen offset:3072 lds
    v_exp_f32 v107, v107
    v_fma_f32 v108, v108, s20, v22
    v_add_f32 v20, v20, v106
    v_mfma_f32_32x32x16_bf16 v[80:95], a[84:87], a[52:55], v[80:95]
    s_waitcnt lgkmcnt(2)
    ds_read_b64_tr_b16 a[68:69], v11 offset:24576
    ds_read_b64_tr_b16 a[70:71], v11 offset:26624
    v_exp_f32 v108, v108
    v_fma_f32 v109, v109, s20, v22
    v_add_f32 v20, v20, v107
    v_cvt_pk_bf16_f32 v105, v106, v107
    v_mfma_f32_32x32x16_bf16 v[64:79], a[88:91], a[24:27], v[64:79]
    v_exp_f32 v109, v109
    v_fma_f32 v110, v110, s20, v22
    v_add_f32 v20, v20, v108
    v_mfma_f32_32x32x16_bf16 v[80:95], a[88:91], a[56:59], v[80:95]
    ds_read_b64_tr_b16 a[72:73], v12 offset:24576
    ds_read_b64_tr_b16 a[74:75], v12 offset:26624
    v_exp_f32 v110, v110
    v_fma_f32 v111, v111, s20, v22
    v_add_f32 v20, v20, v109
    v_cvt_pk_bf16_f32 v106, v108, v109
    v_mfma_f32_32x32x16_bf16 v[64:79], a[92:95], a[28:31], v[64:79]
    v_exp_f32 v111, v111
    v_fma_f32 v120, v120, s20, v23
    v_add_f32 v20, v20, v110
    v_mfma_f32_32x32x16_bf16 v[80:95], a[92:95], a[60:63], v[80:95]
    s_waitcnt lgkmcnt(2)
    ds_read_b64_tr_b16 a[76:77], v13 offset:24576
    ds_read_b64_tr_b16 a[78:79], v13 offset:26624
    v_exp_f32 v120, v120
    v_fma_f32 v121, v121, s20, v23
    v_add_f32 v20, v20, v111
    v_cvt_pk_bf16_f32 v107, v110, v111
    v_mfma_f32_32x32x16_bf16 a[128:143], a[64:67], v[96:99], a[128:143]
    v_exp_f32 v121, v121
    v_fma_f32 v122, v122, s20, v23
    v_add_f32 v21, v21, v120
    v_mfma_f32_32x32x16_bf16 a[192:207], a[64:67], v[112:115], a[192:207]
    ds_read_b64_tr_b16 a[80:81], v10 offset:28672
    ds_read_b64_tr_b16 a[82:83], v10 offset:30720
    v_exp_f32 v122, v122
    v_fma_f32 v123, v123, s20, v23
    v_add_f32 v21, v21, v121
    v_cvt_pk_bf16_f32 v120, v120, v121
    v_mfma_f32_32x32x16_bf16 a[144:159], a[68:71], v[96:99], a[144:159]
    v_exp_f32 v123, v123
    v_fma_f32 v124, v124, s20, v23
    v_add_f32 v21, v21, v122
    v_mfma_f32_32x32x16_bf16 a[208:223], a[68:71], v[112:115], a[208:223]
    s_waitcnt lgkmcnt(2)
    ds_read_b64_tr_b16 a[84:85], v11 offset:28672
    ds_read_b64_tr_b16 a[86:87], v11 offset:30720
    v_exp_f32 v124, v124
    v_fma_f32 v125, v125, s20, v23
    v_add_f32 v21, v21, v123
    v_cvt_pk_bf16_f32 v121, v122, v123
    v_mfma_f32_32x32x16_bf16 a[160:175], a[72:75], v[96:99], a[160:175]
    v_exp_f32 v125, v125
    v_fma_f32 v126, v126, s20, v23
    v_add_f32 v21, v21, v124
    v_mfma_f32_32x32x16_bf16 a[224:239], a[72:75], v[112:115], a[224:239]
    ds_read_b64_tr_b16 a[88:89], v12 offset:28672
    ds_read_b64_tr_b16 a[90:91], v12 offset:30720
    v_exp_f32 v126, v126
    v_fma_f32 v127, v127, s20, v23
    v_add_f32 v21, v21, v125
    v_cvt_pk_bf16_f32 v122, v124, v125
    v_mfma_f32_32x32x16_bf16 a[176:191], a[76:79], v[96:99], a[176:191]
    v_exp_f32 v127, v127
    v_add_f32 v21, v21, v126
    v_add_f32 v21, v21, v127
    v_cvt_pk_bf16_f32 v123, v126, v127
    v_mfma_f32_32x32x16_bf16 a[240:255], a[76:79], v[112:115], a[240:255]
    s_waitcnt lgkmcnt(2)
    ds_read_b64_tr_b16 a[92:93], v13 offset:28672
    ds_read_b64_tr_b16 a[94:95], v13 offset:30720
    v_fma_f32 v64, v64, s20, v22
    v_exp_f32 v64, v64
    v_fma_f32 v65, v65, s20, v22
    v_mfma_f32_32x32x16_bf16 a[128:143], a[80:83], v[104:107], a[128:143]
    v_exp_f32 v65, v65
    v_fma_f32 v66, v66, s20, v22
    v_add_f32 v20, v20, v64
    v_mfma_f32_32x32x16_bf16 a[192:207], a[80:83], v[120:123], a[192:207]
    ds_read_b128 a[64:67], v2 offset:40960
    v_exp_f32 v66, v66
    v_fma_f32 v67, v67, s20, v22
    v_add_f32 v20, v20, v65
    v_cvt_pk_bf16_f32 v64, v64, v65
    v_mfma_f32_32x32x16_bf16 a[144:159], a[84:87], v[104:107], a[144:159]
    v_exp_f32 v67, v67
    v_fma_f32 v68, v68, s20, v22
    v_add_f32 v20, v20, v66
    v_mfma_f32_32x32x16_bf16 a[208:223], a[84:87], v[120:123], a[208:223]
    s_waitcnt lgkmcnt(1)
    ds_read_b128 a[68:71], v3 offset:40960
    v_exp_f32 v68, v68
    v_fma_f32 v69, v69, s20, v22
    v_add_f32 v20, v20, v67
    v_cvt_pk_bf16_f32 v65, v66, v67
    v_mfma_f32_32x32x16_bf16 a[160:175], a[88:91], v[104:107], a[160:175]
    v_exp_f32 v69, v69
    v_fma_f32 v70, v70, s20, v22
    v_add_f32 v20, v20, v68
    v_mfma_f32_32x32x16_bf16 a[224:239], a[88:91], v[120:123], a[224:239]
    ds_read_b128 a[72:75], v4 offset:40960
    v_exp_f32 v70, v70
    v_fma_f32 v71, v71, s20, v22
    v_add_f32 v20, v20, v69
    v_cvt_pk_bf16_f32 v66, v68, v69
    v_mfma_f32_32x32x16_bf16 a[176:191], a[92:95], v[104:107], a[176:191]
    v_exp_f32 v71, v71
    v_fma_f32 v80, v80, s20, v23
    v_add_f32 v20, v20, v70
    v_mfma_f32_32x32x16_bf16 a[240:255], a[92:95], v[120:123], a[240:255]
    s_waitcnt lgkmcnt(1)
    ds_read_b128 a[76:79], v5 offset:40960
    v_exp_f32 v80, v80
    v_fma_f32 v81, v81, s20, v23
    v_add_f32 v20, v20, v71
    v_cvt_pk_bf16_f32 v67, v70, v71
    v_mfma_f32_32x32x16_bf16 v[96:111], a[64:67], a[0:3], 0
    v_exp_f32 v81, v81
    v_fma_f32 v82, v82, s20, v23
    v_add_f32 v21, v21, v80
    v_mfma_f32_32x32x16_bf16 v[112:127], a[64:67], a[32:35], 0
    s_waitcnt vmcnt(12)
    ds_read_b128 a[80:83], v6 offset:40960
    v_exp_f32 v82, v82
    v_fma_f32 v83, v83, s20, v23
    v_add_f32 v21, v21, v81
    v_cvt_pk_bf16_f32 v80, v80, v81
    v_mfma_f32_32x32x16_bf16 v[96:111], a[68:71], a[4:7], v[96:111]
    s_barrier
    v_exp_f32 v83, v83
    v_fma_f32 v84, v84, s20, v23
    v_add_f32 v21, v21, v82
    v_mfma_f32_32x32x16_bf16 v[112:127], a[68:71], a[36:39], v[112:127]
    s_waitcnt lgkmcnt(1)
    ds_read_b128 a[84:87], v7 offset:40960
    v_exp_f32 v84, v84
    v_fma_f32 v85, v85, s20, v23
    v_add_f32 v21, v21, v83
    v_cvt_pk_bf16_f32 v81, v82, v83
    v_mfma_f32_32x32x16_bf16 v[96:111], a[72:75], a[8:11], v[96:111]
    s_add_u32 m0, s22, 16384
    s_add_u32 s23, s22, 81920
    v_exp_f32 v85, v85
    v_fma_f32 v86, v86, s20, v23
    v_add_f32 v21, v21, v84
    v_mfma_f32_32x32x16_bf16 v[112:127], a[72:75], a[40:43], v[112:127]
    ds_read_b128 a[88:91], v8 offset:40960
    v_exp_f32 v86, v86
    v_fma_f32 v87, v87, s20, v23
    v_add_f32 v21, v21, v85
    v_cvt_pk_bf16_f32 v82, v84, v85
    v_mfma_f32_32x32x16_bf16 v[96:111], a[76:79], a[12:15], v[96:111]
    buffer_load_dwordx4 v14, s[8:11], s23 offen offset:0 lds
    v_exp_f32 v87, v87
    v_fma_f32 v72, v72, s20, v22
    v_add_f32 v21, v21, v86
    v_mfma_f32_32x32x16_bf16 v[112:127], a[76:79], a[44:47], v[112:127]
    s_waitcnt lgkmcnt(1)
    ds_read_b128 a[92:95], v9 offset:40960
    v_exp_f32 v72, v72
    v_fma_f32 v73, v73, s20, v22
    v_add_f32 v21, v21, v87
    v_cvt_pk_bf16_f32 v83, v86, v87
    v_mfma_f32_32x32x16_bf16 v[96:111], a[80:83], a[16:19], v[96:111]
    buffer_load_dwordx4 v15, s[8:11], s23 offen offset:1024 lds
    v_exp_f32 v73, v73
    v_fma_f32 v74, v74, s20, v22
    v_add_f32 v20, v20, v72
    v_mfma_f32_32x32x16_bf16 v[112:127], a[80:83], a[48:51], v[112:127]
    ds_read_b64_tr_b16 a[64:65], v10 offset:32768
    ds_read_b64_tr_b16 a[66:67], v10 offset:34816
    v_exp_f32 v74, v74
    v_fma_f32 v75, v75, s20, v22
    v_add_f32 v20, v20, v73
    v_cvt_pk_bf16_f32 v72, v72, v73
    v_mfma_f32_32x32x16_bf16 v[96:111], a[84:87], a[20:23], v[96:111]
    buffer_load_dwordx4 v16, s[8:11], s23 offen offset:2048 lds
    v_exp_f32 v75, v75
    v_fma_f32 v76, v76, s20, v22
    v_add_f32 v20, v20, v74
    v_mfma_f32_32x32x16_bf16 v[112:127], a[84:87], a[52:55], v[112:127]
    s_waitcnt lgkmcnt(2)
    ds_read_b64_tr_b16 a[68:69], v11 offset:32768
    ds_read_b64_tr_b16 a[70:71], v11 offset:34816
    v_exp_f32 v76, v76
    v_fma_f32 v77, v77, s20, v22
    v_add_f32 v20, v20, v75
    v_cvt_pk_bf16_f32 v73, v74, v75
    v_mfma_f32_32x32x16_bf16 v[96:111], a[88:91], a[24:27], v[96:111]
    buffer_load_dwordx4 v17, s[8:11], s23 offen offset:3072 lds
    v_exp_f32 v77, v77
    v_fma_f32 v78, v78, s20, v22
    v_add_f32 v20, v20, v76
    v_mfma_f32_32x32x16_bf16 v[112:127], a[88:91], a[56:59], v[112:127]
    ds_read_b64_tr_b16 a[72:73], v12 offset:32768
    ds_read_b64_tr_b16 a[74:75], v12 offset:34816
    v_exp_f32 v78, v78
    v_fma_f32 v79, v79, s20, v22
    v_add_f32 v20, v20, v77
    v_cvt_pk_bf16_f32 v74, v76, v77
    v_mfma_f32_32x32x16_bf16 v[96:111], a[92:95], a[28:31], v[96:111]
    v_exp_f32 v79, v79
    v_fma_f32 v88, v88, s20, v23
    v_add_f32 v20, v20, v78
    v_mfma_f32_32x32x16_bf16 v[112:127], a[92:95], a[60:63], v[112:127]
    s_waitcnt lgkmcnt(2)
    ds_read_b64_tr_b16 a[76:77], v13 offset:32768
    ds_read_b64_tr_b16 a[78:79], v13 offset:34816
    v_exp_f32 v88, v88
    v_fma_f32 v89, v89, s20, v23
    v_add_f32 v20, v20, v79
    v_cvt_pk_bf16_f32 v75, v78, v79
    v_mfma_f32_32x32x16_bf16 a[128:143], a[64:67], v[64:67], a[128:143]
    v_exp_f32 v89, v89
    v_fma_f32 v90, v90, s20, v23
    v_add_f32 v21, v21, v88
    v_mfma_f32_32x32x16_bf16 a[192:207], a[64:67], v[80:83], a[192:207]
    ds_read_b64_tr_b16 a[80:81], v10 offset:36864
    ds_read_b64_tr_b16 a[82:83], v10 offset:38912
    v_exp_f32 v90, v90
    v_fma_f32 v91, v91, s20, v23
    v_add_f32 v21, v21, v89
    v_cvt_pk_bf16_f32 v88, v88, v89
    v_mfma_f32_32x32x16_bf16 a[144:159], a[68:71], v[64:67], a[144:159]
    v_exp_f32 v91, v91
    v_fma_f32 v92, v92, s20, v23
    v_add_f32 v21, v21, v90
    v_mfma_f32_32x32x16_bf16 a[208:223], a[68:71], v[80:83], a[208:223]
    s_waitcnt lgkmcnt(2)
    ds_read_b64_tr_b16 a[84:85], v11 offset:36864
    ds_read_b64_tr_b16 a[86:87], v11 offset:38912
    v_exp_f32 v92, v92
    v_fma_f32 v93, v93, s20, v23
    v_add_f32 v21, v21, v91
    v_cvt_pk_bf16_f32 v89, v90, v91
    v_mfma_f32_32x32x16_bf16 a[160:175], a[72:75], v[64:67], a[160:175]
    v_exp_f32 v93, v93
    v_fma_f32 v94, v94, s20, v23
    v_add_f32 v21, v21, v92
    v_mfma_f32_32x32x16_bf16 a[224:239], a[72:75], v[80:83], a[224:239]
    ds_read_b64_tr_b16 a[88:89], v12 offset:36864
    ds_read_b64_tr_b16 a[90:91], v12 offset:38912
    v_exp_f32 v94, v94
    v_fma_f32 v95, v95, s20, v23
    v_add_f32 v21, v21, v93
    v_cvt_pk_bf16_f32 v90, v92, v93
    v_mfma_f32_32x32x16_bf16 a[176:191], a[76:79], v[64:67], a[176:191]
    v_exp_f32 v95, v95
    v_add_f32 v21, v21, v94
    v_add_f32 v21, v21, v95
    v_cvt_pk_bf16_f32 v91, v94, v95
    v_mfma_f32_32x32x16_bf16 a[240:255], a[76:79], v[80:83], a[240:255]
    s_waitcnt lgkmcnt(2)
    ds_read_b64_tr_b16 a[92:93], v13 offset:36864
    ds_read_b64_tr_b16 a[94:95], v13 offset:38912
    v_fma_f32 v96, v96, s20, v22
    v_exp_f32 v96, v96
    v_fma_f32 v97, v97, s20, v22
    v_mfma_f32_32x32x16_bf16 a[128:143], a[80:83], v[72:75], a[128:143]
    v_exp_f32 v97, v97
    v_fma_f32 v98, v98, s20, v22
    v_add_f32 v20, v20, v96
    v_mfma_f32_32x32x16_bf16 a[192:207], a[80:83], v[88:91], a[192:207]
    ds_read_b128 a[64:67], v2 offset:49152
    v_exp_f32 v98, v98
    v_fma_f32 v99, v99, s20, v22
    v_add_f32 v20, v20, v97
    v_cvt_pk_bf16_f32 v96, v96, v97
    v_mfma_f32_32x32x16_bf16 a[144:159], a[84:87], v[72:75], a[144:159]
    v_exp_f32 v99, v99
    v_fma_f32 v100, v100, s20, v22
    v_add_f32 v20, v20, v98
    v_mfma_f32_32x32x16_bf16 a[208:223], a[84:87], v[88:91], a[208:223]
    s_waitcnt lgkmcnt(1)
    ds_read_b128 a[68:71], v3 offset:49152
    v_exp_f32 v100, v100
    v_fma_f32 v101, v101, s20, v22
    v_add_f32 v20, v20, v99
    v_cvt_pk_bf16_f32 v97, v98, v99
    v_mfma_f32_32x32x16_bf16 a[160:175], a[88:91], v[72:75], a[160:175]
    v_exp_f32 v101, v101
    v_fma_f32 v102, v102, s20, v22
    v_add_f32 v20, v20, v100
    v_mfma_f32_32x32x16_bf16 a[224:239], a[88:91], v[88:91], a[224:239]
    ds_read_b128 a[72:75], v4 offset:49152
    v_exp_f32 v102, v102
    v_fma_f32 v103, v103, s20, v22
    v_add_f32 v20, v20, v101
    v_cvt_pk_bf16_f32 v98, v100, v101
    v_mfma_f32_32x32x16_bf16 a[176:191], a[92:95], v[72:75], a[176:191]
    v_exp_f32 v103, v103
    v_fma_f32 v112, v112, s20, v23
    v_add_f32 v20, v20, v102
    v_mfma_f32_32x32x16_bf16 a[240:255], a[92:95], v[88:91], a[240:255]
    s_waitcnt lgkmcnt(1)
    ds_read_b128 a[76:79], v5 offset:49152
    v_exp_f32 v112, v112
    v_fma_f32 v113, v113, s20, v23
    v_add_f32 v20, v20, v103
    v_cvt_pk_bf16_f32 v99, v102, v103
    v_mfma_f32_32x32x16_bf16 v[64:79], a[64:67], a[0:3], 0
    v_exp_f32 v113, v113
    v_fma_f32 v114, v114, s20, v23
    v_add_f32 v21, v21, v112
    v_mfma_f32_32x32x16_bf16 v[80:95], a[64:67], a[32:35], 0
    ds_read_b128 a[80:83], v6 offset:49152
    v_exp_f32 v114, v114
    v_fma_f32 v115, v115, s20, v23
    v_add_f32 v21, v21, v113
    v_cvt_pk_bf16_f32 v112, v112, v113
    v_mfma_f32_32x32x16_bf16 v[64:79], a[68:71], a[4:7], v[64:79]
    s_add_u32 m0, s22, 81920
    s_add_u32 s33, s22, 81920
    v_exp_f32 v115, v115
    v_fma_f32 v116, v116, s20, v23
    v_add_f32 v21, v21, v114
    v_mfma_f32_32x32x16_bf16 v[80:95], a[68:71], a[36:39], v[80:95]
    s_waitcnt lgkmcnt(1)
    ds_read_b128 a[84:87], v7 offset:49152
    v_exp_f32 v116, v116
    v_fma_f32 v117, v117, s20, v23
    v_add_f32 v21, v21, v115
    v_cvt_pk_bf16_f32 v113, v114, v115
    v_mfma_f32_32x32x16_bf16 v[64:79], a[72:75], a[8:11], v[64:79]
    buffer_load_dwordx4 v18, s[12:15], s33 offen offset:0 lds
    v_exp_f32 v117, v117
    v_fma_f32 v118, v118, s20, v23
    v_add_f32 v21, v21, v116
    v_mfma_f32_32x32x16_bf16 v[80:95], a[72:75], a[40:43], v[80:95]
    ds_read_b128 a[88:91], v8 offset:49152
    v_exp_f32 v118, v118
    v_fma_f32 v119, v119, s20, v23
    v_add_f32 v21, v21, v117
    v_cvt_pk_bf16_f32 v114, v116, v117
    v_mfma_f32_32x32x16_bf16 v[64:79], a[76:79], a[12:15], v[64:79]
    buffer_load_dwordx4 v18, s[12:15], s33 offen offset:1024 lds
    v_exp_f32 v119, v119
    v_fma_f32 v104, v104, s20, v22
    v_add_f32 v21, v21, v118
    v_mfma_f32_32x32x16_bf16 v[80:95], a[76:79], a[44:47], v[80:95]
    s_waitcnt lgkmcnt(1)
    ds_read_b128 a[92:95], v9 offset:49152
    v_exp_f32 v104, v104
    v_fma_f32 v105, v105, s20, v22
    v_add_f32 v21, v21, v119
    v_cvt_pk_bf16_f32 v115, v118, v119
    v_mfma_f32_32x32x16_bf16 v[64:79], a[80:83], a[16:19], v[64:79]
    buffer_load_dwordx4 v18, s[12:15], s33 offen offset:2048 lds
    v_exp_f32 v105, v105
    v_fma_f32 v106, v106, s20, v22
    v_add_f32 v20, v20, v104
    v_mfma_f32_32x32x16_bf16 v[80:95], a[80:83], a[48:51], v[80:95]
    ds_read_b64_tr_b16 a[64:65], v10 offset:40960
    ds_read_b64_tr_b16 a[66:67], v10 offset:43008
    v_exp_f32 v106, v106
    v_fma_f32 v107, v107, s20, v22
    v_add_f32 v20, v20, v105
    v_cvt_pk_bf16_f32 v104, v104, v105
    v_mfma_f32_32x32x16_bf16 v[64:79], a[84:87], a[20:23], v[64:79]
    buffer_load_dwordx4 v18, s[12:15], s33 offen offset:3072 lds
    v_exp_f32 v107, v107
    v_fma_f32 v108, v108, s20, v22
    v_add_f32 v20, v20, v106
    v_mfma_f32_32x32x16_bf16 v[80:95], a[84:87], a[52:55], v[80:95]
    s_waitcnt lgkmcnt(2)
    ds_read_b64_tr_b16 a[68:69], v11 offset:40960
    ds_read_b64_tr_b16 a[70:71], v11 offset:43008
    v_exp_f32 v108, v108
    v_fma_f32 v109, v109, s20, v22
    v_add_f32 v20, v20, v107
    v_cvt_pk_bf16_f32 v105, v106, v107
    v_mfma_f32_32x32x16_bf16 v[64:79], a[88:91], a[24:27], v[64:79]
    v_exp_f32 v109, v109
    v_fma_f32 v110, v110, s20, v22
    v_add_f32 v20, v20, v108
    v_mfma_f32_32x32x16_bf16 v[80:95], a[88:91], a[56:59], v[80:95]
    ds_read_b64_tr_b16 a[72:73], v12 offset:40960
    ds_read_b64_tr_b16 a[74:75], v12 offset:43008
    v_exp_f32 v110, v110
    v_fma_f32 v111, v111, s20, v22
    v_add_f32 v20, v20, v109
    v_cvt_pk_bf16_f32 v106, v108, v109
    v_mfma_f32_32x32x16_bf16 v[64:79], a[92:95], a[28:31], v[64:79]
    v_exp_f32 v111, v111
    v_fma_f32 v120, v120, s20, v23
    v_add_f32 v20, v20, v110
    v_mfma_f32_32x32x16_bf16 v[80:95], a[92:95], a[60:63], v[80:95]
    s_waitcnt lgkmcnt(2)
    ds_read_b64_tr_b16 a[76:77], v13 offset:40960
    ds_read_b64_tr_b16 a[78:79], v13 offset:43008
    v_exp_f32 v120, v120
    v_fma_f32 v121, v121, s20, v23
    v_add_f32 v20, v20, v111
    v_cvt_pk_bf16_f32 v107, v110, v111
    v_mfma_f32_32x32x16_bf16 a[128:143], a[64:67], v[96:99], a[128:143]
    v_exp_f32 v121, v121
    v_fma_f32 v122, v122, s20, v23
    v_add_f32 v21, v21, v120
    v_mfma_f32_32x32x16_bf16 a[192:207], a[64:67], v[112:115], a[192:207]
    ds_read_b64_tr_b16 a[80:81], v10 offset:45056
    ds_read_b64_tr_b16 a[82:83], v10 offset:47104
    v_exp_f32 v122, v122
    v_fma_f32 v123, v123, s20, v23
    v_add_f32 v21, v21, v121
    v_cvt_pk_bf16_f32 v120, v120, v121
    v_mfma_f32_32x32x16_bf16 a[144:159], a[68:71], v[96:99], a[144:159]
    v_exp_f32 v123, v123
    v_fma_f32 v124, v124, s20, v23
    v_add_f32 v21, v21, v122
    v_mfma_f32_32x32x16_bf16 a[208:223], a[68:71], v[112:115], a[208:223]
    s_waitcnt lgkmcnt(2)
    ds_read_b64_tr_b16 a[84:85], v11 offset:45056
    ds_read_b64_tr_b16 a[86:87], v11 offset:47104
    v_exp_f32 v124, v124
    v_fma_f32 v125, v125, s20, v23
    v_add_f32 v21, v21, v123
    v_cvt_pk_bf16_f32 v121, v122, v123
    v_mfma_f32_32x32x16_bf16 a[160:175], a[72:75], v[96:99], a[160:175]
    v_exp_f32 v125, v125
    v_fma_f32 v126, v126, s20, v23
    v_add_f32 v21, v21, v124
    v_mfma_f32_32x32x16_bf16 a[224:239], a[72:75], v[112:115], a[224:239]
    ds_read_b64_tr_b16 a[88:89], v12 offset:45056
    ds_read_b64_tr_b16 a[90:91], v12 offset:47104
    v_exp_f32 v126, v126
    v_fma_f32 v127, v127, s20, v23
    v_add_f32 v21, v21, v125
    v_cvt_pk_bf16_f32 v122, v124, v125
    v_mfma_f32_32x32x16_bf16 a[176:191], a[76:79], v[96:99], a[176:191]
    v_exp_f32 v127, v127
    v_add_f32 v21, v21, v126
    v_add_f32 v21, v21, v127
    v_cvt_pk_bf16_f32 v123, v126, v127
    v_mfma_f32_32x32x16_bf16 a[240:255], a[76:79], v[112:115], a[240:255]
    s_waitcnt lgkmcnt(2)
    ds_read_b64_tr_b16 a[92:93], v13 offset:45056
    ds_read_b64_tr_b16 a[94:95], v13 offset:47104
    v_fma_f32 v64, v64, s20, v22
    v_exp_f32 v64, v64
    v_fma_f32 v65, v65, s20, v22
    v_mfma_f32_32x32x16_bf16 a[128:143], a[80:83], v[104:107], a[128:143]
    v_exp_f32 v65, v65
    v_fma_f32 v66, v66, s20, v22
    v_add_f32 v20, v20, v64
    v_mfma_f32_32x32x16_bf16 a[192:207], a[80:83], v[120:123], a[192:207]
    ds_read_b128 a[64:67], v2 offset:57344
    v_exp_f32 v66, v66
    v_fma_f32 v67, v67, s20, v22
    v_add_f32 v20, v20, v65
    v_cvt_pk_bf16_f32 v64, v64, v65
    v_mfma_f32_32x32x16_bf16 a[144:159], a[84:87], v[104:107], a[144:159]
    v_exp_f32 v67, v67
    v_fma_f32 v68, v68, s20, v22
    v_add_f32 v20, v20, v66
    v_mfma_f32_32x32x16_bf16 a[208:223], a[84:87], v[120:123], a[208:223]
    s_waitcnt lgkmcnt(1)
    ds_read_b128 a[68:71], v3 offset:57344
    v_exp_f32 v68, v68
    v_fma_f32 v69, v69, s20, v22
    v_add_f32 v20, v20, v67
    v_cvt_pk_bf16_f32 v65, v66, v67
    v_mfma_f32_32x32x16_bf16 a[160:175], a[88:91], v[104:107], a[160:175]
    v_exp_f32 v69, v69
    v_fma_f32 v70, v70, s20, v22
    v_add_f32 v20, v20, v68
    v_mfma_f32_32x32x16_bf16 a[224:239], a[88:91], v[120:123], a[224:239]
    ds_read_b128 a[72:75], v4 offset:57344
    v_exp_f32 v70, v70
    v_fma_f32 v71, v71, s20, v22
    v_add_f32 v20, v20, v69
    v_cvt_pk_bf16_f32 v66, v68, v69
    v_mfma_f32_32x32x16_bf16 a[176:191], a[92:95], v[104:107], a[176:191]
    v_exp_f32 v71, v71
    v_fma_f32 v80, v80, s20, v23
    v_add_f32 v20, v20, v70
    v_mfma_f32_32x32x16_bf16 a[240:255], a[92:95], v[120:123], a[240:255]
    s_waitcnt lgkmcnt(1)
    ds_read_b128 a[76:79], v5 offset:57344
    v_exp_f32 v80, v80
    v_fma_f32 v81, v81, s20, v23
    v_add_f32 v20, v20, v71
    v_cvt_pk_bf16_f32 v67, v70, v71
    v_mfma_f32_32x32x16_bf16 v[96:111], a[64:67], a[0:3], 0
    v_exp_f32 v81, v81
    v_fma_f32 v82, v82, s20, v23
    v_add_f32 v21, v21, v80
    v_mfma_f32_32x32x16_bf16 v[112:127], a[64:67], a[32:35], 0
    s_waitcnt vmcnt(12)
    ds_read_b128 a[80:83], v6 offset:57344
    v_exp_f32 v82, v82
    v_fma_f32 v83, v83, s20, v23
    v_add_f32 v21, v21, v81
    v_cvt_pk_bf16_f32 v80, v80, v81
    v_mfma_f32_32x32x16_bf16 v[96:111], a[68:71], a[4:7], v[96:111]
    s_barrier
    v_exp_f32 v83, v83
    v_fma_f32 v84, v84, s20, v23
    v_add_f32 v21, v21, v82
    v_mfma_f32_32x32x16_bf16 v[112:127], a[68:71], a[36:39], v[112:127]
    s_waitcnt lgkmcnt(1)
    ds_read_b128 a[84:87], v7 offset:57344
    v_exp_f32 v84, v84
    v_fma_f32 v85, v85, s20, v23
    v_add_f32 v21, v21, v83
    v_cvt_pk_bf16_f32 v81, v82, v83
    v_mfma_f32_32x32x16_bf16 v[96:111], a[72:75], a[8:11], v[96:111]
    s_add_u32 m0, s22, 32768
    s_add_u32 s23, s22, 98304
    v_exp_f32 v85, v85
    v_fma_f32 v86, v86, s20, v23
    v_add_f32 v21, v21, v84
    v_mfma_f32_32x32x16_bf16 v[112:127], a[72:75], a[40:43], v[112:127]
    ds_read_b128 a[88:91], v8 offset:57344
    v_exp_f32 v86, v86
    v_fma_f32 v87, v87, s20, v23
    v_add_f32 v21, v21, v85
    v_cvt_pk_bf16_f32 v82, v84, v85
    v_mfma_f32_32x32x16_bf16 v[96:111], a[76:79], a[12:15], v[96:111]
    buffer_load_dwordx4 v14, s[8:11], s23 offen offset:0 lds
    v_exp_f32 v87, v87
    v_fma_f32 v72, v72, s20, v22
    v_add_f32 v21, v21, v86
    v_mfma_f32_32x32x16_bf16 v[112:127], a[76:79], a[44:47], v[112:127]
    s_waitcnt lgkmcnt(1)
    ds_read_b128 a[92:95], v9 offset:57344
    v_exp_f32 v72, v72
    v_fma_f32 v73, v73, s20, v22
    v_add_f32 v21, v21, v87
    v_cvt_pk_bf16_f32 v83, v86, v87
    v_mfma_f32_32x32x16_bf16 v[96:111], a[80:83], a[16:19], v[96:111]
    buffer_load_dwordx4 v15, s[8:11], s23 offen offset:1024 lds
    v_exp_f32 v73, v73
    v_fma_f32 v74, v74, s20, v22
    v_add_f32 v20, v20, v72
    v_mfma_f32_32x32x16_bf16 v[112:127], a[80:83], a[48:51], v[112:127]
    ds_read_b64_tr_b16 a[64:65], v10 offset:49152
    ds_read_b64_tr_b16 a[66:67], v10 offset:51200
    v_exp_f32 v74, v74
    v_fma_f32 v75, v75, s20, v22
    v_add_f32 v20, v20, v73
    v_cvt_pk_bf16_f32 v72, v72, v73
    v_mfma_f32_32x32x16_bf16 v[96:111], a[84:87], a[20:23], v[96:111]
    buffer_load_dwordx4 v16, s[8:11], s23 offen offset:2048 lds
    v_exp_f32 v75, v75
    v_fma_f32 v76, v76, s20, v22
    v_add_f32 v20, v20, v74
    v_mfma_f32_32x32x16_bf16 v[112:127], a[84:87], a[52:55], v[112:127]
    s_waitcnt lgkmcnt(2)
    ds_read_b64_tr_b16 a[68:69], v11 offset:49152
    ds_read_b64_tr_b16 a[70:71], v11 offset:51200
    v_exp_f32 v76, v76
    v_fma_f32 v77, v77, s20, v22
    v_add_f32 v20, v20, v75
    v_cvt_pk_bf16_f32 v73, v74, v75
    v_mfma_f32_32x32x16_bf16 v[96:111], a[88:91], a[24:27], v[96:111]
    buffer_load_dwordx4 v17, s[8:11], s23 offen offset:3072 lds
    v_exp_f32 v77, v77
    v_fma_f32 v78, v78, s20, v22
    v_add_f32 v20, v20, v76
    v_mfma_f32_32x32x16_bf16 v[112:127], a[88:91], a[56:59], v[112:127]
    ds_read_b64_tr_b16 a[72:73], v12 offset:49152
    ds_read_b64_tr_b16 a[74:75], v12 offset:51200
    v_exp_f32 v78, v78
    v_fma_f32 v79, v79, s20, v22
    v_add_f32 v20, v20, v77
    v_cvt_pk_bf16_f32 v74, v76, v77
    v_mfma_f32_32x32x16_bf16 v[96:111], a[92:95], a[28:31], v[96:111]
    v_exp_f32 v79, v79
    v_fma_f32 v88, v88, s20, v23
    v_add_f32 v20, v20, v78
    v_mfma_f32_32x32x16_bf16 v[112:127], a[92:95], a[60:63], v[112:127]
    s_waitcnt lgkmcnt(2)
    ds_read_b64_tr_b16 a[76:77], v13 offset:49152
    ds_read_b64_tr_b16 a[78:79], v13 offset:51200
    v_exp_f32 v88, v88
    v_fma_f32 v89, v89, s20, v23
    v_add_f32 v20, v20, v79
    v_cvt_pk_bf16_f32 v75, v78, v79
    v_mfma_f32_32x32x16_bf16 a[128:143], a[64:67], v[64:67], a[128:143]
    s_add_u32 m0, s24, 131072
    s_nop 0
    buffer_load_dwordx4 v14, s[4:7], s27 offen offset:0 lds
    v_exp_f32 v89, v89
    v_fma_f32 v90, v90, s20, v23
    v_add_f32 v21, v21, v88
    v_mfma_f32_32x32x16_bf16 a[192:207], a[64:67], v[80:83], a[192:207]
    buffer_load_dwordx4 v15, s[4:7], s27 offen offset:1024 lds
    ds_read_b64_tr_b16 a[80:81], v10 offset:53248
    v_exp_f32 v90, v90
    v_fma_f32 v91, v91, s20, v23
    v_add_f32 v21, v21, v89
    v_cvt_pk_bf16_f32 v88, v88, v89
    v_mfma_f32_32x32x16_bf16 a[144:159], a[68:71], v[64:67], a[144:159]
    buffer_load_dwordx4 v16, s[4:7], s27 offen offset:2048 lds
    ds_read_b64_tr_b16 a[82:83], v10 offset:55296
    v_exp_f32 v91, v91
    v_fma_f32 v92, v92, s20, v23
    v_add_f32 v21, v21, v90
    v_mfma_f32_32x32x16_bf16 a[208:223], a[68:71], v[80:83], a[208:223]
    s_waitcnt lgkmcnt(2)
    buffer_load_dwordx4 v17, s[4:7], s27 offen offset:3072 lds
    ds_read_b64_tr_b16 a[84:85], v11 offset:53248
    v_exp_f32 v92, v92
    v_fma_f32 v93, v93, s20, v23
    v_add_f32 v21, v21, v91
    v_cvt_pk_bf16_f32 v89, v90, v91
    v_mfma_f32_32x32x16_bf16 a[160:175], a[72:75], v[64:67], a[160:175]
    s_add_u32 m0, s24, 135168
    s_nop 0
    buffer_load_dwordx4 v14, s[4:7], s70 offen offset:0 lds
    v_exp_f32 v93, v93
    v_fma_f32 v94, v94, s20, v23
    v_add_f32 v21, v21, v92
    v_mfma_f32_32x32x16_bf16 a[224:239], a[72:75], v[80:83], a[224:239]
    buffer_load_dwordx4 v15, s[4:7], s70 offen offset:1024 lds
    ds_read_b64_tr_b16 a[86:87], v11 offset:55296
    v_exp_f32 v94, v94
    v_fma_f32 v95, v95, s20, v23
    v_add_f32 v21, v21, v93
    v_cvt_pk_bf16_f32 v90, v92, v93
    v_mfma_f32_32x32x16_bf16 a[176:191], a[76:79], v[64:67], a[176:191]
    buffer_load_dwordx4 v16, s[4:7], s70 offen offset:2048 lds
    ds_read_b64_tr_b16 a[88:89], v12 offset:53248
    v_exp_f32 v95, v95
    v_add_f32 v21, v21, v94
    v_add_f32 v21, v21, v95
    v_cvt_pk_bf16_f32 v91, v94, v95
    v_mfma_f32_32x32x16_bf16 a[240:255], a[76:79], v[80:83], a[240:255]
    s_waitcnt lgkmcnt(2)
    buffer_load_dwordx4 v17, s[4:7], s70 offen offset:3072 lds
    ds_read_b64_tr_b16 a[90:91], v12 offset:55296
    v_fma_f32 v96, v96, s20, v22
    v_exp_f32 v96, v96
    v_fma_f32 v97, v97, s20, v22
    v_mfma_f32_32x32x16_bf16 a[128:143], a[80:83], v[72:75], a[128:143]
    ds_read_b64_tr_b16 a[92:93], v13 offset:53248
    ds_read_b64_tr_b16 a[94:95], v13 offset:55296
    v_exp_f32 v97, v97
    v_fma_f32 v98, v98, s20, v22
    v_add_f32 v20, v20, v96
    v_mfma_f32_32x32x16_bf16 a[192:207], a[80:83], v[88:91], a[192:207]
    s_waitcnt lgkmcnt(3)
    ds_read_b128 a[64:67], v2 offset:0
    v_exp_f32 v98, v98
    v_fma_f32 v99, v99, s20, v22
    v_add_f32 v20, v20, v97
    v_cvt_pk_bf16_f32 v96, v96, v97
    v_mfma_f32_32x32x16_bf16 a[144:159], a[84:87], v[72:75], a[144:159]
    v_exp_f32 v99, v99
    v_fma_f32 v100, v100, s20, v22
    v_add_f32 v20, v20, v98
    v_mfma_f32_32x32x16_bf16 a[208:223], a[84:87], v[88:91], a[208:223]
    s_waitcnt lgkmcnt(1)
    ds_read_b128 a[68:71], v3 offset:0
    v_exp_f32 v100, v100
    v_fma_f32 v101, v101, s20, v22
    v_add_f32 v20, v20, v99
    v_cvt_pk_bf16_f32 v97, v98, v99
    v_mfma_f32_32x32x16_bf16 a[160:175], a[88:91], v[72:75], a[160:175]
    v_exp_f32 v101, v101
    v_fma_f32 v102, v102, s20, v22
    v_add_f32 v20, v20, v100
    v_mfma_f32_32x32x16_bf16 a[224:239], a[88:91], v[88:91], a[224:239]
    ds_read_b128 a[72:75], v4 offset:0
    v_exp_f32 v102, v102
    v_fma_f32 v103, v103, s20, v22
    v_add_f32 v20, v20, v101
    v_cvt_pk_bf16_f32 v98, v100, v101
    v_mfma_f32_32x32x16_bf16 a[176:191], a[92:95], v[72:75], a[176:191]
    v_exp_f32 v103, v103
    v_fma_f32 v112, v112, s20, v23
    v_add_f32 v20, v20, v102
    v_mfma_f32_32x32x16_bf16 a[240:255], a[92:95], v[88:91], a[240:255]
    s_waitcnt lgkmcnt(1)
    ds_read_b128 a[76:79], v5 offset:0
    v_exp_f32 v112, v112
    v_fma_f32 v113, v113, s20, v23
    v_add_f32 v20, v20, v103
    v_cvt_pk_bf16_f32 v99, v102, v103
    v_mfma_f32_32x32x16_bf16 v[64:79], a[64:67], a[0:3], 0
    v_exp_f32 v113, v113
    v_fma_f32 v114, v114, s20, v23
    v_add_f32 v21, v21, v112
    v_mfma_f32_32x32x16_bf16 v[80:95], a[64:67], a[32:35], 0
    ds_read_b128 a[80:83], v6 offset:0
    v_exp_f32 v114, v114
    v_fma_f32 v115, v115, s20, v23
    v_add_f32 v21, v21, v113
    v_cvt_pk_bf16_f32 v112, v112, v113
    v_mfma_f32_32x32x16_bf16 v[64:79], a[68:71], a[4:7], v[64:79]
    s_add_u32 m0, s22, 98304
    s_add_u32 s33, s22, 98304
    v_exp_f32 v115, v115
    v_fma_f32 v116, v116, s20, v23
    v_add_f32 v21, v21, v114
    v_mfma_f32_32x32x16_bf16 v[80:95], a[68:71], a[36:39], v[80:95]
    s_waitcnt lgkmcnt(1)
    ds_read_b128 a[84:87], v7 offset:0
    v_exp_f32 v116, v116
    v_fma_f32 v117, v117, s20, v23
    v_add_f32 v21, v21, v115
    v_cvt_pk_bf16_f32 v113, v114, v115
    v_mfma_f32_32x32x16_bf16 v[64:79], a[72:75], a[8:11], v[64:79]
    buffer_load_dwordx4 v18, s[12:15], s33 offen offset:0 lds
    v_exp_f32 v117, v117
    v_fma_f32 v118, v118, s20, v23
    v_add_f32 v21, v21, v116
    v_mfma_f32_32x32x16_bf16 v[80:95], a[72:75], a[40:43], v[80:95]
    ds_read_b128 a[88:91], v8 offset:0
    v_exp_f32 v118, v118
    v_fma_f32 v119, v119, s20, v23
    v_add_f32 v21, v21, v117
    v_cvt_pk_bf16_f32 v114, v116, v117
    v_mfma_f32_32x32x16_bf16 v[64:79], a[76:79], a[12:15], v[64:79]
    buffer_load_dwordx4 v18, s[12:15], s33 offen offset:1024 lds
    v_exp_f32 v119, v119
    v_fma_f32 v104, v104, s20, v22
    v_add_f32 v21, v21, v118
    v_mfma_f32_32x32x16_bf16 v[80:95], a[76:79], a[44:47], v[80:95]
    s_waitcnt lgkmcnt(1)
    ds_read_b128 a[92:95], v9 offset:0
    v_exp_f32 v104, v104
    v_fma_f32 v105, v105, s20, v22
    v_add_f32 v21, v21, v119
    v_cvt_pk_bf16_f32 v115, v118, v119
    v_mfma_f32_32x32x16_bf16 v[64:79], a[80:83], a[16:19], v[64:79]
    buffer_load_dwordx4 v18, s[12:15], s33 offen offset:2048 lds
    v_exp_f32 v105, v105
    v_fma_f32 v106, v106, s20, v22
    v_add_f32 v20, v20, v104
    v_mfma_f32_32x32x16_bf16 v[80:95], a[80:83], a[48:51], v[80:95]
    ds_read_b64_tr_b16 a[64:65], v10 offset:57344
    ds_read_b64_tr_b16 a[66:67], v10 offset:59392
    v_exp_f32 v106, v106
    v_fma_f32 v107, v107, s20, v22
    v_add_f32 v20, v20, v105
    v_cvt_pk_bf16_f32 v104, v104, v105
    v_mfma_f32_32x32x16_bf16 v[64:79], a[84:87], a[20:23], v[64:79]
    buffer_load_dwordx4 v18, s[12:15], s33 offen offset:3072 lds
    v_exp_f32 v107, v107
    v_fma_f32 v108, v108, s20, v22
    v_add_f32 v20, v20, v106
    v_mfma_f32_32x32x16_bf16 v[80:95], a[84:87], a[52:55], v[80:95]
    s_waitcnt lgkmcnt(2)
    ds_read_b64_tr_b16 a[68:69], v11 offset:57344
    ds_read_b64_tr_b16 a[70:71], v11 offset:59392
    v_exp_f32 v108, v108
    v_fma_f32 v109, v109, s20, v22
    v_add_f32 v20, v20, v107
    v_cvt_pk_bf16_f32 v105, v106, v107
    v_mfma_f32_32x32x16_bf16 v[64:79], a[88:91], a[24:27], v[64:79]
    v_exp_f32 v109, v109
    v_fma_f32 v110, v110, s20, v22
    v_add_f32 v20, v20, v108
    v_mfma_f32_32x32x16_bf16 v[80:95], a[88:91], a[56:59], v[80:95]
    ds_read_b64_tr_b16 a[72:73], v12 offset:57344
    ds_read_b64_tr_b16 a[74:75], v12 offset:59392
    v_exp_f32 v110, v110
    v_fma_f32 v111, v111, s20, v22
    v_add_f32 v20, v20, v109
    v_cvt_pk_bf16_f32 v106, v108, v109
    v_mfma_f32_32x32x16_bf16 v[64:79], a[92:95], a[28:31], v[64:79]
    v_exp_f32 v111, v111
    v_fma_f32 v120, v120, s20, v23
    v_add_f32 v20, v20, v110
    v_mfma_f32_32x32x16_bf16 v[80:95], a[92:95], a[60:63], v[80:95]
    s_waitcnt lgkmcnt(2)
    ds_read_b64_tr_b16 a[76:77], v13 offset:57344
    ds_read_b64_tr_b16 a[78:79], v13 offset:59392
    v_exp_f32 v120, v120
    v_fma_f32 v121, v121, s20, v23
    v_add_f32 v20, v20, v111
    v_cvt_pk_bf16_f32 v107, v110, v111
    v_mfma_f32_32x32x16_bf16 a[128:143], a[64:67], v[96:99], a[128:143]
    v_exp_f32 v121, v121
    v_fma_f32 v122, v122, s20, v23
    v_add_f32 v21, v21, v120
    v_mfma_f32_32x32x16_bf16 a[192:207], a[64:67], v[112:115], a[192:207]
    ds_read_b64_tr_b16 a[80:81], v10 offset:61440
    ds_read_b64_tr_b16 a[82:83], v10 offset:63488
    v_exp_f32 v122, v122
    v_fma_f32 v123, v123, s20, v23
    v_add_f32 v21, v21, v121
    v_cvt_pk_bf16_f32 v120, v120, v121
    v_mfma_f32_32x32x16_bf16 a[144:159], a[68:71], v[96:99], a[144:159]
    v_exp_f32 v123, v123
    v_fma_f32 v124, v124, s20, v23
    v_add_f32 v21, v21, v122
    v_mfma_f32_32x32x16_bf16 a[208:223], a[68:71], v[112:115], a[208:223]
    s_waitcnt lgkmcnt(2)
    ds_read_b64_tr_b16 a[84:85], v11 offset:61440
    ds_read_b64_tr_b16 a[86:87], v11 offset:63488
    v_exp_f32 v124, v124
    v_fma_f32 v125, v125, s20, v23
    v_add_f32 v21, v21, v123
    v_cvt_pk_bf16_f32 v121, v122, v123
    v_mfma_f32_32x32x16_bf16 a[160:175], a[72:75], v[96:99], a[160:175]
    v_exp_f32 v125, v125
    v_fma_f32 v126, v126, s20, v23
    v_add_f32 v21, v21, v124
    v_mfma_f32_32x32x16_bf16 a[224:239], a[72:75], v[112:115], a[224:239]
    ds_read_b64_tr_b16 a[88:89], v12 offset:61440
    ds_read_b64_tr_b16 a[90:91], v12 offset:63488
    v_exp_f32 v126, v126
    v_fma_f32 v127, v127, s20, v23
    v_add_f32 v21, v21, v125
    v_cvt_pk_bf16_f32 v122, v124, v125
    v_mfma_f32_32x32x16_bf16 a[176:191], a[76:79], v[96:99], a[176:191]
    v_exp_f32 v127, v127
    v_add_f32 v21, v21, v126
    v_add_f32 v21, v21, v127
    v_cvt_pk_bf16_f32 v123, v126, v127
    v_mfma_f32_32x32x16_bf16 a[240:255], a[76:79], v[112:115], a[240:255]
    s_waitcnt lgkmcnt(2)
    ds_read_b64_tr_b16 a[92:93], v13 offset:61440
    ds_read_b64_tr_b16 a[94:95], v13 offset:63488
    v_fma_f32 v64, v64, s20, v22
    v_exp_f32 v64, v64
    v_fma_f32 v65, v65, s20, v22
    v_mfma_f32_32x32x16_bf16 a[128:143], a[80:83], v[104:107], a[128:143]
    v_exp_f32 v65, v65
    v_fma_f32 v66, v66, s20, v22
    v_add_f32 v20, v20, v64
    v_mfma_f32_32x32x16_bf16 a[192:207], a[80:83], v[120:123], a[192:207]
    ds_read_b128 a[64:67], v2 offset:8192
    v_exp_f32 v66, v66
    v_fma_f32 v67, v67, s20, v22
    v_add_f32 v20, v20, v65
    v_cvt_pk_bf16_f32 v64, v64, v65
    v_mfma_f32_32x32x16_bf16 a[144:159], a[84:87], v[104:107], a[144:159]
    v_exp_f32 v67, v67
    v_fma_f32 v68, v68, s20, v22
    v_add_f32 v20, v20, v66
    v_mfma_f32_32x32x16_bf16 a[208:223], a[84:87], v[120:123], a[208:223]
    s_waitcnt lgkmcnt(1)
    ds_read_b128 a[68:71], v3 offset:8192
    v_exp_f32 v68, v68
    v_fma_f32 v69, v69, s20, v22
    v_add_f32 v20, v20, v67
    v_cvt_pk_bf16_f32 v65, v66, v67
    v_mfma_f32_32x32x16_bf16 a[160:175], a[88:91], v[104:107], a[160:175]
    v_exp_f32 v69, v69
    v_fma_f32 v70, v70, s20, v22
    v_add_f32 v20, v20, v68
    v_mfma_f32_32x32x16_bf16 a[224:239], a[88:91], v[120:123], a[224:239]
    ds_read_b128 a[72:75], v4 offset:8192
    v_exp_f32 v70, v70
    v_fma_f32 v71, v71, s20, v22
    v_add_f32 v20, v20, v69
    v_cvt_pk_bf16_f32 v66, v68, v69
    v_mfma_f32_32x32x16_bf16 a[176:191], a[92:95], v[104:107], a[176:191]
    v_exp_f32 v71, v71
    v_fma_f32 v80, v80, s20, v23
    v_add_f32 v20, v20, v70
    v_mfma_f32_32x32x16_bf16 a[240:255], a[92:95], v[120:123], a[240:255]
    s_waitcnt lgkmcnt(1)
    ds_read_b128 a[76:79], v5 offset:8192
    v_exp_f32 v80, v80
    v_fma_f32 v81, v81, s20, v23
    v_add_f32 v20, v20, v71
    v_cvt_pk_bf16_f32 v67, v70, v71
    v_mfma_f32_32x32x16_bf16 v[96:111], a[64:67], a[0:3], 0
    v_exp_f32 v81, v81
    v_fma_f32 v82, v82, s20, v23
    v_add_f32 v21, v21, v80
    v_mfma_f32_32x32x16_bf16 v[112:127], a[64:67], a[32:35], 0
    s_waitcnt vmcnt(20)
    ds_read_b128 a[80:83], v6 offset:8192
    v_exp_f32 v82, v82
    v_fma_f32 v83, v83, s20, v23
    v_add_f32 v21, v21, v81
    v_cvt_pk_bf16_f32 v80, v80, v81
    v_mfma_f32_32x32x16_bf16 v[96:111], a[68:71], a[4:7], v[96:111]
    s_barrier
    v_exp_f32 v83, v83
    v_fma_f32 v84, v84, s20, v23
    v_add_f32 v21, v21, v82
    v_mfma_f32_32x32x16_bf16 v[112:127], a[68:71], a[36:39], v[112:127]
    s_waitcnt lgkmcnt(1)
    ds_read_b128 a[84:87], v7 offset:8192
    v_exp_f32 v84, v84
    v_fma_f32 v85, v85, s20, v23
    v_add_f32 v21, v21, v83
    v_cvt_pk_bf16_f32 v81, v82, v83
    v_mfma_f32_32x32x16_bf16 v[96:111], a[72:75], a[8:11], v[96:111]
    s_add_u32 m0, s22, 49152
    s_add_u32 s23, s22, 114688
    v_exp_f32 v85, v85
    v_fma_f32 v86, v86, s20, v23
    v_add_f32 v21, v21, v84
    v_mfma_f32_32x32x16_bf16 v[112:127], a[72:75], a[40:43], v[112:127]
    ds_read_b128 a[88:91], v8 offset:8192
    v_exp_f32 v86, v86
    v_fma_f32 v87, v87, s20, v23
    v_add_f32 v21, v21, v85
    v_cvt_pk_bf16_f32 v82, v84, v85
    v_mfma_f32_32x32x16_bf16 v[96:111], a[76:79], a[12:15], v[96:111]
    buffer_load_dwordx4 v14, s[8:11], s23 offen offset:0 lds
    v_exp_f32 v87, v87
    v_fma_f32 v72, v72, s20, v22
    v_add_f32 v21, v21, v86
    v_mfma_f32_32x32x16_bf16 v[112:127], a[76:79], a[44:47], v[112:127]
    s_waitcnt lgkmcnt(1)
    ds_read_b128 a[92:95], v9 offset:8192
    v_exp_f32 v72, v72
    v_fma_f32 v73, v73, s20, v22
    v_add_f32 v21, v21, v87
    v_cvt_pk_bf16_f32 v83, v86, v87
    v_mfma_f32_32x32x16_bf16 v[96:111], a[80:83], a[16:19], v[96:111]
    buffer_load_dwordx4 v15, s[8:11], s23 offen offset:1024 lds
    v_exp_f32 v73, v73
    v_fma_f32 v74, v74, s20, v22
    v_add_f32 v20, v20, v72
    v_mfma_f32_32x32x16_bf16 v[112:127], a[80:83], a[48:51], v[112:127]
    ds_read_b64_tr_b16 a[64:65], v10 offset:0
    ds_read_b64_tr_b16 a[66:67], v10 offset:2048
    v_exp_f32 v74, v74
    v_fma_f32 v75, v75, s20, v22
    v_add_f32 v20, v20, v73
    v_cvt_pk_bf16_f32 v72, v72, v73
    v_mfma_f32_32x32x16_bf16 v[96:111], a[84:87], a[20:23], v[96:111]
    buffer_load_dwordx4 v16, s[8:11], s23 offen offset:2048 lds
    v_exp_f32 v75, v75
    v_fma_f32 v76, v76, s20, v22
    v_add_f32 v20, v20, v74
    v_mfma_f32_32x32x16_bf16 v[112:127], a[84:87], a[52:55], v[112:127]
    s_waitcnt lgkmcnt(2)
    ds_read_b64_tr_b16 a[68:69], v11 offset:0
    ds_read_b64_tr_b16 a[70:71], v11 offset:2048
    v_exp_f32 v76, v76
    v_fma_f32 v77, v77, s20, v22
    v_add_f32 v20, v20, v75
    v_cvt_pk_bf16_f32 v73, v74, v75
    v_mfma_f32_32x32x16_bf16 v[96:111], a[88:91], a[24:27], v[96:111]
    buffer_load_dwordx4 v17, s[8:11], s23 offen offset:3072 lds
    v_exp_f32 v77, v77
    v_fma_f32 v78, v78, s20, v22
    v_add_f32 v20, v20, v76
    v_mfma_f32_32x32x16_bf16 v[112:127], a[88:91], a[56:59], v[112:127]
    ds_read_b64_tr_b16 a[72:73], v12 offset:0
    ds_read_b64_tr_b16 a[74:75], v12 offset:2048
    v_exp_f32 v78, v78
    v_fma_f32 v79, v79, s20, v22
    v_add_f32 v20, v20, v77
    v_cvt_pk_bf16_f32 v74, v76, v77
    v_mfma_f32_32x32x16_bf16 v[96:111], a[92:95], a[28:31], v[96:111]
    v_exp_f32 v79, v79
    v_fma_f32 v88, v88, s20, v23
    v_add_f32 v20, v20, v78
    v_mfma_f32_32x32x16_bf16 v[112:127], a[92:95], a[60:63], v[112:127]
    s_waitcnt lgkmcnt(2)
    ds_read_b64_tr_b16 a[76:77], v13 offset:0
    ds_read_b64_tr_b16 a[78:79], v13 offset:2048
    v_exp_f32 v88, v88
    v_fma_f32 v89, v89, s20, v23
    v_add_f32 v20, v20, v79
    v_cvt_pk_bf16_f32 v75, v78, v79
    v_mfma_f32_32x32x16_bf16 a[128:143], a[64:67], v[64:67], a[128:143]
    v_exp_f32 v89, v89
    v_fma_f32 v90, v90, s20, v23
    v_add_f32 v21, v21, v88
    v_mfma_f32_32x32x16_bf16 a[192:207], a[64:67], v[80:83], a[192:207]
    ds_read_b64_tr_b16 a[80:81], v10 offset:4096
    ds_read_b64_tr_b16 a[82:83], v10 offset:6144
    v_exp_f32 v90, v90
    v_fma_f32 v91, v91, s20, v23
    v_add_f32 v21, v21, v89
    v_cvt_pk_bf16_f32 v88, v88, v89
    v_mfma_f32_32x32x16_bf16 a[144:159], a[68:71], v[64:67], a[144:159]
    v_exp_f32 v91, v91
    v_fma_f32 v92, v92, s20, v23
    v_add_f32 v21, v21, v90
    v_mfma_f32_32x32x16_bf16 a[208:223], a[68:71], v[80:83], a[208:223]
    s_waitcnt lgkmcnt(2)
    ds_read_b64_tr_b16 a[84:85], v11 offset:4096
    ds_read_b64_tr_b16 a[86:87], v11 offset:6144
    v_exp_f32 v92, v92
    v_fma_f32 v93, v93, s20, v23
    v_add_f32 v21, v21, v91
    v_cvt_pk_bf16_f32 v89, v90, v91
    v_mfma_f32_32x32x16_bf16 a[160:175], a[72:75], v[64:67], a[160:175]
    v_exp_f32 v93, v93
    v_fma_f32 v94, v94, s20, v23
    v_add_f32 v21, v21, v92
    v_mfma_f32_32x32x16_bf16 a[224:239], a[72:75], v[80:83], a[224:239]
    ds_read_b64_tr_b16 a[88:89], v12 offset:4096
    ds_read_b64_tr_b16 a[90:91], v12 offset:6144
    v_exp_f32 v94, v94
    v_fma_f32 v95, v95, s20, v23
    v_add_f32 v21, v21, v93
    v_cvt_pk_bf16_f32 v90, v92, v93
    v_mfma_f32_32x32x16_bf16 a[176:191], a[76:79], v[64:67], a[176:191]
    v_exp_f32 v95, v95
    v_add_f32 v21, v21, v94
    v_add_f32 v21, v21, v95
    v_cvt_pk_bf16_f32 v91, v94, v95
    v_mfma_f32_32x32x16_bf16 a[240:255], a[76:79], v[80:83], a[240:255]
    s_waitcnt lgkmcnt(2)
    ds_read_b64_tr_b16 a[92:93], v13 offset:4096
    ds_read_b64_tr_b16 a[94:95], v13 offset:6144
    v_fma_f32 v96, v96, s20, v22
    v_exp_f32 v96, v96
    v_fma_f32 v97, v97, s20, v22
    v_mfma_f32_32x32x16_bf16 a[128:143], a[80:83], v[72:75], a[128:143]
    v_exp_f32 v97, v97
    v_fma_f32 v98, v98, s20, v22
    v_add_f32 v20, v20, v96
    v_mfma_f32_32x32x16_bf16 a[192:207], a[80:83], v[88:91], a[192:207]
    ds_read_b128 a[64:67], v2 offset:16384
    v_exp_f32 v98, v98
    v_fma_f32 v99, v99, s20, v22
    v_add_f32 v20, v20, v97
    v_cvt_pk_bf16_f32 v96, v96, v97
    v_mfma_f32_32x32x16_bf16 a[144:159], a[84:87], v[72:75], a[144:159]
    v_exp_f32 v99, v99
    v_fma_f32 v100, v100, s20, v22
    v_add_f32 v20, v20, v98
    v_mfma_f32_32x32x16_bf16 a[208:223], a[84:87], v[88:91], a[208:223]
    s_waitcnt lgkmcnt(1)
    ds_read_b128 a[68:71], v3 offset:16384
    v_exp_f32 v100, v100
    v_fma_f32 v101, v101, s20, v22
    v_add_f32 v20, v20, v99
    v_cvt_pk_bf16_f32 v97, v98, v99
    v_mfma_f32_32x32x16_bf16 a[160:175], a[88:91], v[72:75], a[160:175]
    v_exp_f32 v101, v101
    v_fma_f32 v102, v102, s20, v22
    v_add_f32 v20, v20, v100
    v_mfma_f32_32x32x16_bf16 a[224:239], a[88:91], v[88:91], a[224:239]
    ds_read_b128 a[72:75], v4 offset:16384
    v_exp_f32 v102, v102
    v_fma_f32 v103, v103, s20, v22
    v_add_f32 v20, v20, v101
    v_cvt_pk_bf16_f32 v98, v100, v101
    v_mfma_f32_32x32x16_bf16 a[176:191], a[92:95], v[72:75], a[176:191]
    v_exp_f32 v103, v103
    v_fma_f32 v112, v112, s20, v23
    v_add_f32 v20, v20, v102
    v_mfma_f32_32x32x16_bf16 a[240:255], a[92:95], v[88:91], a[240:255]
    s_waitcnt lgkmcnt(1)
    ds_read_b128 a[76:79], v5 offset:16384
    v_exp_f32 v112, v112
    v_fma_f32 v113, v113, s20, v23
    v_add_f32 v20, v20, v103
    v_cvt_pk_bf16_f32 v99, v102, v103
    v_mfma_f32_32x32x16_bf16 v[64:79], a[64:67], a[0:3], 0
    v_exp_f32 v113, v113
    v_fma_f32 v114, v114, s20, v23
    v_add_f32 v21, v21, v112
    v_mfma_f32_32x32x16_bf16 v[80:95], a[64:67], a[32:35], 0
    ds_read_b128 a[80:83], v6 offset:16384
    v_exp_f32 v114, v114
    v_fma_f32 v115, v115, s20, v23
    v_add_f32 v21, v21, v113
    v_cvt_pk_bf16_f32 v112, v112, v113
    v_mfma_f32_32x32x16_bf16 v[64:79], a[68:71], a[4:7], v[64:79]
    s_add_u32 m0, s22, 114688
    s_add_u32 s33, s22, 114688
    v_exp_f32 v115, v115
    v_fma_f32 v116, v116, s20, v23
    v_add_f32 v21, v21, v114
    v_mfma_f32_32x32x16_bf16 v[80:95], a[68:71], a[36:39], v[80:95]
    s_waitcnt lgkmcnt(1)
    ds_read_b128 a[84:87], v7 offset:16384
    v_exp_f32 v116, v116
    v_fma_f32 v117, v117, s20, v23
    v_add_f32 v21, v21, v115
    v_cvt_pk_bf16_f32 v113, v114, v115
    v_mfma_f32_32x32x16_bf16 v[64:79], a[72:75], a[8:11], v[64:79]
    buffer_load_dwordx4 v18, s[12:15], s33 offen offset:0 lds
    v_exp_f32 v117, v117
    v_fma_f32 v118, v118, s20, v23
    v_add_f32 v21, v21, v116
    v_mfma_f32_32x32x16_bf16 v[80:95], a[72:75], a[40:43], v[80:95]
    ds_read_b128 a[88:91], v8 offset:16384
    v_exp_f32 v118, v118
    v_fma_f32 v119, v119, s20, v23
    v_add_f32 v21, v21, v117
    v_cvt_pk_bf16_f32 v114, v116, v117
    v_mfma_f32_32x32x16_bf16 v[64:79], a[76:79], a[12:15], v[64:79]
    buffer_load_dwordx4 v18, s[12:15], s33 offen offset:1024 lds
    v_exp_f32 v119, v119
    v_fma_f32 v104, v104, s20, v22
    v_add_f32 v21, v21, v118
    v_mfma_f32_32x32x16_bf16 v[80:95], a[76:79], a[44:47], v[80:95]
    s_waitcnt lgkmcnt(1)
    ds_read_b128 a[92:95], v9 offset:16384
    v_exp_f32 v104, v104
    v_fma_f32 v105, v105, s20, v22
    v_add_f32 v21, v21, v119
    v_cvt_pk_bf16_f32 v115, v118, v119
    v_mfma_f32_32x32x16_bf16 v[64:79], a[80:83], a[16:19], v[64:79]
    buffer_load_dwordx4 v18, s[12:15], s33 offen offset:2048 lds
    v_exp_f32 v105, v105
    v_fma_f32 v106, v106, s20, v22
    v_add_f32 v20, v20, v104
    v_mfma_f32_32x32x16_bf16 v[80:95], a[80:83], a[48:51], v[80:95]
    ds_read_b64_tr_b16 a[64:65], v10 offset:8192
    ds_read_b64_tr_b16 a[66:67], v10 offset:10240
    v_exp_f32 v106, v106
    v_fma_f32 v107, v107, s20, v22
    v_add_f32 v20, v20, v105
    v_cvt_pk_bf16_f32 v104, v104, v105
    v_mfma_f32_32x32x16_bf16 v[64:79], a[84:87], a[20:23], v[64:79]
    buffer_load_dwordx4 v18, s[12:15], s33 offen offset:3072 lds
    v_exp_f32 v107, v107
    v_fma_f32 v108, v108, s20, v22
    v_add_f32 v20, v20, v106
    v_mfma_f32_32x32x16_bf16 v[80:95], a[84:87], a[52:55], v[80:95]
    s_waitcnt lgkmcnt(2)
    ds_read_b64_tr_b16 a[68:69], v11 offset:8192
    ds_read_b64_tr_b16 a[70:71], v11 offset:10240
    v_exp_f32 v108, v108
    v_fma_f32 v109, v109, s20, v22
    v_add_f32 v20, v20, v107
    v_cvt_pk_bf16_f32 v105, v106, v107
    v_mfma_f32_32x32x16_bf16 v[64:79], a[88:91], a[24:27], v[64:79]
    v_exp_f32 v109, v109
    v_fma_f32 v110, v110, s20, v22
    v_add_f32 v20, v20, v108
    v_mfma_f32_32x32x16_bf16 v[80:95], a[88:91], a[56:59], v[80:95]
    ds_read_b64_tr_b16 a[72:73], v12 offset:8192
    ds_read_b64_tr_b16 a[74:75], v12 offset:10240
    v_exp_f32 v110, v110
    v_fma_f32 v111, v111, s20, v22
    v_add_f32 v20, v20, v109
    v_cvt_pk_bf16_f32 v106, v108, v109
    v_mfma_f32_32x32x16_bf16 v[64:79], a[92:95], a[28:31], v[64:79]
    v_exp_f32 v111, v111
    v_fma_f32 v120, v120, s20, v23
    v_add_f32 v20, v20, v110
    v_mfma_f32_32x32x16_bf16 v[80:95], a[92:95], a[60:63], v[80:95]
    s_waitcnt lgkmcnt(2)
    ds_read_b64_tr_b16 a[76:77], v13 offset:8192
    ds_read_b64_tr_b16 a[78:79], v13 offset:10240
    v_exp_f32 v120, v120
    v_fma_f32 v121, v121, s20, v23
    v_add_f32 v20, v20, v111
    v_cvt_pk_bf16_f32 v107, v110, v111
    v_mfma_f32_32x32x16_bf16 a[128:143], a[64:67], v[96:99], a[128:143]
    s_waitcnt vmcnt(12)
    v_exp_f32 v121, v121
    v_fma_f32 v122, v122, s20, v23
    v_add_f32 v21, v21, v120
    v_mfma_f32_32x32x16_bf16 a[192:207], a[64:67], v[112:115], a[192:207]
    ds_read_b128 a[96:99], v48 offset:32768
    ds_read_b64_tr_b16 a[80:81], v10 offset:12288
    v_exp_f32 v122, v122
    v_fma_f32 v123, v123, s20, v23
    v_add_f32 v21, v21, v121
    v_cvt_pk_bf16_f32 v120, v120, v121
    v_mfma_f32_32x32x16_bf16 a[144:159], a[68:71], v[96:99], a[144:159]
    ds_read_b128 a[100:103], v49 offset:32768
    ds_read_b64_tr_b16 a[82:83], v10 offset:14336
    v_exp_f32 v123, v123
    v_fma_f32 v124, v124, s20, v23
    v_add_f32 v21, v21, v122
    v_mfma_f32_32x32x16_bf16 a[208:223], a[68:71], v[112:115], a[208:223]
    s_waitcnt lgkmcnt(4)
    ds_read_b128 a[104:107], v50 offset:32768
    ds_read_b64_tr_b16 a[84:85], v11 offset:12288
    v_exp_f32 v124, v124
    v_fma_f32 v125, v125, s20, v23
    v_add_f32 v21, v21, v123
    v_cvt_pk_bf16_f32 v121, v122, v123
    v_mfma_f32_32x32x16_bf16 a[160:175], a[72:75], v[96:99], a[160:175]
    ds_read_b128 a[108:111], v51 offset:32768
    ds_read_b64_tr_b16 a[86:87], v11 offset:14336
    v_exp_f32 v125, v125
    v_fma_f32 v126, v126, s20, v23
    v_add_f32 v21, v21, v124
    v_mfma_f32_32x32x16_bf16 a[224:239], a[72:75], v[112:115], a[224:239]
    ds_read_b128 a[112:115], v52 offset:32768
    ds_read_b64_tr_b16 a[88:89], v12 offset:12288
    v_exp_f32 v126, v126
    v_fma_f32 v127, v127, s20, v23
    v_add_f32 v21, v21, v125
    v_cvt_pk_bf16_f32 v122, v124, v125
    v_mfma_f32_32x32x16_bf16 a[176:191], a[76:79], v[96:99], a[176:191]
    ds_read_b128 a[116:119], v53 offset:32768
    ds_read_b64_tr_b16 a[90:91], v12 offset:14336
    v_exp_f32 v127, v127
    v_add_f32 v21, v21, v126
    v_add_f32 v21, v21, v127
    v_cvt_pk_bf16_f32 v123, v126, v127
    v_mfma_f32_32x32x16_bf16 a[240:255], a[76:79], v[112:115], a[240:255]
    s_waitcnt lgkmcnt(4)
    ds_read_b128 a[120:123], v54 offset:32768
    ds_read_b64_tr_b16 a[92:93], v13 offset:12288
    v_fma_f32 v64, v64, s20, v22
    v_exp_f32 v64, v64
    v_fma_f32 v65, v65, s20, v22
    v_mfma_f32_32x32x16_bf16 a[128:143], a[80:83], v[104:107], a[128:143]
    ds_read_b128 a[124:127], v55 offset:32768
    ds_read_b64_tr_b16 a[94:95], v13 offset:14336
    v_exp_f32 v65, v65
    v_fma_f32 v66, v66, s20, v22
    v_add_f32 v20, v20, v64
    v_mfma_f32_32x32x16_bf16 a[192:207], a[80:83], v[120:123], a[192:207]
    ds_read_b128 a[64:67], v2 offset:24576
    v_exp_f32 v66, v66
    v_fma_f32 v67, v67, s20, v22
    v_add_f32 v20, v20, v65
    v_cvt_pk_bf16_f32 v64, v64, v65
    v_mfma_f32_32x32x16_bf16 a[144:159], a[84:87], v[104:107], a[144:159]
    v_exp_f32 v67, v67
    v_fma_f32 v68, v68, s20, v22
    v_add_f32 v20, v20, v66
    v_mfma_f32_32x32x16_bf16 a[208:223], a[84:87], v[120:123], a[208:223]
    s_waitcnt lgkmcnt(1)
    ds_read_b128 a[68:71], v3 offset:24576
    v_exp_f32 v68, v68
    v_fma_f32 v69, v69, s20, v22
    v_add_f32 v20, v20, v67
    v_cvt_pk_bf16_f32 v65, v66, v67
    v_mfma_f32_32x32x16_bf16 a[160:175], a[88:91], v[104:107], a[160:175]
    v_exp_f32 v69, v69
    v_fma_f32 v70, v70, s20, v22
    v_add_f32 v20, v20, v68
    v_mfma_f32_32x32x16_bf16 a[224:239], a[88:91], v[120:123], a[224:239]
    ds_read_b128 a[72:75], v4 offset:24576
    v_exp_f32 v70, v70
    v_fma_f32 v71, v71, s20, v22
    v_add_f32 v20, v20, v69
    v_cvt_pk_bf16_f32 v66, v68, v69
    v_mfma_f32_32x32x16_bf16 a[176:191], a[92:95], v[104:107], a[176:191]
    v_exp_f32 v71, v71
    v_fma_f32 v80, v80, s20, v23
    v_add_f32 v20, v20, v70
    v_mfma_f32_32x32x16_bf16 a[240:255], a[92:95], v[120:123], a[240:255]
    s_waitcnt lgkmcnt(1)
    ds_read_b128 a[76:79], v5 offset:24576
    v_exp_f32 v80, v80
    v_fma_f32 v81, v81, s20, v23
    v_add_f32 v20, v20, v71
    v_cvt_pk_bf16_f32 v67, v70, v71
    v_mfma_f32_32x32x16_bf16 v[96:111], a[64:67], a[0:3], 0
    v_exp_f32 v81, v81
    v_fma_f32 v82, v82, s20, v23
    v_add_f32 v21, v21, v80
    v_mfma_f32_32x32x16_bf16 v[112:127], a[64:67], a[32:35], 0
    s_waitcnt vmcnt(20)
    ds_read_b128 a[80:83], v6 offset:24576
    v_exp_f32 v82, v82
    v_fma_f32 v83, v83, s20, v23
    v_add_f32 v21, v21, v81
    v_cvt_pk_bf16_f32 v80, v80, v81
    v_mfma_f32_32x32x16_bf16 v[96:111], a[68:71], a[4:7], v[96:111]
    s_barrier
    v_exp_f32 v83, v83
    v_fma_f32 v84, v84, s20, v23
    v_add_f32 v21, v21, v82
    v_mfma_f32_32x32x16_bf16 v[112:127], a[68:71], a[36:39], v[112:127]
    s_waitcnt lgkmcnt(1)
    ds_read_b128 a[84:87], v7 offset:24576
    v_exp_f32 v84, v84
    v_fma_f32 v85, v85, s20, v23
    v_add_f32 v21, v21, v83
    v_cvt_pk_bf16_f32 v81, v82, v83
    v_mfma_f32_32x32x16_bf16 v[96:111], a[72:75], a[8:11], v[96:111]
    s_add_u32 m0, s22, 0
    s_add_u32 s23, s22, 0
    v_exp_f32 v85, v85
    v_fma_f32 v86, v86, s20, v23
    v_add_f32 v21, v21, v84
    v_mfma_f32_32x32x16_bf16 v[112:127], a[72:75], a[40:43], v[112:127]
    ds_read_b128 a[88:91], v8 offset:24576
    v_exp_f32 v86, v86
    v_fma_f32 v87, v87, s20, v23
    v_add_f32 v21, v21, v85
    v_cvt_pk_bf16_f32 v82, v84, v85
    v_mfma_f32_32x32x16_bf16 v[96:111], a[76:79], a[12:15], v[96:111]
    buffer_load_dwordx4 v14, s[8:11], s23 offen offset:0 lds
    v_exp_f32 v87, v87
    v_fma_f32 v72, v72, s20, v22
    v_add_f32 v21, v21, v86
    v_mfma_f32_32x32x16_bf16 v[112:127], a[76:79], a[44:47], v[112:127]
    s_waitcnt lgkmcnt(1)
    ds_read_b128 a[92:95], v9 offset:24576
    v_exp_f32 v72, v72
    v_fma_f32 v73, v73, s20, v22
    v_add_f32 v21, v21, v87
    v_cvt_pk_bf16_f32 v83, v86, v87
    v_mfma_f32_32x32x16_bf16 v[96:111], a[80:83], a[16:19], v[96:111]
    buffer_load_dwordx4 v15, s[8:11], s23 offen offset:1024 lds
    v_exp_f32 v73, v73
    v_fma_f32 v74, v74, s20, v22
    v_add_f32 v20, v20, v72
    v_mfma_f32_32x32x16_bf16 v[112:127], a[80:83], a[48:51], v[112:127]
    ds_read_b64_tr_b16 a[64:65], v10 offset:16384
    ds_read_b64_tr_b16 a[66:67], v10 offset:18432
    v_exp_f32 v74, v74
    v_fma_f32 v75, v75, s20, v22
    v_add_f32 v20, v20, v73
    v_cvt_pk_bf16_f32 v72, v72, v73
    v_mfma_f32_32x32x16_bf16 v[96:111], a[84:87], a[20:23], v[96:111]
    buffer_load_dwordx4 v16, s[8:11], s23 offen offset:2048 lds
    v_exp_f32 v75, v75
    v_fma_f32 v76, v76, s20, v22
    v_add_f32 v20, v20, v74
    v_mfma_f32_32x32x16_bf16 v[112:127], a[84:87], a[52:55], v[112:127]
    s_waitcnt lgkmcnt(2)
    ds_read_b64_tr_b16 a[68:69], v11 offset:16384
    ds_read_b64_tr_b16 a[70:71], v11 offset:18432
    v_exp_f32 v76, v76
    v_fma_f32 v77, v77, s20, v22
    v_add_f32 v20, v20, v75
    v_cvt_pk_bf16_f32 v73, v74, v75
    v_mfma_f32_32x32x16_bf16 v[96:111], a[88:91], a[24:27], v[96:111]
    buffer_load_dwordx4 v17, s[8:11], s23 offen offset:3072 lds
    v_exp_f32 v77, v77
    v_fma_f32 v78, v78, s20, v22
    v_add_f32 v20, v20, v76
    v_mfma_f32_32x32x16_bf16 v[112:127], a[88:91], a[56:59], v[112:127]
    ds_read_b64_tr_b16 a[72:73], v12 offset:16384
    ds_read_b64_tr_b16 a[74:75], v12 offset:18432
    v_exp_f32 v78, v78
    v_fma_f32 v79, v79, s20, v22
    v_add_f32 v20, v20, v77
    v_cvt_pk_bf16_f32 v74, v76, v77
    v_mfma_f32_32x32x16_bf16 v[96:111], a[92:95], a[28:31], v[96:111]
    v_exp_f32 v79, v79
    v_fma_f32 v88, v88, s20, v23
    v_add_f32 v20, v20, v78
    v_mfma_f32_32x32x16_bf16 v[112:127], a[92:95], a[60:63], v[112:127]
    s_waitcnt lgkmcnt(2)
    ds_read_b64_tr_b16 a[76:77], v13 offset:16384
    ds_read_b64_tr_b16 a[78:79], v13 offset:18432
    v_exp_f32 v88, v88
    v_fma_f32 v89, v89, s20, v23
    v_add_f32 v20, v20, v79
    v_cvt_pk_bf16_f32 v75, v78, v79
    v_mfma_f32_32x32x16_bf16 a[128:143], a[64:67], v[64:67], a[128:143]
    s_add_u32 m0, s24, 131072
    s_nop 0
    buffer_load_dwordx4 v14, s[4:7], s28 offen offset:0 lds
    v_exp_f32 v89, v89
    v_fma_f32 v90, v90, s20, v23
    v_add_f32 v21, v21, v88
    v_mfma_f32_32x32x16_bf16 a[192:207], a[64:67], v[80:83], a[192:207]
    buffer_load_dwordx4 v15, s[4:7], s28 offen offset:1024 lds
    ds_read_b64_tr_b16 a[80:81], v10 offset:20480
    v_exp_f32 v90, v90
    v_fma_f32 v91, v91, s20, v23
    v_add_f32 v21, v21, v89
    v_cvt_pk_bf16_f32 v88, v88, v89
    v_mfma_f32_32x32x16_bf16 a[144:159], a[68:71], v[64:67], a[144:159]
    buffer_load_dwordx4 v16, s[4:7], s28 offen offset:2048 lds
    ds_read_b64_tr_b16 a[82:83], v10 offset:22528
    v_exp_f32 v91, v91
    v_fma_f32 v92, v92, s20, v23
    v_add_f32 v21, v21, v90
    v_mfma_f32_32x32x16_bf16 a[208:223], a[68:71], v[80:83], a[208:223]
    s_waitcnt lgkmcnt(2)
    buffer_load_dwordx4 v17, s[4:7], s28 offen offset:3072 lds
    ds_read_b64_tr_b16 a[84:85], v11 offset:20480
    v_exp_f32 v92, v92
    v_fma_f32 v93, v93, s20, v23
    v_add_f32 v21, v21, v91
    v_cvt_pk_bf16_f32 v89, v90, v91
    v_mfma_f32_32x32x16_bf16 a[160:175], a[72:75], v[64:67], a[160:175]
    s_add_u32 m0, s24, 135168
    s_nop 0
    buffer_load_dwordx4 v14, s[4:7], s71 offen offset:0 lds
    v_exp_f32 v93, v93
    v_fma_f32 v94, v94, s20, v23
    v_add_f32 v21, v21, v92
    v_mfma_f32_32x32x16_bf16 a[224:239], a[72:75], v[80:83], a[224:239]
    buffer_load_dwordx4 v15, s[4:7], s71 offen offset:1024 lds
    ds_read_b64_tr_b16 a[86:87], v11 offset:22528
    v_exp_f32 v94, v94
    v_fma_f32 v95, v95, s20, v23
    v_add_f32 v21, v21, v93
    v_cvt_pk_bf16_f32 v90, v92, v93
    v_mfma_f32_32x32x16_bf16 a[176:191], a[76:79], v[64:67], a[176:191]
    buffer_load_dwordx4 v16, s[4:7], s71 offen offset:2048 lds
    ds_read_b64_tr_b16 a[88:89], v12 offset:20480
    v_exp_f32 v95, v95
    v_add_f32 v21, v21, v94
    v_add_f32 v21, v21, v95
    v_cvt_pk_bf16_f32 v91, v94, v95
    v_mfma_f32_32x32x16_bf16 a[240:255], a[76:79], v[80:83], a[240:255]
    s_waitcnt lgkmcnt(2)
    buffer_load_dwordx4 v17, s[4:7], s71 offen offset:3072 lds
    ds_read_b64_tr_b16 a[90:91], v12 offset:22528
    v_fma_f32 v96, v96, s20, v22
    v_exp_f32 v96, v96
    v_fma_f32 v97, v97, s20, v22
    v_mfma_f32_32x32x16_bf16 a[128:143], a[80:83], v[72:75], a[128:143]
    ds_read_b64_tr_b16 a[92:93], v13 offset:20480
    ds_read_b64_tr_b16 a[94:95], v13 offset:22528
    v_exp_f32 v97, v97
    v_fma_f32 v98, v98, s20, v22
    v_add_f32 v20, v20, v96
    v_mfma_f32_32x32x16_bf16 a[192:207], a[80:83], v[88:91], a[192:207]
    s_waitcnt lgkmcnt(3)
    ds_read_b128 a[64:67], v2 offset:32768
    v_exp_f32 v98, v98
    v_fma_f32 v99, v99, s20, v22
    v_add_f32 v20, v20, v97
    v_cvt_pk_bf16_f32 v96, v96, v97
    v_mfma_f32_32x32x16_bf16 a[144:159], a[84:87], v[72:75], a[144:159]
    v_exp_f32 v99, v99
    v_fma_f32 v100, v100, s20, v22
    v_add_f32 v20, v20, v98
    v_mfma_f32_32x32x16_bf16 a[208:223], a[84:87], v[88:91], a[208:223]
    s_waitcnt lgkmcnt(1)
    ds_read_b128 a[68:71], v3 offset:32768
    v_exp_f32 v100, v100
    v_fma_f32 v101, v101, s20, v22
    v_add_f32 v20, v20, v99
    v_cvt_pk_bf16_f32 v97, v98, v99
    v_mfma_f32_32x32x16_bf16 a[160:175], a[88:91], v[72:75], a[160:175]
    v_exp_f32 v101, v101
    v_fma_f32 v102, v102, s20, v22
    v_add_f32 v20, v20, v100
    v_mfma_f32_32x32x16_bf16 a[224:239], a[88:91], v[88:91], a[224:239]
    ds_read_b128 a[72:75], v4 offset:32768
    v_exp_f32 v102, v102
    v_fma_f32 v103, v103, s20, v22
    v_add_f32 v20, v20, v101
    v_cvt_pk_bf16_f32 v98, v100, v101
    v_mfma_f32_32x32x16_bf16 a[176:191], a[92:95], v[72:75], a[176:191]
    v_exp_f32 v103, v103
    v_fma_f32 v112, v112, s20, v23
    v_add_f32 v20, v20, v102
    v_mfma_f32_32x32x16_bf16 a[240:255], a[92:95], v[88:91], a[240:255]
    s_waitcnt lgkmcnt(1)
    ds_read_b128 a[76:79], v5 offset:32768
    v_exp_f32 v112, v112
    v_fma_f32 v113, v113, s20, v23
    v_add_f32 v20, v20, v103
    v_cvt_pk_bf16_f32 v99, v102, v103
    v_mfma_f32_32x32x16_bf16 v[64:79], a[64:67], a[0:3], 0
    v_exp_f32 v113, v113
    v_fma_f32 v114, v114, s20, v23
    v_add_f32 v21, v21, v112
    v_mfma_f32_32x32x16_bf16 v[80:95], a[64:67], a[32:35], 0
    ds_read_b128 a[80:83], v6 offset:32768
    v_exp_f32 v114, v114
    v_fma_f32 v115, v115, s20, v23
    v_add_f32 v21, v21, v113
    v_cvt_pk_bf16_f32 v112, v112, v113
    v_mfma_f32_32x32x16_bf16 v[64:79], a[68:71], a[4:7], v[64:79]
    s_add_u32 m0, s22, 65536
    s_add_u32 s33, s22, 0
    v_exp_f32 v115, v115
    v_fma_f32 v116, v116, s20, v23
    v_add_f32 v21, v21, v114
    v_mfma_f32_32x32x16_bf16 v[80:95], a[68:71], a[36:39], v[80:95]
    s_waitcnt lgkmcnt(1)
    ds_read_b128 a[84:87], v7 offset:32768
    v_exp_f32 v116, v116
    v_fma_f32 v117, v117, s20, v23
    v_add_f32 v21, v21, v115
    v_cvt_pk_bf16_f32 v113, v114, v115
    v_mfma_f32_32x32x16_bf16 v[64:79], a[72:75], a[8:11], v[64:79]
    buffer_load_dwordx4 v18, s[12:15], s33 offen offset:0 lds
    v_exp_f32 v117, v117
    v_fma_f32 v118, v118, s20, v23
    v_add_f32 v21, v21, v116
    v_mfma_f32_32x32x16_bf16 v[80:95], a[72:75], a[40:43], v[80:95]
    ds_read_b128 a[88:91], v8 offset:32768
    v_exp_f32 v118, v118
    v_fma_f32 v119, v119, s20, v23
    v_add_f32 v21, v21, v117
    v_cvt_pk_bf16_f32 v114, v116, v117
    v_mfma_f32_32x32x16_bf16 v[64:79], a[76:79], a[12:15], v[64:79]
    buffer_load_dwordx4 v18, s[12:15], s33 offen offset:1024 lds
    v_exp_f32 v119, v119
    v_fma_f32 v104, v104, s20, v22
    v_add_f32 v21, v21, v118
    v_mfma_f32_32x32x16_bf16 v[80:95], a[76:79], a[44:47], v[80:95]
    s_waitcnt lgkmcnt(1)
    ds_read_b128 a[92:95], v9 offset:32768
    v_exp_f32 v104, v104
    v_fma_f32 v105, v105, s20, v22
    v_add_f32 v21, v21, v119
    v_cvt_pk_bf16_f32 v115, v118, v119
    v_mfma_f32_32x32x16_bf16 v[64:79], a[80:83], a[16:19], v[64:79]
    buffer_load_dwordx4 v18, s[12:15], s33 offen offset:2048 lds
    v_exp_f32 v105, v105
    v_fma_f32 v106, v106, s20, v22
    v_add_f32 v20, v20, v104
    v_mfma_f32_32x32x16_bf16 v[80:95], a[80:83], a[48:51], v[80:95]
    ds_read_b64_tr_b16 a[64:65], v10 offset:24576
    ds_read_b64_tr_b16 a[66:67], v10 offset:26624
    v_exp_f32 v106, v106
    v_fma_f32 v107, v107, s20, v22
    v_add_f32 v20, v20, v105
    v_cvt_pk_bf16_f32 v104, v104, v105
    v_mfma_f32_32x32x16_bf16 v[64:79], a[84:87], a[20:23], v[64:79]
    buffer_load_dwordx4 v18, s[12:15], s33 offen offset:3072 lds
    v_exp_f32 v107, v107
    v_fma_f32 v108, v108, s20, v22
    v_add_f32 v20, v20, v106
    v_mfma_f32_32x32x16_bf16 v[80:95], a[84:87], a[52:55], v[80:95]
    s_waitcnt lgkmcnt(2)
    ds_read_b64_tr_b16 a[68:69], v11 offset:24576
    ds_read_b64_tr_b16 a[70:71], v11 offset:26624
    v_exp_f32 v108, v108
    v_fma_f32 v109, v109, s20, v22
    v_add_f32 v20, v20, v107
    v_cvt_pk_bf16_f32 v105, v106, v107
    v_mfma_f32_32x32x16_bf16 v[64:79], a[88:91], a[24:27], v[64:79]
    v_exp_f32 v109, v109
    v_fma_f32 v110, v110, s20, v22
    v_add_f32 v20, v20, v108
    v_mfma_f32_32x32x16_bf16 v[80:95], a[88:91], a[56:59], v[80:95]
    ds_read_b64_tr_b16 a[72:73], v12 offset:24576
    ds_read_b64_tr_b16 a[74:75], v12 offset:26624
    v_exp_f32 v110, v110
    v_fma_f32 v111, v111, s20, v22
    v_add_f32 v20, v20, v109
    v_cvt_pk_bf16_f32 v106, v108, v109
    v_mfma_f32_32x32x16_bf16 v[64:79], a[92:95], a[28:31], v[64:79]
    v_exp_f32 v111, v111
    v_fma_f32 v120, v120, s20, v23
    v_add_f32 v20, v20, v110
    v_mfma_f32_32x32x16_bf16 v[80:95], a[92:95], a[60:63], v[80:95]
    s_waitcnt lgkmcnt(2)
    ds_read_b64_tr_b16 a[76:77], v13 offset:24576
    ds_read_b64_tr_b16 a[78:79], v13 offset:26624
    v_exp_f32 v120, v120
    v_fma_f32 v121, v121, s20, v23
    v_add_f32 v20, v20, v111
    v_cvt_pk_bf16_f32 v107, v110, v111
    v_mfma_f32_32x32x16_bf16 a[128:143], a[64:67], v[96:99], a[128:143]
    v_exp_f32 v121, v121
    v_fma_f32 v122, v122, s20, v23
    v_add_f32 v21, v21, v120
    v_mfma_f32_32x32x16_bf16 a[192:207], a[64:67], v[112:115], a[192:207]
    ds_read_b64_tr_b16 a[80:81], v10 offset:28672
    ds_read_b64_tr_b16 a[82:83], v10 offset:30720
    v_exp_f32 v122, v122
    v_fma_f32 v123, v123, s20, v23
    v_add_f32 v21, v21, v121
    v_cvt_pk_bf16_f32 v120, v120, v121
    v_mfma_f32_32x32x16_bf16 a[144:159], a[68:71], v[96:99], a[144:159]
    v_exp_f32 v123, v123
    v_fma_f32 v124, v124, s20, v23
    v_add_f32 v21, v21, v122
    v_mfma_f32_32x32x16_bf16 a[208:223], a[68:71], v[112:115], a[208:223]
    s_waitcnt lgkmcnt(2)
    ds_read_b64_tr_b16 a[84:85], v11 offset:28672
    ds_read_b64_tr_b16 a[86:87], v11 offset:30720
    v_exp_f32 v124, v124
    v_fma_f32 v125, v125, s20, v23
    v_add_f32 v21, v21, v123
    v_cvt_pk_bf16_f32 v121, v122, v123
    v_mfma_f32_32x32x16_bf16 a[160:175], a[72:75], v[96:99], a[160:175]
    v_exp_f32 v125, v125
    v_fma_f32 v126, v126, s20, v23
    v_add_f32 v21, v21, v124
    v_mfma_f32_32x32x16_bf16 a[224:239], a[72:75], v[112:115], a[224:239]
    ds_read_b64_tr_b16 a[88:89], v12 offset:28672
    ds_read_b64_tr_b16 a[90:91], v12 offset:30720
    v_exp_f32 v126, v126
    v_fma_f32 v127, v127, s20, v23
    v_add_f32 v21, v21, v125
    v_cvt_pk_bf16_f32 v122, v124, v125
    v_mfma_f32_32x32x16_bf16 a[176:191], a[76:79], v[96:99], a[176:191]
    v_exp_f32 v127, v127
    v_add_f32 v21, v21, v126
    v_add_f32 v21, v21, v127
    v_cvt_pk_bf16_f32 v123, v126, v127
    v_mfma_f32_32x32x16_bf16 a[240:255], a[76:79], v[112:115], a[240:255]
    s_waitcnt lgkmcnt(2)
    ds_read_b64_tr_b16 a[92:93], v13 offset:28672
    ds_read_b64_tr_b16 a[94:95], v13 offset:30720
    v_fma_f32 v64, v64, s20, v22
    v_exp_f32 v64, v64
    v_fma_f32 v65, v65, s20, v22
    v_mfma_f32_32x32x16_bf16 a[128:143], a[80:83], v[104:107], a[128:143]
    v_exp_f32 v65, v65
    v_fma_f32 v66, v66, s20, v22
    v_add_f32 v20, v20, v64
    v_mfma_f32_32x32x16_bf16 a[192:207], a[80:83], v[120:123], a[192:207]
    ds_read_b128 a[64:67], v2 offset:40960
    v_exp_f32 v66, v66
    v_fma_f32 v67, v67, s20, v22
    v_add_f32 v20, v20, v65
    v_cvt_pk_bf16_f32 v64, v64, v65
    v_mfma_f32_32x32x16_bf16 a[144:159], a[84:87], v[104:107], a[144:159]
    v_exp_f32 v67, v67
    v_fma_f32 v68, v68, s20, v22
    v_add_f32 v20, v20, v66
    v_mfma_f32_32x32x16_bf16 a[208:223], a[84:87], v[120:123], a[208:223]
    s_waitcnt lgkmcnt(1)
    ds_read_b128 a[68:71], v3 offset:40960
    v_exp_f32 v68, v68
    v_fma_f32 v69, v69, s20, v22
    v_add_f32 v20, v20, v67
    v_cvt_pk_bf16_f32 v65, v66, v67
    v_mfma_f32_32x32x16_bf16 a[160:175], a[88:91], v[104:107], a[160:175]
    v_exp_f32 v69, v69
    v_fma_f32 v70, v70, s20, v22
    v_add_f32 v20, v20, v68
    v_mfma_f32_32x32x16_bf16 a[224:239], a[88:91], v[120:123], a[224:239]
    ds_read_b128 a[72:75], v4 offset:40960
    v_exp_f32 v70, v70
    v_fma_f32 v71, v71, s20, v22
    v_add_f32 v20, v20, v69
    v_cvt_pk_bf16_f32 v66, v68, v69
    v_mfma_f32_32x32x16_bf16 a[176:191], a[92:95], v[104:107], a[176:191]
    v_exp_f32 v71, v71
    v_fma_f32 v80, v80, s20, v23
    v_add_f32 v20, v20, v70
    v_mfma_f32_32x32x16_bf16 a[240:255], a[92:95], v[120:123], a[240:255]
    s_waitcnt lgkmcnt(1)
    ds_read_b128 a[76:79], v5 offset:40960
    v_exp_f32 v80, v80
    v_fma_f32 v81, v81, s20, v23
    v_add_f32 v20, v20, v71
    v_cvt_pk_bf16_f32 v67, v70, v71
    v_mfma_f32_32x32x16_bf16 v[96:111], a[64:67], a[0:3], 0
    v_exp_f32 v81, v81
    v_fma_f32 v82, v82, s20, v23
    v_add_f32 v21, v21, v80
    v_mfma_f32_32x32x16_bf16 v[112:127], a[64:67], a[32:35], 0
    s_waitcnt vmcnt(20)
    ds_read_b128 a[80:83], v6 offset:40960
    v_exp_f32 v82, v82
    v_fma_f32 v83, v83, s20, v23
    v_add_f32 v21, v21, v81
    v_cvt_pk_bf16_f32 v80, v80, v81
    v_mfma_f32_32x32x16_bf16 v[96:111], a[68:71], a[4:7], v[96:111]
    s_barrier
    v_exp_f32 v83, v83
    v_fma_f32 v84, v84, s20, v23
    v_add_f32 v21, v21, v82
    v_mfma_f32_32x32x16_bf16 v[112:127], a[68:71], a[36:39], v[112:127]
    s_waitcnt lgkmcnt(1)
    ds_read_b128 a[84:87], v7 offset:40960
    v_exp_f32 v84, v84
    v_fma_f32 v85, v85, s20, v23
    v_add_f32 v21, v21, v83
    v_cvt_pk_bf16_f32 v81, v82, v83
    v_mfma_f32_32x32x16_bf16 v[96:111], a[72:75], a[8:11], v[96:111]
    s_add_u32 m0, s22, 16384
    s_add_u32 s23, s22, 16384
    v_exp_f32 v85, v85
    v_fma_f32 v86, v86, s20, v23
    v_add_f32 v21, v21, v84
    v_mfma_f32_32x32x16_bf16 v[112:127], a[72:75], a[40:43], v[112:127]
    ds_read_b128 a[88:91], v8 offset:40960
    v_exp_f32 v86, v86
    v_fma_f32 v87, v87, s20, v23
    v_add_f32 v21, v21, v85
    v_cvt_pk_bf16_f32 v82, v84, v85
    v_mfma_f32_32x32x16_bf16 v[96:111], a[76:79], a[12:15], v[96:111]
    buffer_load_dwordx4 v14, s[8:11], s23 offen offset:0 lds
    v_exp_f32 v87, v87
    v_fma_f32 v72, v72, s20, v22
    v_add_f32 v21, v21, v86
    v_mfma_f32_32x32x16_bf16 v[112:127], a[76:79], a[44:47], v[112:127]
    s_waitcnt lgkmcnt(1)
    ds_read_b128 a[92:95], v9 offset:40960
    v_exp_f32 v72, v72
    v_fma_f32 v73, v73, s20, v22
    v_add_f32 v21, v21, v87
    v_cvt_pk_bf16_f32 v83, v86, v87
    v_mfma_f32_32x32x16_bf16 v[96:111], a[80:83], a[16:19], v[96:111]
    buffer_load_dwordx4 v15, s[8:11], s23 offen offset:1024 lds
    v_exp_f32 v73, v73
    v_fma_f32 v74, v74, s20, v22
    v_add_f32 v20, v20, v72
    v_mfma_f32_32x32x16_bf16 v[112:127], a[80:83], a[48:51], v[112:127]
    ds_read_b64_tr_b16 a[64:65], v10 offset:32768
    ds_read_b64_tr_b16 a[66:67], v10 offset:34816
    v_exp_f32 v74, v74
    v_fma_f32 v75, v75, s20, v22
    v_add_f32 v20, v20, v73
    v_cvt_pk_bf16_f32 v72, v72, v73
    v_mfma_f32_32x32x16_bf16 v[96:111], a[84:87], a[20:23], v[96:111]
    buffer_load_dwordx4 v16, s[8:11], s23 offen offset:2048 lds
    v_exp_f32 v75, v75
    v_fma_f32 v76, v76, s20, v22
    v_add_f32 v20, v20, v74
    v_mfma_f32_32x32x16_bf16 v[112:127], a[84:87], a[52:55], v[112:127]
    s_waitcnt lgkmcnt(2)
    ds_read_b64_tr_b16 a[68:69], v11 offset:32768
    ds_read_b64_tr_b16 a[70:71], v11 offset:34816
    v_exp_f32 v76, v76
    v_fma_f32 v77, v77, s20, v22
    v_add_f32 v20, v20, v75
    v_cvt_pk_bf16_f32 v73, v74, v75
    v_mfma_f32_32x32x16_bf16 v[96:111], a[88:91], a[24:27], v[96:111]
    buffer_load_dwordx4 v17, s[8:11], s23 offen offset:3072 lds
    v_exp_f32 v77, v77
    v_fma_f32 v78, v78, s20, v22
    v_add_f32 v20, v20, v76
    v_mfma_f32_32x32x16_bf16 v[112:127], a[88:91], a[56:59], v[112:127]
    ds_read_b64_tr_b16 a[72:73], v12 offset:32768
    ds_read_b64_tr_b16 a[74:75], v12 offset:34816
    v_exp_f32 v78, v78
    v_fma_f32 v79, v79, s20, v22
    v_add_f32 v20, v20, v77
    v_cvt_pk_bf16_f32 v74, v76, v77
    v_mfma_f32_32x32x16_bf16 v[96:111], a[92:95], a[28:31], v[96:111]
    v_exp_f32 v79, v79
    v_fma_f32 v88, v88, s20, v23
    v_add_f32 v20, v20, v78
    v_mfma_f32_32x32x16_bf16 v[112:127], a[92:95], a[60:63], v[112:127]
    s_waitcnt lgkmcnt(2)
    ds_read_b64_tr_b16 a[76:77], v13 offset:32768
    ds_read_b64_tr_b16 a[78:79], v13 offset:34816
    v_exp_f32 v88, v88
    v_fma_f32 v89, v89, s20, v23
    v_add_f32 v20, v20, v79
    v_cvt_pk_bf16_f32 v75, v78, v79
    v_mfma_f32_32x32x16_bf16 a[128:143], a[64:67], v[64:67], a[128:143]
    v_exp_f32 v89, v89
    v_fma_f32 v90, v90, s20, v23
    v_add_f32 v21, v21, v88
    v_mfma_f32_32x32x16_bf16 a[192:207], a[64:67], v[80:83], a[192:207]
    ds_read_b64_tr_b16 a[80:81], v10 offset:36864
    ds_read_b64_tr_b16 a[82:83], v10 offset:38912
    v_exp_f32 v90, v90
    v_fma_f32 v91, v91, s20, v23
    v_add_f32 v21, v21, v89
    v_cvt_pk_bf16_f32 v88, v88, v89
    v_mfma_f32_32x32x16_bf16 a[144:159], a[68:71], v[64:67], a[144:159]
    v_exp_f32 v91, v91
    v_fma_f32 v92, v92, s20, v23
    v_add_f32 v21, v21, v90
    v_mfma_f32_32x32x16_bf16 a[208:223], a[68:71], v[80:83], a[208:223]
    s_waitcnt lgkmcnt(2)
    ds_read_b64_tr_b16 a[84:85], v11 offset:36864
    ds_read_b64_tr_b16 a[86:87], v11 offset:38912
    v_exp_f32 v92, v92
    v_fma_f32 v93, v93, s20, v23
    v_add_f32 v21, v21, v91
    v_cvt_pk_bf16_f32 v89, v90, v91
    v_mfma_f32_32x32x16_bf16 a[160:175], a[72:75], v[64:67], a[160:175]
    v_exp_f32 v93, v93
    v_fma_f32 v94, v94, s20, v23
    v_add_f32 v21, v21, v92
    v_mfma_f32_32x32x16_bf16 a[224:239], a[72:75], v[80:83], a[224:239]
    ds_read_b64_tr_b16 a[88:89], v12 offset:36864
    ds_read_b64_tr_b16 a[90:91], v12 offset:38912
    v_exp_f32 v94, v94
    v_fma_f32 v95, v95, s20, v23
    v_add_f32 v21, v21, v93
    v_cvt_pk_bf16_f32 v90, v92, v93
    v_mfma_f32_32x32x16_bf16 a[176:191], a[76:79], v[64:67], a[176:191]
    v_exp_f32 v95, v95
    v_add_f32 v21, v21, v94
    v_add_f32 v21, v21, v95
    v_cvt_pk_bf16_f32 v91, v94, v95
    v_mfma_f32_32x32x16_bf16 a[240:255], a[76:79], v[80:83], a[240:255]
    s_waitcnt lgkmcnt(2)
    ds_read_b64_tr_b16 a[92:93], v13 offset:36864
    ds_read_b64_tr_b16 a[94:95], v13 offset:38912
    v_fma_f32 v96, v96, s20, v22
    v_exp_f32 v96, v96
    v_fma_f32 v97, v97, s20, v22
    v_mfma_f32_32x32x16_bf16 a[128:143], a[80:83], v[72:75], a[128:143]
    v_exp_f32 v97, v97
    v_fma_f32 v98, v98, s20, v22
    v_add_f32 v20, v20, v96
    v_mfma_f32_32x32x16_bf16 a[192:207], a[80:83], v[88:91], a[192:207]
    ds_read_b128 a[64:67], v2 offset:49152
    v_exp_f32 v98, v98
    v_fma_f32 v99, v99, s20, v22
    v_add_f32 v20, v20, v97
    v_cvt_pk_bf16_f32 v96, v96, v97
    v_mfma_f32_32x32x16_bf16 a[144:159], a[84:87], v[72:75], a[144:159]
    v_exp_f32 v99, v99
    v_fma_f32 v100, v100, s20, v22
    v_add_f32 v20, v20, v98
    v_mfma_f32_32x32x16_bf16 a[208:223], a[84:87], v[88:91], a[208:223]
    s_waitcnt lgkmcnt(1)
    ds_read_b128 a[68:71], v3 offset:49152
    v_exp_f32 v100, v100
    v_fma_f32 v101, v101, s20, v22
    v_add_f32 v20, v20, v99
    v_cvt_pk_bf16_f32 v97, v98, v99
    v_mfma_f32_32x32x16_bf16 a[160:175], a[88:91], v[72:75], a[160:175]
    v_exp_f32 v101, v101
    v_fma_f32 v102, v102, s20, v22
    v_add_f32 v20, v20, v100
    v_mfma_f32_32x32x16_bf16 a[224:239], a[88:91], v[88:91], a[224:239]
    ds_read_b128 a[72:75], v4 offset:49152
    v_exp_f32 v102, v102
    v_fma_f32 v103, v103, s20, v22
    v_add_f32 v20, v20, v101
    v_cvt_pk_bf16_f32 v98, v100, v101
    v_mfma_f32_32x32x16_bf16 a[176:191], a[92:95], v[72:75], a[176:191]
    v_exp_f32 v103, v103
    v_fma_f32 v112, v112, s20, v23
    v_add_f32 v20, v20, v102
    v_mfma_f32_32x32x16_bf16 a[240:255], a[92:95], v[88:91], a[240:255]
    s_waitcnt lgkmcnt(1)
    ds_read_b128 a[76:79], v5 offset:49152
    v_exp_f32 v112, v112
    v_fma_f32 v113, v113, s20, v23
    v_add_f32 v20, v20, v103
    v_cvt_pk_bf16_f32 v99, v102, v103
    v_mfma_f32_32x32x16_bf16 v[64:79], a[64:67], a[0:3], 0
    v_exp_f32 v113, v113
    v_fma_f32 v114, v114, s20, v23
    v_add_f32 v21, v21, v112
    v_mfma_f32_32x32x16_bf16 v[80:95], a[64:67], a[32:35], 0
    ds_read_b128 a[80:83], v6 offset:49152
    v_exp_f32 v114, v114
    v_fma_f32 v115, v115, s20, v23
    v_add_f32 v21, v21, v113
    v_cvt_pk_bf16_f32 v112, v112, v113
    v_mfma_f32_32x32x16_bf16 v[64:79], a[68:71], a[4:7], v[64:79]
    s_add_u32 m0, s22, 81920
    s_add_u32 s33, s22, 16384
    v_exp_f32 v115, v115
    v_fma_f32 v116, v116, s20, v23
    v_add_f32 v21, v21, v114
    v_mfma_f32_32x32x16_bf16 v[80:95], a[68:71], a[36:39], v[80:95]
    s_waitcnt lgkmcnt(1)
    ds_read_b128 a[84:87], v7 offset:49152
    v_exp_f32 v116, v116
    v_fma_f32 v117, v117, s20, v23
    v_add_f32 v21, v21, v115
    v_cvt_pk_bf16_f32 v113, v114, v115
    v_mfma_f32_32x32x16_bf16 v[64:79], a[72:75], a[8:11], v[64:79]
    buffer_load_dwordx4 v18, s[12:15], s33 offen offset:0 lds
    v_exp_f32 v117, v117
    v_fma_f32 v118, v118, s20, v23
    v_add_f32 v21, v21, v116
    v_mfma_f32_32x32x16_bf16 v[80:95], a[72:75], a[40:43], v[80:95]
    ds_read_b128 a[88:91], v8 offset:49152
    v_exp_f32 v118, v118
    v_fma_f32 v119, v119, s20, v23
    v_add_f32 v21, v21, v117
    v_cvt_pk_bf16_f32 v114, v116, v117
    v_mfma_f32_32x32x16_bf16 v[64:79], a[76:79], a[12:15], v[64:79]
    buffer_load_dwordx4 v18, s[12:15], s33 offen offset:1024 lds
    v_exp_f32 v119, v119
    v_fma_f32 v104, v104, s20, v22
    v_add_f32 v21, v21, v118
    v_mfma_f32_32x32x16_bf16 v[80:95], a[76:79], a[44:47], v[80:95]
    s_waitcnt lgkmcnt(1)
    ds_read_b128 a[92:95], v9 offset:49152
    v_exp_f32 v104, v104
    v_fma_f32 v105, v105, s20, v22
    v_add_f32 v21, v21, v119
    v_cvt_pk_bf16_f32 v115, v118, v119
    v_mfma_f32_32x32x16_bf16 v[64:79], a[80:83], a[16:19], v[64:79]
    buffer_load_dwordx4 v18, s[12:15], s33 offen offset:2048 lds
    v_exp_f32 v105, v105
    v_fma_f32 v106, v106, s20, v22
    v_add_f32 v20, v20, v104
    v_mfma_f32_32x32x16_bf16 v[80:95], a[80:83], a[48:51], v[80:95]
    ds_read_b64_tr_b16 a[64:65], v10 offset:40960
    ds_read_b64_tr_b16 a[66:67], v10 offset:43008
    v_exp_f32 v106, v106
    v_fma_f32 v107, v107, s20, v22
    v_add_f32 v20, v20, v105
    v_cvt_pk_bf16_f32 v104, v104, v105
    v_mfma_f32_32x32x16_bf16 v[64:79], a[84:87], a[20:23], v[64:79]
    buffer_load_dwordx4 v18, s[12:15], s33 offen offset:3072 lds
    v_exp_f32 v107, v107
    v_fma_f32 v108, v108, s20, v22
    v_add_f32 v20, v20, v106
    v_mfma_f32_32x32x16_bf16 v[80:95], a[84:87], a[52:55], v[80:95]
    s_waitcnt lgkmcnt(2)
    ds_read_b64_tr_b16 a[68:69], v11 offset:40960
    ds_read_b64_tr_b16 a[70:71], v11 offset:43008
    v_exp_f32 v108, v108
    v_fma_f32 v109, v109, s20, v22
    v_add_f32 v20, v20, v107
    v_cvt_pk_bf16_f32 v105, v106, v107
    v_mfma_f32_32x32x16_bf16 v[64:79], a[88:91], a[24:27], v[64:79]
    v_exp_f32 v109, v109
    v_fma_f32 v110, v110, s20, v22
    v_add_f32 v20, v20, v108
    v_mfma_f32_32x32x16_bf16 v[80:95], a[88:91], a[56:59], v[80:95]
    ds_read_b64_tr_b16 a[72:73], v12 offset:40960
    ds_read_b64_tr_b16 a[74:75], v12 offset:43008
    v_exp_f32 v110, v110
    v_fma_f32 v111, v111, s20, v22
    v_add_f32 v20, v20, v109
    v_cvt_pk_bf16_f32 v106, v108, v109
    v_mfma_f32_32x32x16_bf16 v[64:79], a[92:95], a[28:31], v[64:79]
    v_exp_f32 v111, v111
    v_fma_f32 v120, v120, s20, v23
    v_add_f32 v20, v20, v110
    v_mfma_f32_32x32x16_bf16 v[80:95], a[92:95], a[60:63], v[80:95]
    s_waitcnt lgkmcnt(2)
    ds_read_b64_tr_b16 a[76:77], v13 offset:40960
    ds_read_b64_tr_b16 a[78:79], v13 offset:43008
    v_exp_f32 v120, v120
    v_fma_f32 v121, v121, s20, v23
    v_add_f32 v20, v20, v111
    v_cvt_pk_bf16_f32 v107, v110, v111
    v_mfma_f32_32x32x16_bf16 a[128:143], a[64:67], v[96:99], a[128:143]
    v_exp_f32 v121, v121
    v_fma_f32 v122, v122, s20, v23
    v_add_f32 v21, v21, v120
    v_mfma_f32_32x32x16_bf16 a[192:207], a[64:67], v[112:115], a[192:207]
    ds_read_b64_tr_b16 a[80:81], v10 offset:45056
    ds_read_b64_tr_b16 a[82:83], v10 offset:47104
    v_exp_f32 v122, v122
    v_fma_f32 v123, v123, s20, v23
    v_add_f32 v21, v21, v121
    v_cvt_pk_bf16_f32 v120, v120, v121
    v_mfma_f32_32x32x16_bf16 a[144:159], a[68:71], v[96:99], a[144:159]
    v_exp_f32 v123, v123
    v_fma_f32 v124, v124, s20, v23
    v_add_f32 v21, v21, v122
    v_mfma_f32_32x32x16_bf16 a[208:223], a[68:71], v[112:115], a[208:223]
    s_waitcnt lgkmcnt(2)
    ds_read_b64_tr_b16 a[84:85], v11 offset:45056
    ds_read_b64_tr_b16 a[86:87], v11 offset:47104
    v_exp_f32 v124, v124
    v_fma_f32 v125, v125, s20, v23
    v_add_f32 v21, v21, v123
    v_cvt_pk_bf16_f32 v121, v122, v123
    v_mfma_f32_32x32x16_bf16 a[160:175], a[72:75], v[96:99], a[160:175]
    v_exp_f32 v125, v125
    v_fma_f32 v126, v126, s20, v23
    v_add_f32 v21, v21, v124
    v_mfma_f32_32x32x16_bf16 a[224:239], a[72:75], v[112:115], a[224:239]
    ds_read_b64_tr_b16 a[88:89], v12 offset:45056
    ds_read_b64_tr_b16 a[90:91], v12 offset:47104
    v_exp_f32 v126, v126
    v_fma_f32 v127, v127, s20, v23
    v_add_f32 v21, v21, v125
    v_cvt_pk_bf16_f32 v122, v124, v125
    v_mfma_f32_32x32x16_bf16 a[176:191], a[76:79], v[96:99], a[176:191]
    v_exp_f32 v127, v127
    v_add_f32 v21, v21, v126
    v_add_f32 v21, v21, v127
    v_cvt_pk_bf16_f32 v123, v126, v127
    v_mfma_f32_32x32x16_bf16 a[240:255], a[76:79], v[112:115], a[240:255]
    s_waitcnt lgkmcnt(2)
    ds_read_b64_tr_b16 a[92:93], v13 offset:45056
    ds_read_b64_tr_b16 a[94:95], v13 offset:47104
    v_fma_f32 v64, v64, s20, v22
    v_exp_f32 v64, v64
    v_fma_f32 v65, v65, s20, v22
    v_mfma_f32_32x32x16_bf16 a[128:143], a[80:83], v[104:107], a[128:143]
    v_exp_f32 v65, v65
    v_fma_f32 v66, v66, s20, v22
    v_add_f32 v20, v20, v64
    v_mfma_f32_32x32x16_bf16 a[192:207], a[80:83], v[120:123], a[192:207]
    ds_read_b128 a[64:67], v2 offset:57344
    v_exp_f32 v66, v66
    v_fma_f32 v67, v67, s20, v22
    v_add_f32 v20, v20, v65
    v_cvt_pk_bf16_f32 v64, v64, v65
    v_mfma_f32_32x32x16_bf16 a[144:159], a[84:87], v[104:107], a[144:159]
    v_exp_f32 v67, v67
    v_fma_f32 v68, v68, s20, v22
    v_add_f32 v20, v20, v66
    v_mfma_f32_32x32x16_bf16 a[208:223], a[84:87], v[120:123], a[208:223]
    s_waitcnt lgkmcnt(1)
    ds_read_b128 a[68:71], v3 offset:57344
    v_exp_f32 v68, v68
    v_fma_f32 v69, v69, s20, v22
    v_add_f32 v20, v20, v67
    v_cvt_pk_bf16_f32 v65, v66, v67
    v_mfma_f32_32x32x16_bf16 a[160:175], a[88:91], v[104:107], a[160:175]
    v_exp_f32 v69, v69
    v_fma_f32 v70, v70, s20, v22
    v_add_f32 v20, v20, v68
    v_mfma_f32_32x32x16_bf16 a[224:239], a[88:91], v[120:123], a[224:239]
    ds_read_b128 a[72:75], v4 offset:57344
    v_exp_f32 v70, v70
    v_fma_f32 v71, v71, s20, v22
    v_add_f32 v20, v20, v69
    v_cvt_pk_bf16_f32 v66, v68, v69
    v_mfma_f32_32x32x16_bf16 a[176:191], a[92:95], v[104:107], a[176:191]
    v_exp_f32 v71, v71
    v_fma_f32 v80, v80, s20, v23
    v_add_f32 v20, v20, v70
    v_mfma_f32_32x32x16_bf16 a[240:255], a[92:95], v[120:123], a[240:255]
    s_waitcnt lgkmcnt(1)
    ds_read_b128 a[76:79], v5 offset:57344
    v_exp_f32 v80, v80
    v_fma_f32 v81, v81, s20, v23
    v_add_f32 v20, v20, v71
    v_cvt_pk_bf16_f32 v67, v70, v71
    v_mfma_f32_32x32x16_bf16 v[96:111], a[64:67], a[0:3], 0
    v_exp_f32 v81, v81
    v_fma_f32 v82, v82, s20, v23
    v_add_f32 v21, v21, v80
    v_mfma_f32_32x32x16_bf16 v[112:127], a[64:67], a[32:35], 0
    s_waitcnt vmcnt(20)
    s_waitcnt vmcnt(12)
    v_exp_f32 v82, v82
    v_fma_f32 v83, v83, s20, v23
    v_add_f32 v21, v21, v81
    v_cvt_pk_bf16_f32 v80, v80, v81
    v_mfma_f32_32x32x16_bf16 v[96:111], a[68:71], a[4:7], v[96:111]
    s_barrier
    ds_read_b128 a[80:83], v6 offset:57344
    v_exp_f32 v83, v83
    v_fma_f32 v84, v84, s20, v23
    v_add_f32 v21, v21, v82
    v_mfma_f32_32x32x16_bf16 v[112:127], a[68:71], a[36:39], v[112:127]
    s_waitcnt lgkmcnt(1)
    ds_read_b128 a[32:35], v48 offset:32768
    ds_read_b128 a[84:87], v7 offset:57344
    v_exp_f32 v84, v84
    v_fma_f32 v85, v85, s20, v23
    v_add_f32 v21, v21, v83
    v_cvt_pk_bf16_f32 v81, v82, v83
    v_mfma_f32_32x32x16_bf16 v[96:111], a[72:75], a[8:11], v[96:111]
    s_add_u32 m0, s22, 32768
    s_add_u32 s23, s22, 32768
    v_exp_f32 v85, v85
    v_fma_f32 v86, v86, s20, v23
    v_add_f32 v21, v21, v84
    v_mfma_f32_32x32x16_bf16 v[112:127], a[72:75], a[40:43], v[112:127]
    ds_read_b128 a[36:39], v49 offset:32768
    ds_read_b128 a[88:91], v8 offset:57344
    v_exp_f32 v86, v86
    v_fma_f32 v87, v87, s20, v23
    v_add_f32 v21, v21, v85
    v_cvt_pk_bf16_f32 v82, v84, v85
    v_mfma_f32_32x32x16_bf16 v[96:111], a[76:79], a[12:15], v[96:111]
    buffer_load_dwordx4 v14, s[8:11], s23 offen offset:0 lds
    v_exp_f32 v87, v87
    v_fma_f32 v72, v72, s20, v22
    v_add_f32 v21, v21, v86
    v_mfma_f32_32x32x16_bf16 v[112:127], a[76:79], a[44:47], v[112:127]
    s_waitcnt lgkmcnt(2)
    ds_read_b128 a[40:43], v50 offset:32768
    ds_read_b128 a[92:95], v9 offset:57344
    v_exp_f32 v72, v72
    v_fma_f32 v73, v73, s20, v22
    v_add_f32 v21, v21, v87
    v_cvt_pk_bf16_f32 v83, v86, v87
    v_mfma_f32_32x32x16_bf16 v[96:111], a[80:83], a[16:19], v[96:111]
    buffer_load_dwordx4 v15, s[8:11], s23 offen offset:1024 lds
    v_exp_f32 v73, v73
    v_fma_f32 v74, v74, s20, v22
    v_add_f32 v20, v20, v72
    v_mfma_f32_32x32x16_bf16 v[112:127], a[80:83], a[48:51], v[112:127]
    ds_read_b128 a[44:47], v51 offset:32768
    ds_read_b64_tr_b16 a[64:65], v10 offset:49152
    v_exp_f32 v74, v74
    v_fma_f32 v75, v75, s20, v22
    v_add_f32 v20, v20, v73
    v_cvt_pk_bf16_f32 v72, v72, v73
    v_mfma_f32_32x32x16_bf16 v[96:111], a[84:87], a[20:23], v[96:111]
    buffer_load_dwordx4 v16, s[8:11], s23 offen offset:2048 lds
    ds_read_b64_tr_b16 a[66:67], v10 offset:51200
    v_exp_f32 v75, v75
    v_fma_f32 v76, v76, s20, v22
    v_add_f32 v20, v20, v74
    v_mfma_f32_32x32x16_bf16 v[112:127], a[84:87], a[52:55], v[112:127]
    s_waitcnt lgkmcnt(3)
    ds_read_b128 a[48:51], v52 offset:32768
    ds_read_b64_tr_b16 a[68:69], v11 offset:49152
    v_exp_f32 v76, v76
    v_fma_f32 v77, v77, s20, v22
    v_add_f32 v20, v20, v75
    v_cvt_pk_bf16_f32 v73, v74, v75
    v_mfma_f32_32x32x16_bf16 v[96:111], a[88:91], a[24:27], v[96:111]
    buffer_load_dwordx4 v17, s[8:11], s23 offen offset:3072 lds
    ds_read_b64_tr_b16 a[70:71], v11 offset:51200
    v_exp_f32 v77, v77
    v_fma_f32 v78, v78, s20, v22
    v_add_f32 v20, v20, v76
    v_mfma_f32_32x32x16_bf16 v[112:127], a[88:91], a[56:59], v[112:127]
    ds_read_b128 a[52:55], v53 offset:32768
    ds_read_b64_tr_b16 a[72:73], v12 offset:49152
    v_exp_f32 v78, v78
    v_fma_f32 v79, v79, s20, v22
    v_add_f32 v20, v20, v77
    v_cvt_pk_bf16_f32 v74, v76, v77
    v_mfma_f32_32x32x16_bf16 v[96:111], a[92:95], a[28:31], v[96:111]
    ds_read_b64_tr_b16 a[74:75], v12 offset:51200
    v_exp_f32 v79, v79
    v_fma_f32 v88, v88, s20, v23
    v_add_f32 v20, v20, v78
    v_mfma_f32_32x32x16_bf16 v[112:127], a[92:95], a[60:63], v[112:127]
    s_waitcnt lgkmcnt(3)
    ds_read_b128 a[56:59], v54 offset:32768
    ds_read_b64_tr_b16 a[76:77], v13 offset:49152
    v_exp_f32 v88, v88
    v_fma_f32 v89, v89, s20, v23
    v_add_f32 v20, v20, v79
    v_cvt_pk_bf16_f32 v75, v78, v79
    v_mfma_f32_32x32x16_bf16 a[128:143], a[64:67], v[64:67], a[128:143]
    ds_read_b64_tr_b16 a[78:79], v13 offset:51200
    v_exp_f32 v89, v89
    v_fma_f32 v90, v90, s20, v23
    v_add_f32 v21, v21, v88
    v_mfma_f32_32x32x16_bf16 a[192:207], a[64:67], v[80:83], a[192:207]
    ds_read_b128 a[60:63], v55 offset:32768
    ds_read_b64_tr_b16 a[80:81], v10 offset:53248
    v_exp_f32 v90, v90
    v_fma_f32 v91, v91, s20, v23
    v_add_f32 v21, v21, v89
    v_cvt_pk_bf16_f32 v88, v88, v89
    v_mfma_f32_32x32x16_bf16 a[144:159], a[68:71], v[64:67], a[144:159]
    ds_read_b64_tr_b16 a[82:83], v10 offset:55296
    v_exp_f32 v91, v91
    v_fma_f32 v92, v92, s20, v23
    v_add_f32 v21, v21, v90
    v_mfma_f32_32x32x16_bf16 a[208:223], a[68:71], v[80:83], a[208:223]
    s_waitcnt lgkmcnt(3)
    ds_read_b64_tr_b16 a[84:85], v11 offset:53248
    ds_read_b64_tr_b16 a[86:87], v11 offset:55296
    v_exp_f32 v92, v92
    v_fma_f32 v93, v93, s20, v23
    v_add_f32 v21, v21, v91
    v_cvt_pk_bf16_f32 v89, v90, v91
    v_mfma_f32_32x32x16_bf16 a[160:175], a[72:75], v[64:67], a[160:175]
    v_exp_f32 v93, v93
    v_fma_f32 v94, v94, s20, v23
    v_add_f32 v21, v21, v92
    v_mfma_f32_32x32x16_bf16 a[224:239], a[72:75], v[80:83], a[224:239]
    ds_read_b64_tr_b16 a[88:89], v12 offset:53248
    ds_read_b64_tr_b16 a[90:91], v12 offset:55296
    v_exp_f32 v94, v94
    v_fma_f32 v95, v95, s20, v23
    v_add_f32 v21, v21, v93
    v_cvt_pk_bf16_f32 v90, v92, v93
    v_mfma_f32_32x32x16_bf16 a[176:191], a[76:79], v[64:67], a[176:191]
    v_exp_f32 v95, v95
    v_add_f32 v21, v21, v94
    v_add_f32 v21, v21, v95
    v_cvt_pk_bf16_f32 v91, v94, v95
    v_mfma_f32_32x32x16_bf16 a[240:255], a[76:79], v[80:83], a[240:255]
    s_waitcnt lgkmcnt(2)
    ds_read_b64_tr_b16 a[92:93], v13 offset:53248
    ds_read_b64_tr_b16 a[94:95], v13 offset:55296
    v_fma_f32 v96, v96, s20, v22
    v_exp_f32 v96, v96
    v_fma_f32 v97, v97, s20, v22
    v_mfma_f32_32x32x16_bf16 a[128:143], a[80:83], v[72:75], a[128:143]
    v_exp_f32 v97, v97
    v_fma_f32 v98, v98, s20, v22
    v_add_f32 v20, v20, v96
    v_mfma_f32_32x32x16_bf16 a[192:207], a[80:83], v[88:91], a[192:207]
    ds_read_b128 a[64:67], v2 offset:0
    v_exp_f32 v98, v98
    v_fma_f32 v99, v99, s20, v22
    v_add_f32 v20, v20, v97
    v_cvt_pk_bf16_f32 v96, v96, v97
    v_mfma_f32_32x32x16_bf16 a[144:159], a[84:87], v[72:75], a[144:159]
    v_exp_f32 v99, v99
    v_fma_f32 v100, v100, s20, v22
    v_add_f32 v20, v20, v98
    v_mfma_f32_32x32x16_bf16 a[208:223], a[84:87], v[88:91], a[208:223]
    s_waitcnt lgkmcnt(1)
    ds_read_b128 a[68:71], v3 offset:0
    v_exp_f32 v100, v100
    v_fma_f32 v101, v101, s20, v22
    v_add_f32 v20, v20, v99
    v_cvt_pk_bf16_f32 v97, v98, v99
    v_mfma_f32_32x32x16_bf16 a[160:175], a[88:91], v[72:75], a[160:175]
    v_exp_f32 v101, v101
    v_fma_f32 v102, v102, s20, v22
    v_add_f32 v20, v20, v100
    v_mfma_f32_32x32x16_bf16 a[224:239], a[88:91], v[88:91], a[224:239]
    ds_read_b128 a[72:75], v4 offset:0
    v_exp_f32 v102, v102
    v_fma_f32 v103, v103, s20, v22
    v_add_f32 v20, v20, v101
    v_cvt_pk_bf16_f32 v98, v100, v101
    v_mfma_f32_32x32x16_bf16 a[176:191], a[92:95], v[72:75], a[176:191]
    v_exp_f32 v103, v103
    v_fma_f32 v112, v112, s20, v23
    v_add_f32 v20, v20, v102
    v_mfma_f32_32x32x16_bf16 a[240:255], a[92:95], v[88:91], a[240:255]
    s_waitcnt lgkmcnt(1)
    ds_read_b128 a[76:79], v5 offset:0
    v_exp_f32 v112, v112
    v_fma_f32 v113, v113, s20, v23
    v_add_f32 v20, v20, v103
    v_cvt_pk_bf16_f32 v99, v102, v103
    v_mfma_f32_32x32x16_bf16 v[64:79], a[64:67], a[96:99], 0
    v_exp_f32 v113, v113
    v_fma_f32 v114, v114, s20, v23
    v_add_f32 v21, v21, v112
    v_mfma_f32_32x32x16_bf16 v[80:95], a[64:67], a[32:35], 0
    ds_read_b128 a[80:83], v6 offset:0
    v_exp_f32 v114, v114
    v_fma_f32 v115, v115, s20, v23
    v_add_f32 v21, v21, v113
    v_cvt_pk_bf16_f32 v112, v112, v113
    v_mfma_f32_32x32x16_bf16 v[64:79], a[68:71], a[100:103], v[64:79]
    s_add_u32 m0, s22, 98304
    s_add_u32 s33, s22, 32768
    v_exp_f32 v115, v115
    v_fma_f32 v116, v116, s20, v23
    v_add_f32 v21, v21, v114
    v_mfma_f32_32x32x16_bf16 v[80:95], a[68:71], a[36:39], v[80:95]
    s_waitcnt lgkmcnt(1)
    ds_read_b128 a[84:87], v7 offset:0
    v_exp_f32 v116, v116
    v_fma_f32 v117, v117, s20, v23
    v_add_f32 v21, v21, v115
    v_cvt_pk_bf16_f32 v113, v114, v115
    v_mfma_f32_32x32x16_bf16 v[64:79], a[72:75], a[104:107], v[64:79]
    buffer_load_dwordx4 v18, s[12:15], s33 offen offset:0 lds
    v_exp_f32 v117, v117
    v_fma_f32 v118, v118, s20, v23
    v_add_f32 v21, v21, v116
    v_mfma_f32_32x32x16_bf16 v[80:95], a[72:75], a[40:43], v[80:95]
    ds_read_b128 a[88:91], v8 offset:0
    v_exp_f32 v118, v118
    v_fma_f32 v119, v119, s20, v23
    v_add_f32 v21, v21, v117
    v_cvt_pk_bf16_f32 v114, v116, v117
    v_mfma_f32_32x32x16_bf16 v[64:79], a[76:79], a[108:111], v[64:79]
    buffer_load_dwordx4 v18, s[12:15], s33 offen offset:1024 lds
    v_exp_f32 v119, v119
    v_fma_f32 v104, v104, s20, v22
    v_add_f32 v21, v21, v118
    v_mfma_f32_32x32x16_bf16 v[80:95], a[76:79], a[44:47], v[80:95]
    s_waitcnt lgkmcnt(1)
    ds_read_b128 a[92:95], v9 offset:0
    v_exp_f32 v104, v104
    v_fma_f32 v105, v105, s20, v22
    v_add_f32 v21, v21, v119
    v_cvt_pk_bf16_f32 v115, v118, v119
    v_mfma_f32_32x32x16_bf16 v[64:79], a[80:83], a[112:115], v[64:79]
    buffer_load_dwordx4 v18, s[12:15], s33 offen offset:2048 lds
    v_exp_f32 v105, v105
    v_fma_f32 v106, v106, s20, v22
    v_add_f32 v20, v20, v104
    v_mfma_f32_32x32x16_bf16 v[80:95], a[80:83], a[48:51], v[80:95]
    ds_read_b64_tr_b16 a[64:65], v10 offset:57344
    ds_read_b64_tr_b16 a[66:67], v10 offset:59392
    v_exp_f32 v106, v106
    v_fma_f32 v107, v107, s20, v22
    v_add_f32 v20, v20, v105
    v_cvt_pk_bf16_f32 v104, v104, v105
    v_mfma_f32_32x32x16_bf16 v[64:79], a[84:87], a[116:119], v[64:79]
    buffer_load_dwordx4 v18, s[12:15], s33 offen offset:3072 lds
    v_exp_f32 v107, v107
    v_fma_f32 v108, v108, s20, v22
    v_add_f32 v20, v20, v106
    v_mfma_f32_32x32x16_bf16 v[80:95], a[84:87], a[52:55], v[80:95]
    s_waitcnt lgkmcnt(2)
    ds_read_b64_tr_b16 a[68:69], v11 offset:57344
    ds_read_b64_tr_b16 a[70:71], v11 offset:59392
    v_exp_f32 v108, v108
    v_fma_f32 v109, v109, s20, v22
    v_add_f32 v20, v20, v107
    v_cvt_pk_bf16_f32 v105, v106, v107
    v_mfma_f32_32x32x16_bf16 v[64:79], a[88:91], a[120:123], v[64:79]
    v_exp_f32 v109, v109
    v_fma_f32 v110, v110, s20, v22
    v_add_f32 v20, v20, v108
    v_mfma_f32_32x32x16_bf16 v[80:95], a[88:91], a[56:59], v[80:95]
    ds_read_b64_tr_b16 a[72:73], v12 offset:57344
    ds_read_b64_tr_b16 a[74:75], v12 offset:59392
    v_exp_f32 v110, v110
    v_fma_f32 v111, v111, s20, v22
    v_add_f32 v20, v20, v109
    v_cvt_pk_bf16_f32 v106, v108, v109
    v_mfma_f32_32x32x16_bf16 v[64:79], a[92:95], a[124:127], v[64:79]
    v_exp_f32 v111, v111
    v_fma_f32 v120, v120, s20, v23
    v_add_f32 v20, v20, v110
    v_mfma_f32_32x32x16_bf16 v[80:95], a[92:95], a[60:63], v[80:95]
    s_waitcnt lgkmcnt(2)
    ds_read_b64_tr_b16 a[76:77], v13 offset:57344
    ds_read_b64_tr_b16 a[78:79], v13 offset:59392
    v_exp_f32 v120, v120
    v_fma_f32 v121, v121, s20, v23
    v_add_f32 v20, v20, v111
    v_cvt_pk_bf16_f32 v107, v110, v111
    v_mfma_f32_32x32x16_bf16 a[128:143], a[64:67], v[96:99], a[128:143]
    s_add_u32 m0, s24, 131072
    s_nop 0
    buffer_load_dwordx4 v14, s[4:7], s29 offen offset:0 lds
    v_exp_f32 v121, v121
    v_fma_f32 v122, v122, s20, v23
    v_add_f32 v21, v21, v120
    v_mfma_f32_32x32x16_bf16 a[192:207], a[64:67], v[112:115], a[192:207]
    buffer_load_dwordx4 v15, s[4:7], s29 offen offset:1024 lds
    ds_read_b64_tr_b16 a[80:81], v10 offset:61440
    v_exp_f32 v122, v122
    v_fma_f32 v123, v123, s20, v23
    v_add_f32 v21, v21, v121
    v_cvt_pk_bf16_f32 v120, v120, v121
    v_mfma_f32_32x32x16_bf16 a[144:159], a[68:71], v[96:99], a[144:159]
    buffer_load_dwordx4 v16, s[4:7], s29 offen offset:2048 lds
    ds_read_b64_tr_b16 a[82:83], v10 offset:63488
    v_exp_f32 v123, v123
    v_fma_f32 v124, v124, s20, v23
    v_add_f32 v21, v21, v122
    v_mfma_f32_32x32x16_bf16 a[208:223], a[68:71], v[112:115], a[208:223]
    s_waitcnt lgkmcnt(2)
    buffer_load_dwordx4 v17, s[4:7], s29 offen offset:3072 lds
    ds_read_b64_tr_b16 a[84:85], v11 offset:61440
    v_exp_f32 v124, v124
    v_fma_f32 v125, v125, s20, v23
    v_add_f32 v21, v21, v123
    v_cvt_pk_bf16_f32 v121, v122, v123
    v_mfma_f32_32x32x16_bf16 a[160:175], a[72:75], v[96:99], a[160:175]
    s_add_u32 m0, s24, 135168
    s_nop 0
    buffer_load_dwordx4 v14, s[4:7], s59 offen offset:0 lds
    v_exp_f32 v125, v125
    v_fma_f32 v126, v126, s20, v23
    v_add_f32 v21, v21, v124
    v_mfma_f32_32x32x16_bf16 a[224:239], a[72:75], v[112:115], a[224:239]
    buffer_load_dwordx4 v15, s[4:7], s59 offen offset:1024 lds
    ds_read_b64_tr_b16 a[86:87], v11 offset:63488
    v_exp_f32 v126, v126
    v_fma_f32 v127, v127, s20, v23
    v_add_f32 v21, v21, v125
    v_cvt_pk_bf16_f32 v122, v124, v125
    v_mfma_f32_32x32x16_bf16 a[176:191], a[76:79], v[96:99], a[176:191]
    buffer_load_dwordx4 v16, s[4:7], s59 offen offset:2048 lds
    ds_read_b64_tr_b16 a[88:89], v12 offset:61440
    v_exp_f32 v127, v127
    v_add_f32 v21, v21, v126
    v_add_f32 v21, v21, v127
    v_cvt_pk_bf16_f32 v123, v126, v127
    v_mfma_f32_32x32x16_bf16 a[240:255], a[76:79], v[112:115], a[240:255]
    s_waitcnt lgkmcnt(2)
    buffer_load_dwordx4 v17, s[4:7], s59 offen offset:3072 lds
    ds_read_b64_tr_b16 a[90:91], v12 offset:63488
    v_max3_f32 v30, v64, v65, v66
    v_max3_f32 v30, v30, v67, v68
    v_max3_f32 v30, v30, v69, v70
    v_max3_f32 v30, v30, v71, v72
    v_mfma_f32_32x32x16_bf16 a[128:143], a[80:83], v[104:107], a[128:143]
    ds_read_b64_tr_b16 a[92:93], v13 offset:61440
    ds_read_b64_tr_b16 a[94:95], v13 offset:63488
    v_max3_f32 v30, v30, v73, v74
    v_max3_f32 v30, v30, v75, v76
    v_max3_f32 v30, v30, v77, v78
    v_max_f32 v30, v30, v79
    v_mov_b32 v46, v30
    v_mfma_f32_32x32x16_bf16 a[192:207], a[80:83], v[120:123], a[192:207]
    s_waitcnt lgkmcnt(3)
    ds_read_b128 a[64:67], v2 offset:8192
    s_nop 1
    v_permlane32_swap_b32 v30, v46
    v_max_f32 v30, v30, v46
    v_mul_f32 v22, s32, v30
    v_max3_f32 v31, v80, v81, v82
    v_mfma_f32_32x32x16_bf16 a[144:159], a[84:87], v[104:107], a[144:159]
    v_max3_f32 v31, v31, v83, v84
    v_max3_f32 v31, v31, v85, v86
    v_max3_f32 v31, v31, v87, v88
    v_max3_f32 v31, v31, v89, v90
    v_max3_f32 v31, v31, v91, v92
    v_max3_f32 v31, v31, v93, v94
    v_mfma_f32_32x32x16_bf16 a[208:223], a[84:87], v[120:123], a[208:223]
    s_waitcnt lgkmcnt(1)
    ds_read_b128 a[68:71], v3 offset:8192
    v_max_f32 v31, v31, v95
    v_mov_b32 v47, v31
    s_nop 1
    v_permlane32_swap_b32 v31, v47
    v_max_f32 v31, v31, v47
    v_mfma_f32_32x32x16_bf16 a[160:175], a[88:91], v[104:107], a[160:175]
    v_mul_f32 v23, s32, v31
    v_mov_b32 v28, v20
    s_nop 1
    v_permlane32_swap_b32 v28, v20
    v_add_f32 v28, v28, v20
    v_cmp_nlt_f32_e64 s[40:41], v28, s30
    v_mfma_f32_32x32x16_bf16 a[224:239], a[88:91], v[120:123], a[224:239]
    ds_read_b128 a[72:75], v4 offset:8192
    v_fma_f32 v64, v64, s20, v22
    v_exp_f32 v64, v64
    v_fma_f32 v65, v65, s20, v22
    v_rcp_f32 v24, v28
    v_mfma_f32_32x32x16_bf16 a[176:191], a[92:95], v[104:107], a[176:191]
    v_exp_f32 v65, v65
    v_fma_f32 v66, v66, s20, v22
    v_mov_b32 v44, v64
    v_mov_b32 v29, v21
    s_nop 1
    v_mfma_f32_32x32x16_bf16 a[240:255], a[92:95], v[120:123], a[240:255]
    s_waitcnt lgkmcnt(1)
    ds_read_b128 a[76:79], v5 offset:8192
    v_exp_f32 v66, v66
    v_fma_f32 v67, v67, s20, v22
    v_add_f32 v44, v44, v65
    v_cvt_pk_bf16_f32 v64, v64, v65
    v_mfma_f32_32x32x16_bf16 v[96:111], a[64:67], a[96:99], 0
    v_exp_f32 v67, v67
    v_fma_f32 v68, v68, s20, v22
    v_add_f32 v44, v44, v66
    v_permlane32_swap_b32 v29, v21
    v_add_f32 v29, v29, v21
    v_mfma_f32_32x32x16_bf16 v[112:127], a[64:67], a[32:35], 0
    s_waitcnt vmcnt(20)
    ds_read_b128 a[80:83], v6 offset:8192
    v_exp_f32 v68, v68
    v_fma_f32 v69, v69, s20, v22
    v_add_f32 v44, v44, v67
    v_cvt_pk_bf16_f32 v65, v66, v67
    v_mfma_f32_32x32x16_bf16 v[96:111], a[68:71], a[100:103], v[96:111]
    s_barrier
    v_exp_f32 v69, v69
    v_fma_f32 v70, v70, s20, v22
    v_add_f32 v44, v44, v68
    v_cmp_nlt_f32_e64 s[42:43], v29, s30
    v_mfma_f32_32x32x16_bf16 v[112:127], a[68:71], a[36:39], v[112:127]
    s_waitcnt lgkmcnt(1)
    ds_read_b128 a[84:87], v7 offset:8192
    v_exp_f32 v70, v70
    v_fma_f32 v71, v71, s20, v22
    v_add_f32 v44, v44, v69
    v_cvt_pk_bf16_f32 v66, v68, v69
    v_mfma_f32_32x32x16_bf16 v[96:111], a[72:75], a[104:107], v[96:111]
    s_add_u32 m0, s22, 49152
    s_add_u32 s23, s22, 49152
    v_exp_f32 v71, v71
    v_fma_f32 v80, v80, s20, v23
    v_add_f32 v44, v44, v70
    v_mfma_f32_32x32x16_bf16 v[112:127], a[72:75], a[40:43], v[112:127]
    ds_read_b128 a[88:91], v8 offset:8192
    v_exp_f32 v80, v80
    v_fma_f32 v81, v81, s20, v23
    v_add_f32 v44, v44, v71
    v_cvt_pk_bf16_f32 v67, v70, v71
    v_mfma_f32_32x32x16_bf16 v[96:111], a[76:79], a[108:111], v[96:111]
    buffer_load_dwordx4 v14, s[8:11], s23 offen offset:0 lds
    v_exp_f32 v81, v81
    v_fma_f32 v82, v82, s20, v23
    v_mov_b32 v45, v80
    v_rcp_f32 v25, v29
    v_mfma_f32_32x32x16_bf16 v[112:127], a[76:79], a[44:47], v[112:127]
    s_waitcnt lgkmcnt(1)
    ds_read_b128 a[92:95], v9 offset:8192
    v_exp_f32 v82, v82
    v_fma_f32 v83, v83, s20, v23
    v_add_f32 v45, v45, v81
    v_cvt_pk_bf16_f32 v80, v80, v81
    v_mfma_f32_32x32x16_bf16 v[96:111], a[80:83], a[112:115], v[96:111]
    buffer_load_dwordx4 v15, s[8:11], s23 offen offset:1024 lds
    v_exp_f32 v83, v83
    v_fma_f32 v84, v84, s20, v23
    v_add_f32 v45, v45, v82
    v_mfma_f32_32x32x16_bf16 v[112:127], a[80:83], a[48:51], v[112:127]
    ds_read_b64_tr_b16 a[64:65], v10 offset:0
    ds_read_b64_tr_b16 a[66:67], v10 offset:2048
    v_exp_f32 v84, v84
    v_fma_f32 v85, v85, s20, v23
    v_add_f32 v45, v45, v83
    v_cvt_pk_bf16_f32 v81, v82, v83
    v_mfma_f32_32x32x16_bf16 v[96:111], a[84:87], a[116:119], v[96:111]
    buffer_load_dwordx4 v16, s[8:11], s23 offen offset:2048 lds
    v_exp_f32 v85, v85
    v_fma_f32 v86, v86, s20, v23
    v_add_f32 v45, v45, v84
    v_mfma_f32_32x32x16_bf16 v[112:127], a[84:87], a[52:55], v[112:127]
    s_waitcnt lgkmcnt(2)
    ds_read_b64_tr_b16 a[68:69], v11 offset:0
    ds_read_b64_tr_b16 a[70:71], v11 offset:2048
    v_exp_f32 v86, v86
    v_fma_f32 v87, v87, s20, v23
    v_add_f32 v45, v45, v85
    v_cvt_pk_bf16_f32 v82, v84, v85
    v_mfma_f32_32x32x16_bf16 v[96:111], a[88:91], a[120:123], v[96:111]
    buffer_load_dwordx4 v17, s[8:11], s23 offen offset:3072 lds
    v_exp_f32 v87, v87
    v_fma_f32 v72, v72, s20, v22
    v_add_f32 v45, v45, v86
    v_mfma_f32_32x32x16_bf16 v[112:127], a[88:91], a[56:59], v[112:127]
    ds_read_b64_tr_b16 a[72:73], v12 offset:0
    ds_read_b64_tr_b16 a[74:75], v12 offset:2048
    v_exp_f32 v72, v72
    v_fma_f32 v73, v73, s20, v22
    v_add_f32 v45, v45, v87
    v_cvt_pk_bf16_f32 v83, v86, v87
    v_mfma_f32_32x32x16_bf16 v[96:111], a[92:95], a[124:127], v[96:111]
    v_exp_f32 v73, v73
    v_fma_f32 v74, v74, s20, v22
    v_add_f32 v44, v44, v72
    v_mfma_f32_32x32x16_bf16 v[112:127], a[92:95], a[60:63], v[112:127]
    s_waitcnt lgkmcnt(2)
    ds_read_b64_tr_b16 a[76:77], v13 offset:0
    ds_read_b64_tr_b16 a[78:79], v13 offset:2048
    v_exp_f32 v74, v74
    v_fma_f32 v75, v75, s20, v22
    v_add_f32 v44, v44, v73
    v_cvt_pk_bf16_f32 v72, v72, v73
    v_mfma_f32_32x32x16_bf16 v[128:143], a[64:67], v[64:67], 0
    v_exp_f32 v75, v75
    v_fma_f32 v76, v76, s20, v22
    v_add_f32 v44, v44, v74
    v_mfma_f32_32x32x16_bf16 v[192:207], a[64:67], v[80:83], 0
    ds_read_b64_tr_b16 a[80:81], v10 offset:4096
    ds_read_b64_tr_b16 a[82:83], v10 offset:6144
    v_exp_f32 v76, v76
    v_fma_f32 v77, v77, s20, v22
    v_add_f32 v44, v44, v75
    v_cvt_pk_bf16_f32 v73, v74, v75
    v_mfma_f32_32x32x16_bf16 v[144:159], a[68:71], v[64:67], 0
    v_exp_f32 v77, v77
    v_fma_f32 v78, v78, s20, v22
    v_add_f32 v44, v44, v76
    v_mfma_f32_32x32x16_bf16 v[208:223], a[68:71], v[80:83], 0
    s_waitcnt lgkmcnt(2)
    ds_read_b64_tr_b16 a[84:85], v11 offset:4096
    ds_read_b64_tr_b16 a[86:87], v11 offset:6144
    v_exp_f32 v78, v78
    v_fma_f32 v79, v79, s20, v22
    v_add_f32 v44, v44, v77
    v_cvt_pk_bf16_f32 v74, v76, v77
    v_mfma_f32_32x32x16_bf16 v[160:175], a[72:75], v[64:67], 0
    v_exp_f32 v79, v79
    v_fma_f32 v88, v88, s20, v23
    v_add_f32 v44, v44, v78
    v_mfma_f32_32x32x16_bf16 v[224:239], a[72:75], v[80:83], 0
    ds_read_b64_tr_b16 a[88:89], v12 offset:4096
    ds_read_b64_tr_b16 a[90:91], v12 offset:6144
    v_exp_f32 v88, v88
    v_fma_f32 v89, v89, s20, v23
    v_add_f32 v44, v44, v79
    v_cvt_pk_bf16_f32 v75, v78, v79
    v_mfma_f32_32x32x16_bf16 v[176:191], a[76:79], v[64:67], 0
    v_exp_f32 v89, v89
    v_fma_f32 v90, v90, s20, v23
    v_add_f32 v45, v45, v88
    v_exp_f32 v90, v90
    v_fma_f32 v91, v91, s20, v23
    v_add_f32 v45, v45, v89
    v_cvt_pk_bf16_f32 v88, v88, v89
    v_exp_f32 v91, v91
    v_fma_f32 v92, v92, s20, v23
    v_add_f32 v45, v45, v90
    v_exp_f32 v92, v92
    v_fma_f32 v93, v93, s20, v23
    v_add_f32 v45, v45, v91
    v_cvt_pk_bf16_f32 v89, v90, v91
    v_exp_f32 v93, v93
    v_fma_f32 v94, v94, s20, v23
    v_add_f32 v45, v45, v92
    v_exp_f32 v94, v94
    v_fma_f32 v95, v95, s20, v23
    v_add_f32 v45, v45, v93
    v_cvt_pk_bf16_f32 v90, v92, v93
    v_exp_f32 v95, v95
    v_add_f32 v45, v45, v94
    v_add_f32 v45, v45, v95
    v_cvt_pk_bf16_f32 v91, v94, v95
    v_mfma_f32_32x32x16_bf16 v[240:255], a[76:79], v[80:83], 0
    s_waitcnt lgkmcnt(2)
    ds_read_b64_tr_b16 a[92:93], v13 offset:4096
    ds_read_b64_tr_b16 a[94:95], v13 offset:6144
    v_fma_f32 v96, v96, s20, v22
    v_exp_f32 v96, v96
    v_fma_f32 v97, v97, s20, v22
    v_mfma_f32_32x32x16_bf16 v[128:143], a[80:83], v[72:75], v[128:143]
    v_exp_f32 v97, v97
    v_fma_f32 v98, v98, s20, v22
    v_add_f32 v44, v44, v96
    v_mfma_f32_32x32x16_bf16 v[192:207], a[80:83], v[88:91], v[192:207]
    ds_read_b128 a[64:67], v2 offset:16384
    v_exp_f32 v98, v98
    v_fma_f32 v99, v99, s20, v22
    v_add_f32 v44, v44, v97
    v_cvt_pk_bf16_f32 v96, v96, v97
    v_mfma_f32_32x32x16_bf16 v[144:159], a[84:87], v[72:75], v[144:159]
    v_exp_f32 v99, v99
    v_fma_f32 v100, v100, s20, v22
    v_add_f32 v44, v44, v98
    v_mfma_f32_32x32x16_bf16 v[208:223], a[84:87], v[88:91], v[208:223]
    s_waitcnt lgkmcnt(1)
    ds_read_b128 a[68:71], v3 offset:16384
    v_exp_f32 v100, v100
    v_fma_f32 v101, v101, s20, v22
    v_add_f32 v44, v44, v99
    v_cvt_pk_bf16_f32 v97, v98, v99
    v_mfma_f32_32x32x16_bf16 v[160:175], a[88:91], v[72:75], v[160:175]
    v_exp_f32 v101, v101
    v_fma_f32 v102, v102, s20, v22
    v_add_f32 v44, v44, v100
    v_mfma_f32_32x32x16_bf16 v[224:239], a[88:91], v[88:91], v[224:239]
    ds_read_b128 a[72:75], v4 offset:16384
    v_exp_f32 v102, v102
    v_fma_f32 v103, v103, s20, v22
    v_add_f32 v44, v44, v101
    v_cvt_pk_bf16_f32 v98, v100, v101
    v_mfma_f32_32x32x16_bf16 v[176:191], a[92:95], v[72:75], v[176:191]
    v_exp_f32 v103, v103
    v_fma_f32 v112, v112, s20, v23
    v_add_f32 v44, v44, v102
    v_mfma_f32_32x32x16_bf16 v[240:255], a[92:95], v[88:91], v[240:255]
    s_waitcnt lgkmcnt(1)
    ds_read_b128 a[76:79], v5 offset:16384
    v_exp_f32 v112, v112
    v_fma_f32 v113, v113, s20, v23
    v_add_f32 v44, v44, v103
    v_cvt_pk_bf16_f32 v99, v102, v103
    v_mfma_f32_32x32x16_bf16 v[64:79], a[64:67], a[96:99], 0
    v_exp_f32 v113, v113
    v_fma_f32 v114, v114, s20, v23
    v_add_f32 v45, v45, v112
    v_mfma_f32_32x32x16_bf16 v[80:95], a[64:67], a[32:35], 0
    ds_read_b128 a[80:83], v6 offset:16384
    v_exp_f32 v114, v114
    v_fma_f32 v115, v115, s20, v23
    v_add_f32 v45, v45, v113
    v_cvt_pk_bf16_f32 v112, v112, v113
    v_mfma_f32_32x32x16_bf16 v[64:79], a[68:71], a[100:103], v[64:79]
    s_add_u32 m0, s22, 114688
    s_add_u32 s33, s22, 49152
    v_exp_f32 v115, v115
    v_fma_f32 v116, v116, s20, v23
    v_add_f32 v45, v45, v114
    v_mfma_f32_32x32x16_bf16 v[80:95], a[68:71], a[36:39], v[80:95]
    s_waitcnt lgkmcnt(1)
    ds_read_b128 a[84:87], v7 offset:16384
    v_exp_f32 v116, v116
    v_fma_f32 v117, v117, s20, v23
    v_add_f32 v45, v45, v115
    v_cvt_pk_bf16_f32 v113, v114, v115
    v_mfma_f32_32x32x16_bf16 v[64:79], a[72:75], a[104:107], v[64:79]
    buffer_load_dwordx4 v18, s[12:15], s33 offen offset:0 lds
    s_waitcnt vmcnt(5)
    v_exp_f32 v117, v117
    v_fma_f32 v118, v118, s20, v23
    v_add_f32 v45, v45, v116
    v_mfma_f32_32x32x16_bf16 v[80:95], a[72:75], a[40:43], v[80:95]
    ds_read_b128 a[0:3], v48 offset:32768
    ds_read_b128 a[88:91], v8 offset:16384
    v_exp_f32 v118, v118
    v_fma_f32 v119, v119, s20, v23
    v_add_f32 v45, v45, v117
    v_cvt_pk_bf16_f32 v114, v116, v117
    v_mfma_f32_32x32x16_bf16 v[64:79], a[76:79], a[108:111], v[64:79]
    buffer_load_dwordx4 v18, s[12:15], s33 offen offset:1024 lds
    ds_read_b128 a[4:7], v49 offset:32768
    v_exp_f32 v119, v119
    v_fma_f32 v104, v104, s20, v22
    v_add_f32 v45, v45, v118
    v_mfma_f32_32x32x16_bf16 v[80:95], a[76:79], a[44:47], v[80:95]
    s_waitcnt lgkmcnt(3)
    ds_read_b128 a[8:11], v50 offset:32768
    ds_read_b128 a[92:95], v9 offset:16384
    v_exp_f32 v104, v104
    v_fma_f32 v105, v105, s20, v22
    v_add_f32 v45, v45, v119
    v_cvt_pk_bf16_f32 v115, v118, v119
    v_mfma_f32_32x32x16_bf16 v[64:79], a[80:83], a[112:115], v[64:79]
    buffer_load_dwordx4 v18, s[12:15], s33 offen offset:2048 lds
    ds_read_b128 a[12:15], v51 offset:32768
    v_exp_f32 v105, v105
    v_fma_f32 v106, v106, s20, v22
    v_add_f32 v44, v44, v104
    v_mfma_f32_32x32x16_bf16 v[80:95], a[80:83], a[48:51], v[80:95]
    ds_read_b128 a[16:19], v52 offset:32768
    ds_read_b64_tr_b16 a[64:65], v10 offset:8192
    v_exp_f32 v106, v106
    v_fma_f32 v107, v107, s20, v22
    v_add_f32 v44, v44, v105
    v_cvt_pk_bf16_f32 v104, v104, v105
    v_mfma_f32_32x32x16_bf16 v[64:79], a[84:87], a[116:119], v[64:79]
    buffer_load_dwordx4 v18, s[12:15], s33 offen offset:3072 lds
    ds_read_b128 a[20:23], v53 offset:32768
    v_exp_f32 v107, v107
    v_fma_f32 v108, v108, s20, v22
    v_add_f32 v44, v44, v106
    v_mfma_f32_32x32x16_bf16 v[80:95], a[84:87], a[52:55], v[80:95]
    s_waitcnt lgkmcnt(3)
    ds_read_b128 a[24:27], v54 offset:32768
    ds_read_b64_tr_b16 a[66:67], v10 offset:10240
    v_exp_f32 v108, v108
    v_fma_f32 v109, v109, s20, v22
    v_add_f32 v44, v44, v107
    v_cvt_pk_bf16_f32 v105, v106, v107
    v_mfma_f32_32x32x16_bf16 v[64:79], a[88:91], a[120:123], v[64:79]
    ds_read_b128 a[28:31], v55 offset:32768
    ds_read_b64_tr_b16 a[68:69], v11 offset:8192
    v_exp_f32 v109, v109
    v_fma_f32 v110, v110, s20, v22
    v_add_f32 v44, v44, v108
    v_mfma_f32_32x32x16_bf16 v[80:95], a[88:91], a[56:59], v[80:95]
    ds_read_b64_tr_b16 a[70:71], v11 offset:10240
    ds_read_b64_tr_b16 a[72:73], v12 offset:8192
    v_exp_f32 v110, v110
    v_fma_f32 v111, v111, s20, v22
    v_add_f32 v44, v44, v109
    v_cvt_pk_bf16_f32 v106, v108, v109
    v_mfma_f32_32x32x16_bf16 v[64:79], a[92:95], a[124:127], v[64:79]
    ds_read_b64_tr_b16 a[74:75], v12 offset:10240
    v_exp_f32 v111, v111
    v_fma_f32 v120, v120, s20, v23
    v_add_f32 v44, v44, v110
    v_mfma_f32_32x32x16_bf16 v[80:95], a[92:95], a[60:63], v[80:95]
    s_waitcnt lgkmcnt(3)
    ds_read_b64_tr_b16 a[76:77], v13 offset:8192
    ds_read_b64_tr_b16 a[78:79], v13 offset:10240
    v_exp_f32 v120, v120
    v_fma_f32 v121, v121, s20, v23
    v_add_f32 v44, v44, v111
    v_cvt_pk_bf16_f32 v107, v110, v111
    v_mfma_f32_32x32x16_bf16 v[128:143], a[64:67], v[96:99], v[128:143]
    v_exp_f32 v121, v121
    v_fma_f32 v122, v122, s20, v23
    v_add_f32 v45, v45, v120
    v_xor_b32 v26, 0, v19
    v_accvgpr_read_b32 v48, a128
    v_mfma_f32_32x32x16_bf16 v[192:207], a[64:67], v[112:115], v[192:207]
    s_waitcnt lgkmcnt(2)
    ds_read_b64_tr_b16 a[80:81], v10 offset:12288
    ds_read_b64_tr_b16 a[82:83], v10 offset:14336
    v_exp_f32 v122, v122
    v_fma_f32 v123, v123, s20, v23
    v_add_f32 v45, v45, v121
    v_cvt_pk_bf16_f32 v120, v120, v121
    v_mfma_f32_32x32x16_bf16 v[144:159], a[68:71], v[96:99], v[144:159]
    v_exp_f32 v123, v123
    v_fma_f32 v124, v124, s20, v23
    v_add_f32 v45, v45, v122
    v_accvgpr_read_b32 v49, a129
    v_accvgpr_read_b32 v50, a130
    v_mfma_f32_32x32x16_bf16 v[208:223], a[68:71], v[112:115], v[208:223]
    ds_read_b64_tr_b16 a[84:85], v11 offset:12288
    ds_read_b64_tr_b16 a[86:87], v11 offset:14336
    v_exp_f32 v124, v124
    v_fma_f32 v125, v125, s20, v23
    v_add_f32 v45, v45, v123
    v_cvt_pk_bf16_f32 v121, v122, v123
    v_mfma_f32_32x32x16_bf16 v[160:175], a[72:75], v[96:99], v[160:175]
    v_exp_f32 v125, v125
    v_fma_f32 v126, v126, s20, v23
    v_add_f32 v45, v45, v124
    v_accvgpr_read_b32 v51, a131
    v_accvgpr_read_b32 v52, a132
    v_mfma_f32_32x32x16_bf16 v[224:239], a[72:75], v[112:115], v[224:239]
    s_waitcnt lgkmcnt(2)
    ds_read_b64_tr_b16 a[88:89], v12 offset:12288
    ds_read_b64_tr_b16 a[90:91], v12 offset:14336
    v_exp_f32 v126, v126
    v_fma_f32 v127, v127, s20, v23
    v_add_f32 v45, v45, v125
    v_cvt_pk_bf16_f32 v122, v124, v125
    v_mfma_f32_32x32x16_bf16 v[176:191], a[76:79], v[96:99], v[176:191]
    v_exp_f32 v127, v127
    v_add_f32 v45, v45, v126
    v_add_f32 v45, v45, v127
    v_cvt_pk_bf16_f32 v123, v126, v127
    v_accvgpr_read_b32 v53, a133
    v_mfma_f32_32x32x16_bf16 v[240:255], a[76:79], v[112:115], v[240:255]
    ds_read_b64_tr_b16 a[92:93], v13 offset:12288
    ds_read_b64_tr_b16 a[94:95], v13 offset:14336
    v_fma_f32 v64, v64, s20, v22
    v_exp_f32 v64, v64
    v_fma_f32 v65, v65, s20, v22
    v_accvgpr_read_b32 v54, a134
    v_mfma_f32_32x32x16_bf16 v[128:143], a[80:83], v[104:107], v[128:143]
    v_exp_f32 v65, v65
    v_fma_f32 v66, v66, s20, v22
    v_add_f32 v44, v44, v64
    v_accvgpr_read_b32 v55, a135
    v_mul_f32 v48, v48, v24
    v_mfma_f32_32x32x16_bf16 v[192:207], a[80:83], v[120:123], v[192:207]
    s_waitcnt lgkmcnt(2)
    ds_read_b128 a[64:67], v2 offset:24576
    v_exp_f32 v66, v66
    v_fma_f32 v67, v67, s20, v22
    v_add_f32 v44, v44, v65
    v_cvt_pk_bf16_f32 v64, v64, v65
    v_mfma_f32_32x32x16_bf16 v[144:159], a[84:87], v[104:107], v[144:159]
    v_exp_f32 v67, v67
    v_fma_f32 v68, v68, s20, v22
    v_add_f32 v44, v44, v66
    v_mul_f32 v49, v49, v24
    v_mul_f32 v50, v50, v24
    v_mfma_f32_32x32x16_bf16 v[208:223], a[84:87], v[120:123], v[208:223]
    ds_read_b128 a[68:71], v3 offset:24576
    v_exp_f32 v68, v68
    v_fma_f32 v69, v69, s20, v22
    v_add_f32 v44, v44, v67
    v_cvt_pk_bf16_f32 v65, v66, v67
    v_mul_f32 v51, v51, v24
    v_mfma_f32_32x32x16_bf16 v[160:175], a[88:91], v[104:107], v[160:175]
    v_exp_f32 v69, v69
    v_fma_f32 v70, v70, s20, v22
    v_add_f32 v44, v44, v68
    v_mul_f32 v52, v52, v24
    v_mul_f32 v53, v53, v24
    v_mfma_f32_32x32x16_bf16 v[224:239], a[88:91], v[120:123], v[224:239]
    s_waitcnt lgkmcnt(1)
    ds_read_b128 a[72:75], v4 offset:24576
    v_exp_f32 v70, v70
    v_fma_f32 v71, v71, s20, v22
    v_add_f32 v44, v44, v69
    v_cvt_pk_bf16_f32 v66, v68, v69
    v_mfma_f32_32x32x16_bf16 v[176:191], a[92:95], v[104:107], v[176:191]
    v_exp_f32 v71, v71
    v_fma_f32 v80, v80, s20, v23
    v_add_f32 v44, v44, v70
    v_mul_f32 v54, v54, v24
    v_mul_f32 v55, v55, v24
    v_mfma_f32_32x32x16_bf16 v[240:255], a[92:95], v[120:123], v[240:255]
    ds_read_b128 a[76:79], v5 offset:24576
    v_exp_f32 v80, v80
    v_fma_f32 v81, v81, s20, v23
    v_add_f32 v44, v44, v71
    v_cvt_pk_bf16_f32 v67, v70, v71
    v_cvt_pk_bf16_f32 v48, v48, v49
    v_mfma_f32_32x32x16_bf16 v[96:111], a[64:67], a[96:99], 0
    v_exp_f32 v81, v81
    v_fma_f32 v82, v82, s20, v23
    v_add_f32 v45, v45, v80
    v_cvt_pk_bf16_f32 v49, v50, v51
    v_cvt_pk_bf16_f32 v50, v52, v53
    v_mfma_f32_32x32x16_bf16 v[112:127], a[64:67], a[32:35], 0
    s_waitcnt lgkmcnt(1)
    s_waitcnt vmcnt(20)
    ds_read_b128 a[80:83], v6 offset:24576
    v_exp_f32 v82, v82
    v_fma_f32 v83, v83, s20, v23
    v_add_f32 v45, v45, v81
    v_cvt_pk_bf16_f32 v80, v80, v81
    v_mfma_f32_32x32x16_bf16 v[96:111], a[68:71], a[100:103], v[96:111]
    s_barrier
    v_exp_f32 v83, v83
    v_fma_f32 v84, v84, s20, v23
    v_add_f32 v45, v45, v82
    v_cvt_pk_bf16_f32 v51, v54, v55
    s_nop 0
    v_mfma_f32_32x32x16_bf16 v[112:127], a[68:71], a[36:39], v[112:127]
    ds_read_b128 a[84:87], v7 offset:24576
    v_exp_f32 v84, v84
    v_fma_f32 v85, v85, s20, v23
    v_add_f32 v45, v45, v83
    v_cvt_pk_bf16_f32 v81, v82, v83
    v_permlane32_swap_b32 v48, v50
    v_mfma_f32_32x32x16_bf16 v[96:111], a[72:75], a[104:107], v[96:111]
    s_add_u32 m0, s22, 0
    s_add_u32 s23, s22, 65536
    v_exp_f32 v85, v85
    v_fma_f32 v86, v86, s20, v23
    v_add_f32 v45, v45, v84
    v_permlane32_swap_b32 v49, v51
    v_mfma_f32_32x32x16_bf16 v[112:127], a[72:75], a[40:43], v[112:127]
    s_waitcnt lgkmcnt(1)
    ds_read_b128 a[88:91], v8 offset:24576
    v_exp_f32 v86, v86
    v_fma_f32 v87, v87, s20, v23
    v_add_f32 v45, v45, v85
    v_cvt_pk_bf16_f32 v82, v84, v85
    v_mfma_f32_32x32x16_bf16 v[96:111], a[76:79], a[108:111], v[96:111]
    buffer_load_dwordx4 v14, s[8:11], s23 offen offset:0 lds
    v_exp_f32 v87, v87
    v_fma_f32 v72, v72, s20, v22
    v_add_f32 v45, v45, v86
    v_xor_b32 v27, 32, v19
    v_mfma_f32_32x32x16_bf16 v[112:127], a[76:79], a[44:47], v[112:127]
    ds_read_b128 a[92:95], v9 offset:24576
    ds_write_b128 v26, v[48:51]
    v_exp_f32 v72, v72
    v_fma_f32 v73, v73, s20, v22
    v_add_f32 v45, v45, v87
    v_cvt_pk_bf16_f32 v83, v86, v87
    v_accvgpr_read_b32 v56, a136
    v_mfma_f32_32x32x16_bf16 v[96:111], a[80:83], a[112:115], v[96:111]
    buffer_load_dwordx4 v15, s[8:11], s23 offen offset:1024 lds
    v_exp_f32 v73, v73
    v_fma_f32 v74, v74, s20, v22
    v_add_f32 v44, v44, v72
    v_accvgpr_read_b32 v57, a137
    v_accvgpr_read_b32 v58, a138
    v_mfma_f32_32x32x16_bf16 v[112:127], a[80:83], a[48:51], v[112:127]
    s_waitcnt lgkmcnt(2)
    ds_read_b64_tr_b16 a[64:65], v10 offset:16384
    ds_read_b64_tr_b16 a[66:67], v10 offset:18432
    v_exp_f32 v74, v74
    v_fma_f32 v75, v75, s20, v22
    v_add_f32 v44, v44, v73
    v_cvt_pk_bf16_f32 v72, v72, v73
    v_mfma_f32_32x32x16_bf16 v[96:111], a[84:87], a[116:119], v[96:111]
    buffer_load_dwordx4 v16, s[8:11], s23 offen offset:2048 lds
    v_exp_f32 v75, v75
    v_fma_f32 v76, v76, s20, v22
    v_add_f32 v44, v44, v74
    v_accvgpr_read_b32 v59, a139
    v_accvgpr_read_b32 v60, a140
    v_mfma_f32_32x32x16_bf16 v[112:127], a[84:87], a[52:55], v[112:127]
    ds_read_b64_tr_b16 a[68:69], v11 offset:16384
    ds_read_b64_tr_b16 a[70:71], v11 offset:18432
    v_exp_f32 v76, v76
    v_fma_f32 v77, v77, s20, v22
    v_add_f32 v44, v44, v75
    v_cvt_pk_bf16_f32 v73, v74, v75
    v_mfma_f32_32x32x16_bf16 v[96:111], a[88:91], a[120:123], v[96:111]
    buffer_load_dwordx4 v17, s[8:11], s23 offen offset:3072 lds
    v_exp_f32 v77, v77
    v_fma_f32 v78, v78, s20, v22
    v_add_f32 v44, v44, v76
    v_accvgpr_read_b32 v61, a141
    v_accvgpr_read_b32 v62, a142
    v_mfma_f32_32x32x16_bf16 v[112:127], a[88:91], a[56:59], v[112:127]
    s_waitcnt lgkmcnt(2)
    ds_read_b64_tr_b16 a[72:73], v12 offset:16384
    ds_read_b64_tr_b16 a[74:75], v12 offset:18432
    v_exp_f32 v78, v78
    v_fma_f32 v79, v79, s20, v22
    v_add_f32 v44, v44, v77
    v_cvt_pk_bf16_f32 v74, v76, v77
    v_mfma_f32_32x32x16_bf16 v[96:111], a[92:95], a[124:127], v[96:111]
    v_exp_f32 v79, v79
    v_fma_f32 v88, v88, s20, v23
    v_add_f32 v44, v44, v78
    v_accvgpr_read_b32 v63, a143
    v_mul_f32 v56, v56, v24
    v_mfma_f32_32x32x16_bf16 v[112:127], a[92:95], a[60:63], v[112:127]
    ds_read_b64_tr_b16 a[76:77], v13 offset:16384
    ds_read_b64_tr_b16 a[78:79], v13 offset:18432
    v_exp_f32 v88, v88
    v_fma_f32 v89, v89, s20, v23
    v_add_f32 v44, v44, v79
    v_cvt_pk_bf16_f32 v75, v78, v79
    v_mfma_f32_32x32x16_bf16 v[128:143], a[64:67], v[64:67], v[128:143]
    v_exp_f32 v89, v89
    v_fma_f32 v90, v90, s20, v23
    v_add_f32 v45, v45, v88
    v_mul_f32 v57, v57, v24
    v_mul_f32 v58, v58, v24
    v_mfma_f32_32x32x16_bf16 v[192:207], a[64:67], v[80:83], v[192:207]
    s_waitcnt lgkmcnt(2)
    ds_read_b64_tr_b16 a[80:81], v10 offset:20480
    ds_read_b64_tr_b16 a[82:83], v10 offset:22528
    v_exp_f32 v90, v90
    v_fma_f32 v91, v91, s20, v23
    v_add_f32 v45, v45, v89
    v_cvt_pk_bf16_f32 v88, v88, v89
    v_mfma_f32_32x32x16_bf16 v[144:159], a[68:71], v[64:67], v[144:159]
    v_exp_f32 v91, v91
    v_fma_f32 v92, v92, s20, v23
    v_add_f32 v45, v45, v90
    v_mul_f32 v59, v59, v24
    v_mul_f32 v60, v60, v24
    v_mfma_f32_32x32x16_bf16 v[208:223], a[68:71], v[80:83], v[208:223]
    ds_read_b64_tr_b16 a[84:85], v11 offset:20480
    ds_read_b64_tr_b16 a[86:87], v11 offset:22528
    v_exp_f32 v92, v92
    v_fma_f32 v93, v93, s20, v23
    v_add_f32 v45, v45, v91
    v_cvt_pk_bf16_f32 v89, v90, v91
    v_mfma_f32_32x32x16_bf16 v[160:175], a[72:75], v[64:67], v[160:175]
    v_exp_f32 v93, v93
    v_fma_f32 v94, v94, s20, v23
    v_add_f32 v45, v45, v92
    v_mul_f32 v61, v61, v24
    v_mul_f32 v62, v62, v24
    v_mfma_f32_32x32x16_bf16 v[224:239], a[72:75], v[80:83], v[224:239]
    s_waitcnt lgkmcnt(2)
    ds_read_b64_tr_b16 a[88:89], v12 offset:20480
    ds_read_b64_tr_b16 a[90:91], v12 offset:22528
    v_exp_f32 v94, v94
    v_fma_f32 v95, v95, s20, v23
    v_add_f32 v45, v45, v93
    v_cvt_pk_bf16_f32 v90, v92, v93
    v_mfma_f32_32x32x16_bf16 v[176:191], a[76:79], v[64:67], v[176:191]
    v_exp_f32 v95, v95
    v_add_f32 v45, v45, v94
    v_add_f32 v45, v45, v95
    v_cvt_pk_bf16_f32 v91, v94, v95
    v_mul_f32 v63, v63, v24
    v_mfma_f32_32x32x16_bf16 v[240:255], a[76:79], v[80:83], v[240:255]
    ds_read_b64_tr_b16 a[92:93], v13 offset:20480
    ds_read_b64_tr_b16 a[94:95], v13 offset:22528
    v_fma_f32 v96, v96, s20, v22
    v_exp_f32 v96, v96
    v_fma_f32 v97, v97, s20, v22
    v_cvt_pk_bf16_f32 v56, v56, v57
    v_mfma_f32_32x32x16_bf16 v[128:143], a[80:83], v[72:75], v[128:143]
    v_exp_f32 v97, v97
    v_fma_f32 v98, v98, s20, v22
    v_add_f32 v44, v44, v96
    v_cvt_pk_bf16_f32 v57, v58, v59
    v_cvt_pk_bf16_f32 v58, v60, v61
    v_mfma_f32_32x32x16_bf16 v[192:207], a[80:83], v[88:91], v[192:207]
    s_waitcnt lgkmcnt(2)
    ds_read_b128 a[64:67], v2 offset:32768
    v_exp_f32 v98, v98
    v_fma_f32 v99, v99, s20, v22
    v_add_f32 v44, v44, v97
    v_cvt_pk_bf16_f32 v96, v96, v97
    v_mfma_f32_32x32x16_bf16 v[144:159], a[84:87], v[72:75], v[144:159]
    v_exp_f32 v99, v99
    v_fma_f32 v100, v100, s20, v22
    v_add_f32 v44, v44, v98
    v_cvt_pk_bf16_f32 v59, v62, v63
    s_nop 0
    v_mfma_f32_32x32x16_bf16 v[208:223], a[84:87], v[88:91], v[208:223]
    ds_read_b128 a[68:71], v3 offset:32768
    v_exp_f32 v100, v100
    v_fma_f32 v101, v101, s20, v22
    v_add_f32 v44, v44, v99
    v_cvt_pk_bf16_f32 v97, v98, v99
    v_permlane32_swap_b32 v56, v58
    v_mfma_f32_32x32x16_bf16 v[160:175], a[88:91], v[72:75], v[160:175]
    v_exp_f32 v101, v101
    v_fma_f32 v102, v102, s20, v22
    v_add_f32 v44, v44, v100
    v_permlane32_swap_b32 v57, v59
    v_mfma_f32_32x32x16_bf16 v[224:239], a[88:91], v[88:91], v[224:239]
    s_waitcnt lgkmcnt(1)
    ds_read_b128 a[72:75], v4 offset:32768
    ds_write_b128 v27, v[56:59]
    v_exp_f32 v102, v102
    v_fma_f32 v103, v103, s20, v22
    v_add_f32 v44, v44, v101
    v_cvt_pk_bf16_f32 v98, v100, v101
    v_mfma_f32_32x32x16_bf16 v[176:191], a[92:95], v[72:75], v[176:191]
    v_exp_f32 v103, v103
    v_fma_f32 v112, v112, s20, v23
    v_add_f32 v44, v44, v102
    v_xor_b32 v26, 64, v19
    v_accvgpr_read_b32 v48, a144
    v_mfma_f32_32x32x16_bf16 v[240:255], a[92:95], v[88:91], v[240:255]
    ds_read_b128 a[76:79], v5 offset:32768
    v_exp_f32 v112, v112
    v_fma_f32 v113, v113, s20, v23
    v_add_f32 v44, v44, v103
    v_cvt_pk_bf16_f32 v99, v102, v103
    v_accvgpr_read_b32 v49, a145
    v_mfma_f32_32x32x16_bf16 v[64:79], a[64:67], a[96:99], 0
    v_exp_f32 v113, v113
    v_fma_f32 v114, v114, s20, v23
    v_add_f32 v45, v45, v112
    v_accvgpr_read_b32 v50, a146
    v_accvgpr_read_b32 v51, a147
    v_mfma_f32_32x32x16_bf16 v[80:95], a[64:67], a[32:35], 0
    s_waitcnt lgkmcnt(1)
    ds_read_b128 a[80:83], v6 offset:32768
    v_exp_f32 v114, v114
    v_fma_f32 v115, v115, s20, v23
    v_add_f32 v45, v45, v113
    v_cvt_pk_bf16_f32 v112, v112, v113
    v_mfma_f32_32x32x16_bf16 v[64:79], a[68:71], a[100:103], v[64:79]
    s_add_u32 m0, s22, 65536
    s_add_u32 s33, s22, 65536
    v_exp_f32 v115, v115
    v_fma_f32 v116, v116, s20, v23
    v_add_f32 v45, v45, v114
    v_accvgpr_read_b32 v52, a148
    v_mfma_f32_32x32x16_bf16 v[80:95], a[68:71], a[36:39], v[80:95]
    ds_read_b128 a[84:87], v7 offset:32768
    v_exp_f32 v116, v116
    v_fma_f32 v117, v117, s20, v23
    v_add_f32 v45, v45, v115
    v_cvt_pk_bf16_f32 v113, v114, v115
    v_accvgpr_read_b32 v53, a149
    v_mfma_f32_32x32x16_bf16 v[64:79], a[72:75], a[104:107], v[64:79]
    buffer_load_dwordx4 v18, s[12:15], s33 offen offset:0 lds
    v_exp_f32 v117, v117
    v_fma_f32 v118, v118, s20, v23
    v_add_f32 v45, v45, v116
    v_accvgpr_read_b32 v54, a150
    v_accvgpr_read_b32 v55, a151
    v_mfma_f32_32x32x16_bf16 v[80:95], a[72:75], a[40:43], v[80:95]
    s_waitcnt lgkmcnt(1)
    ds_read_b128 a[88:91], v8 offset:32768
    v_exp_f32 v118, v118
    v_fma_f32 v119, v119, s20, v23
    v_add_f32 v45, v45, v117
    v_cvt_pk_bf16_f32 v114, v116, v117
    v_mfma_f32_32x32x16_bf16 v[64:79], a[76:79], a[108:111], v[64:79]
    buffer_load_dwordx4 v18, s[12:15], s33 offen offset:1024 lds
    v_exp_f32 v119, v119
    v_fma_f32 v104, v104, s20, v22
    v_add_f32 v45, v45, v118
    v_mul_f32 v48, v48, v24
    v_mul_f32 v49, v49, v24
    v_mfma_f32_32x32x16_bf16 v[80:95], a[76:79], a[44:47], v[80:95]
    ds_read_b128 a[92:95], v9 offset:32768
    v_exp_f32 v104, v104
    v_fma_f32 v105, v105, s20, v22
    v_add_f32 v45, v45, v119
    v_cvt_pk_bf16_f32 v115, v118, v119
    v_mul_f32 v50, v50, v24
    v_mfma_f32_32x32x16_bf16 v[64:79], a[80:83], a[112:115], v[64:79]
    buffer_load_dwordx4 v18, s[12:15], s33 offen offset:2048 lds
    v_exp_f32 v105, v105
    v_fma_f32 v106, v106, s20, v22
    v_add_f32 v44, v44, v104
    v_mul_f32 v51, v51, v24
    v_mul_f32 v52, v52, v24
    v_mfma_f32_32x32x16_bf16 v[80:95], a[80:83], a[48:51], v[80:95]
    s_waitcnt lgkmcnt(1)
    ds_read_b64_tr_b16 a[64:65], v10 offset:24576
    ds_read_b64_tr_b16 a[66:67], v10 offset:26624
    v_exp_f32 v106, v106
    v_fma_f32 v107, v107, s20, v22
    v_add_f32 v44, v44, v105
    v_cvt_pk_bf16_f32 v104, v104, v105
    v_mfma_f32_32x32x16_bf16 v[64:79], a[84:87], a[116:119], v[64:79]
    buffer_load_dwordx4 v18, s[12:15], s33 offen offset:3072 lds
    v_exp_f32 v107, v107
    v_fma_f32 v108, v108, s20, v22
    v_add_f32 v44, v44, v106
    v_mul_f32 v53, v53, v24
    v_mul_f32 v54, v54, v24
    v_mfma_f32_32x32x16_bf16 v[80:95], a[84:87], a[52:55], v[80:95]
    ds_read_b64_tr_b16 a[68:69], v11 offset:24576
    ds_read_b64_tr_b16 a[70:71], v11 offset:26624
    v_exp_f32 v108, v108
    v_fma_f32 v109, v109, s20, v22
    v_add_f32 v44, v44, v107
    v_cvt_pk_bf16_f32 v105, v106, v107
    v_mfma_f32_32x32x16_bf16 v[64:79], a[88:91], a[120:123], v[64:79]
    v_exp_f32 v109, v109
    v_fma_f32 v110, v110, s20, v22
    v_add_f32 v44, v44, v108
    v_mul_f32 v55, v55, v24
    v_cvt_pk_bf16_f32 v48, v48, v49
    v_mfma_f32_32x32x16_bf16 v[80:95], a[88:91], a[56:59], v[80:95]
    s_waitcnt lgkmcnt(2)
    ds_read_b64_tr_b16 a[72:73], v12 offset:24576
    ds_read_b64_tr_b16 a[74:75], v12 offset:26624
    v_exp_f32 v110, v110
    v_fma_f32 v111, v111, s20, v22
    v_add_f32 v44, v44, v109
    v_cvt_pk_bf16_f32 v106, v108, v109
    v_mfma_f32_32x32x16_bf16 v[64:79], a[92:95], a[124:127], v[64:79]
    v_exp_f32 v111, v111
    v_fma_f32 v120, v120, s20, v23
    v_add_f32 v44, v44, v110
    v_cvt_pk_bf16_f32 v49, v50, v51
    v_cvt_pk_bf16_f32 v50, v52, v53
    v_mfma_f32_32x32x16_bf16 v[80:95], a[92:95], a[60:63], v[80:95]
    ds_read_b64_tr_b16 a[76:77], v13 offset:24576
    ds_read_b64_tr_b16 a[78:79], v13 offset:26624
    v_exp_f32 v120, v120
    v_fma_f32 v121, v121, s20, v23
    v_add_f32 v44, v44, v111
    v_cvt_pk_bf16_f32 v107, v110, v111
    v_mfma_f32_32x32x16_bf16 v[128:143], a[64:67], v[96:99], v[128:143]
    v_exp_f32 v121, v121
    v_fma_f32 v122, v122, s20, v23
    v_add_f32 v45, v45, v120
    v_cvt_pk_bf16_f32 v51, v54, v55
    s_nop 0
    v_mfma_f32_32x32x16_bf16 v[192:207], a[64:67], v[112:115], v[192:207]
    s_waitcnt lgkmcnt(2)
    ds_read_b64_tr_b16 a[80:81], v10 offset:28672
    ds_read_b64_tr_b16 a[82:83], v10 offset:30720
    v_exp_f32 v122, v122
    v_fma_f32 v123, v123, s20, v23
    v_add_f32 v45, v45, v121
    v_cvt_pk_bf16_f32 v120, v120, v121
    v_mfma_f32_32x32x16_bf16 v[144:159], a[68:71], v[96:99], v[144:159]
    v_exp_f32 v123, v123
    v_fma_f32 v124, v124, s20, v23
    v_add_f32 v45, v45, v122
    v_permlane32_swap_b32 v48, v50
    v_permlane32_swap_b32 v49, v51
    v_mfma_f32_32x32x16_bf16 v[208:223], a[68:71], v[112:115], v[208:223]
    ds_read_b64_tr_b16 a[84:85], v11 offset:28672
    ds_read_b64_tr_b16 a[86:87], v11 offset:30720
    v_exp_f32 v124, v124
    v_fma_f32 v125, v125, s20, v23
    v_add_f32 v45, v45, v123
    v_cvt_pk_bf16_f32 v121, v122, v123
    v_mfma_f32_32x32x16_bf16 v[160:175], a[72:75], v[96:99], v[160:175]
    v_exp_f32 v125, v125
    v_fma_f32 v126, v126, s20, v23
    v_add_f32 v45, v45, v124
    v_xor_b32 v27, 96, v19
    v_mfma_f32_32x32x16_bf16 v[224:239], a[72:75], v[112:115], v[224:239]
    s_waitcnt lgkmcnt(2)
    ds_read_b64_tr_b16 a[88:89], v12 offset:28672
    ds_read_b64_tr_b16 a[90:91], v12 offset:30720
    ds_write_b128 v26, v[48:51]
    v_exp_f32 v126, v126
    v_fma_f32 v127, v127, s20, v23
    v_add_f32 v45, v45, v125
    v_cvt_pk_bf16_f32 v122, v124, v125
    v_mfma_f32_32x32x16_bf16 v[176:191], a[76:79], v[96:99], v[176:191]
    v_exp_f32 v127, v127
    v_add_f32 v45, v45, v126
    v_add_f32 v45, v45, v127
    v_cvt_pk_bf16_f32 v123, v126, v127
    v_accvgpr_read_b32 v56, a152
    v_mfma_f32_32x32x16_bf16 v[240:255], a[76:79], v[112:115], v[240:255]
    ds_read_b64_tr_b16 a[92:93], v13 offset:28672
    ds_read_b64_tr_b16 a[94:95], v13 offset:30720
    v_fma_f32 v64, v64, s20, v22
    v_exp_f32 v64, v64
    v_fma_f32 v65, v65, s20, v22
    v_accvgpr_read_b32 v57, a153
    v_mfma_f32_32x32x16_bf16 v[128:143], a[80:83], v[104:107], v[128:143]
    v_exp_f32 v65, v65
    v_fma_f32 v66, v66, s20, v22
    v_add_f32 v44, v44, v64
    v_accvgpr_read_b32 v58, a154
    v_accvgpr_read_b32 v59, a155
    v_mfma_f32_32x32x16_bf16 v[192:207], a[80:83], v[120:123], v[192:207]
    s_waitcnt lgkmcnt(2)
    ds_read_b128 a[64:67], v2 offset:40960
    v_exp_f32 v66, v66
    v_fma_f32 v67, v67, s20, v22
    v_add_f32 v44, v44, v65
    v_cvt_pk_bf16_f32 v64, v64, v65
    v_mfma_f32_32x32x16_bf16 v[144:159], a[84:87], v[104:107], v[144:159]
    v_exp_f32 v67, v67
    v_fma_f32 v68, v68, s20, v22
    v_add_f32 v44, v44, v66
    v_accvgpr_read_b32 v60, a156
    v_accvgpr_read_b32 v61, a157
    v_mfma_f32_32x32x16_bf16 v[208:223], a[84:87], v[120:123], v[208:223]
    ds_read_b128 a[68:71], v3 offset:40960
    v_exp_f32 v68, v68
    v_fma_f32 v69, v69, s20, v22
    v_add_f32 v44, v44, v67
    v_cvt_pk_bf16_f32 v65, v66, v67
    v_accvgpr_read_b32 v62, a158
    v_mfma_f32_32x32x16_bf16 v[160:175], a[88:91], v[104:107], v[160:175]
    v_exp_f32 v69, v69
    v_fma_f32 v70, v70, s20, v22
    v_add_f32 v44, v44, v68
    v_accvgpr_read_b32 v63, a159
    v_mul_f32 v56, v56, v24
    v_mfma_f32_32x32x16_bf16 v[224:239], a[88:91], v[120:123], v[224:239]
    s_waitcnt lgkmcnt(1)
    ds_read_b128 a[72:75], v4 offset:40960
    v_exp_f32 v70, v70
    v_fma_f32 v71, v71, s20, v22
    v_add_f32 v44, v44, v69
    v_cvt_pk_bf16_f32 v66, v68, v69
    v_mfma_f32_32x32x16_bf16 v[176:191], a[92:95], v[104:107], v[176:191]
    v_exp_f32 v71, v71
    v_fma_f32 v80, v80, s20, v23
    v_add_f32 v44, v44, v70
    v_mul_f32 v57, v57, v24
    v_mul_f32 v58, v58, v24
    v_mfma_f32_32x32x16_bf16 v[240:255], a[92:95], v[120:123], v[240:255]
    ds_read_b128 a[76:79], v5 offset:40960
    v_exp_f32 v80, v80
    v_fma_f32 v81, v81, s20, v23
    v_add_f32 v44, v44, v71
    v_cvt_pk_bf16_f32 v67, v70, v71
    v_mul_f32 v59, v59, v24
    v_mfma_f32_32x32x16_bf16 v[96:111], a[64:67], a[96:99], 0
    v_exp_f32 v81, v81
    v_fma_f32 v82, v82, s20, v23
    v_add_f32 v45, v45, v80
    v_mul_f32 v60, v60, v24
    v_mul_f32 v61, v61, v24
    v_mfma_f32_32x32x16_bf16 v[112:127], a[64:67], a[32:35], 0
    s_waitcnt lgkmcnt(1)
    s_waitcnt vmcnt(12)
    ds_read_b128 a[80:83], v6 offset:40960
    v_exp_f32 v82, v82
    v_fma_f32 v83, v83, s20, v23
    v_add_f32 v45, v45, v81
    v_cvt_pk_bf16_f32 v80, v80, v81
    v_mfma_f32_32x32x16_bf16 v[96:111], a[68:71], a[100:103], v[96:111]
    s_barrier
    v_exp_f32 v83, v83
    v_fma_f32 v84, v84, s20, v23
    v_add_f32 v45, v45, v82
    v_mul_f32 v62, v62, v24
    v_mul_f32 v63, v63, v24
    v_mfma_f32_32x32x16_bf16 v[112:127], a[68:71], a[36:39], v[112:127]
    ds_read_b128 a[84:87], v7 offset:40960
    v_exp_f32 v84, v84
    v_fma_f32 v85, v85, s20, v23
    v_add_f32 v45, v45, v83
    v_cvt_pk_bf16_f32 v81, v82, v83
    v_cvt_pk_bf16_f32 v56, v56, v57
    v_mfma_f32_32x32x16_bf16 v[96:111], a[72:75], a[104:107], v[96:111]
    s_add_u32 m0, s22, 16384
    s_add_u32 s23, s22, 81920
    v_exp_f32 v85, v85
    v_fma_f32 v86, v86, s20, v23
    v_add_f32 v45, v45, v84
    v_cvt_pk_bf16_f32 v57, v58, v59
    v_mfma_f32_32x32x16_bf16 v[112:127], a[72:75], a[40:43], v[112:127]
    s_waitcnt lgkmcnt(1)
    ds_read_b128 a[88:91], v8 offset:40960
    v_exp_f32 v86, v86
    v_fma_f32 v87, v87, s20, v23
    v_add_f32 v45, v45, v85
    v_cvt_pk_bf16_f32 v82, v84, v85
    v_mfma_f32_32x32x16_bf16 v[96:111], a[76:79], a[108:111], v[96:111]
    buffer_load_dwordx4 v14, s[8:11], s23 offen offset:0 lds
    v_exp_f32 v87, v87
    v_fma_f32 v72, v72, s20, v22
    v_add_f32 v45, v45, v86
    v_cvt_pk_bf16_f32 v58, v60, v61
    v_cvt_pk_bf16_f32 v59, v62, v63
    v_mfma_f32_32x32x16_bf16 v[112:127], a[76:79], a[44:47], v[112:127]
    ds_read_b128 a[92:95], v9 offset:40960
    v_exp_f32 v72, v72
    v_fma_f32 v73, v73, s20, v22
    v_add_f32 v45, v45, v87
    v_cvt_pk_bf16_f32 v83, v86, v87
    s_nop 0
    v_mfma_f32_32x32x16_bf16 v[96:111], a[80:83], a[112:115], v[96:111]
    buffer_load_dwordx4 v15, s[8:11], s23 offen offset:1024 lds
    v_exp_f32 v73, v73
    v_fma_f32 v74, v74, s20, v22
    v_add_f32 v44, v44, v72
    v_permlane32_swap_b32 v56, v58
    v_permlane32_swap_b32 v57, v59
    v_mfma_f32_32x32x16_bf16 v[112:127], a[80:83], a[48:51], v[112:127]
    s_waitcnt lgkmcnt(1)
    ds_read_b64_tr_b16 a[64:65], v10 offset:32768
    ds_read_b64_tr_b16 a[66:67], v10 offset:34816
    v_exp_f32 v74, v74
    v_fma_f32 v75, v75, s20, v22
    v_add_f32 v44, v44, v73
    v_cvt_pk_bf16_f32 v72, v72, v73
    v_mfma_f32_32x32x16_bf16 v[96:111], a[84:87], a[116:119], v[96:111]
    buffer_load_dwordx4 v16, s[8:11], s23 offen offset:2048 lds
    v_exp_f32 v75, v75
    v_fma_f32 v76, v76, s20, v22
    v_add_f32 v44, v44, v74
    v_xor_b32 v26, 128, v19
    v_mfma_f32_32x32x16_bf16 v[112:127], a[84:87], a[52:55], v[112:127]
    ds_read_b64_tr_b16 a[68:69], v11 offset:32768
    ds_read_b64_tr_b16 a[70:71], v11 offset:34816
    ds_write_b128 v27, v[56:59]
    v_exp_f32 v76, v76
    v_fma_f32 v77, v77, s20, v22
    v_add_f32 v44, v44, v75
    v_cvt_pk_bf16_f32 v73, v74, v75
    v_mfma_f32_32x32x16_bf16 v[96:111], a[88:91], a[120:123], v[96:111]
    buffer_load_dwordx4 v17, s[8:11], s23 offen offset:3072 lds
    v_exp_f32 v77, v77
    v_fma_f32 v78, v78, s20, v22
    v_add_f32 v44, v44, v76
    v_accvgpr_read_b32 v48, a160
    v_accvgpr_read_b32 v49, a161
    v_mfma_f32_32x32x16_bf16 v[112:127], a[88:91], a[56:59], v[112:127]
    s_waitcnt lgkmcnt(3)
    ds_read_b64_tr_b16 a[72:73], v12 offset:32768
    ds_read_b64_tr_b16 a[74:75], v12 offset:34816
    v_exp_f32 v78, v78
    v_fma_f32 v79, v79, s20, v22
    v_add_f32 v44, v44, v77
    v_cvt_pk_bf16_f32 v74, v76, v77
    v_mfma_f32_32x32x16_bf16 v[96:111], a[92:95], a[124:127], v[96:111]
    v_exp_f32 v79, v79
    v_fma_f32 v88, v88, s20, v23
    v_add_f32 v44, v44, v78
    v_accvgpr_read_b32 v50, a162
    v_accvgpr_read_b32 v51, a163
    v_mfma_f32_32x32x16_bf16 v[112:127], a[92:95], a[60:63], v[112:127]
    ds_read_b64_tr_b16 a[76:77], v13 offset:32768
    ds_read_b64_tr_b16 a[78:79], v13 offset:34816
    v_exp_f32 v88, v88
    v_fma_f32 v89, v89, s20, v23
    v_add_f32 v44, v44, v79
    v_cvt_pk_bf16_f32 v75, v78, v79
    v_mfma_f32_32x32x16_bf16 v[128:143], a[64:67], v[64:67], v[128:143]
    v_exp_f32 v89, v89
    v_fma_f32 v90, v90, s20, v23
    v_add_f32 v45, v45, v88
    v_accvgpr_read_b32 v52, a164
    v_accvgpr_read_b32 v53, a165
    v_mfma_f32_32x32x16_bf16 v[192:207], a[64:67], v[80:83], v[192:207]
    s_waitcnt lgkmcnt(2)
    ds_read_b64_tr_b16 a[80:81], v10 offset:36864
    ds_read_b64_tr_b16 a[82:83], v10 offset:38912
    v_exp_f32 v90, v90
    v_fma_f32 v91, v91, s20, v23
    v_add_f32 v45, v45, v89
    v_cvt_pk_bf16_f32 v88, v88, v89
    v_mfma_f32_32x32x16_bf16 v[144:159], a[68:71], v[64:67], v[144:159]
    v_exp_f32 v91, v91
    v_fma_f32 v92, v92, s20, v23
    v_add_f32 v45, v45, v90
    v_accvgpr_read_b32 v54, a166
    v_accvgpr_read_b32 v55, a167
    v_mfma_f32_32x32x16_bf16 v[208:223], a[68:71], v[80:83], v[208:223]
    ds_read_b64_tr_b16 a[84:85], v11 offset:36864
    ds_read_b64_tr_b16 a[86:87], v11 offset:38912
    v_exp_f32 v92, v92
    v_fma_f32 v93, v93, s20, v23
    v_add_f32 v45, v45, v91
    v_cvt_pk_bf16_f32 v89, v90, v91
    v_mfma_f32_32x32x16_bf16 v[160:175], a[72:75], v[64:67], v[160:175]
    v_exp_f32 v93, v93
    v_fma_f32 v94, v94, s20, v23
    v_add_f32 v45, v45, v92
    v_mul_f32 v48, v48, v24
    v_mul_f32 v49, v49, v24
    v_mfma_f32_32x32x16_bf16 v[224:239], a[72:75], v[80:83], v[224:239]
    s_waitcnt lgkmcnt(2)
    ds_read_b64_tr_b16 a[88:89], v12 offset:36864
    ds_read_b64_tr_b16 a[90:91], v12 offset:38912
    v_exp_f32 v94, v94
    v_fma_f32 v95, v95, s20, v23
    v_add_f32 v45, v45, v93
    v_cvt_pk_bf16_f32 v90, v92, v93
    v_mfma_f32_32x32x16_bf16 v[176:191], a[76:79], v[64:67], v[176:191]
    v_exp_f32 v95, v95
    v_add_f32 v45, v45, v94
    v_add_f32 v45, v45, v95
    v_cvt_pk_bf16_f32 v91, v94, v95
    v_mul_f32 v50, v50, v24
    v_mfma_f32_32x32x16_bf16 v[240:255], a[76:79], v[80:83], v[240:255]
    ds_read_b64_tr_b16 a[92:93], v13 offset:36864
    ds_read_b64_tr_b16 a[94:95], v13 offset:38912
    v_fma_f32 v96, v96, s20, v22
    v_exp_f32 v96, v96
    v_fma_f32 v97, v97, s20, v22
    v_mul_f32 v51, v51, v24
    v_mfma_f32_32x32x16_bf16 v[128:143], a[80:83], v[72:75], v[128:143]
    v_exp_f32 v97, v97
    v_fma_f32 v98, v98, s20, v22
    v_add_f32 v44, v44, v96
    v_mul_f32 v52, v52, v24
    v_mul_f32 v53, v53, v24
    v_mfma_f32_32x32x16_bf16 v[192:207], a[80:83], v[88:91], v[192:207]
    s_waitcnt lgkmcnt(2)
    ds_read_b128 a[64:67], v2 offset:49152
    v_exp_f32 v98, v98
    v_fma_f32 v99, v99, s20, v22
    v_add_f32 v44, v44, v97
    v_cvt_pk_bf16_f32 v96, v96, v97
    v_mfma_f32_32x32x16_bf16 v[144:159], a[84:87], v[72:75], v[144:159]
    v_exp_f32 v99, v99
    v_fma_f32 v100, v100, s20, v22
    v_add_f32 v44, v44, v98
    v_mul_f32 v54, v54, v24
    v_mul_f32 v55, v55, v24
    v_mfma_f32_32x32x16_bf16 v[208:223], a[84:87], v[88:91], v[208:223]
    ds_read_b128 a[68:71], v3 offset:49152
    v_exp_f32 v100, v100
    v_fma_f32 v101, v101, s20, v22
    v_add_f32 v44, v44, v99
    v_cvt_pk_bf16_f32 v97, v98, v99
    v_cvt_pk_bf16_f32 v48, v48, v49
    v_mfma_f32_32x32x16_bf16 v[160:175], a[88:91], v[72:75], v[160:175]
    v_exp_f32 v101, v101
    v_fma_f32 v102, v102, s20, v22
    v_add_f32 v44, v44, v100
    v_cvt_pk_bf16_f32 v49, v50, v51
    v_cvt_pk_bf16_f32 v50, v52, v53
    v_mfma_f32_32x32x16_bf16 v[224:239], a[88:91], v[88:91], v[224:239]
    s_waitcnt lgkmcnt(1)
    ds_read_b128 a[72:75], v4 offset:49152
    v_exp_f32 v102, v102
    v_fma_f32 v103, v103, s20, v22
    v_add_f32 v44, v44, v101
    v_cvt_pk_bf16_f32 v98, v100, v101
    v_mfma_f32_32x32x16_bf16 v[176:191], a[92:95], v[72:75], v[176:191]
    v_exp_f32 v103, v103
    v_fma_f32 v112, v112, s20, v23
    v_add_f32 v44, v44, v102
    v_cvt_pk_bf16_f32 v51, v54, v55
    s_nop 0
    v_mfma_f32_32x32x16_bf16 v[240:255], a[92:95], v[88:91], v[240:255]
    ds_read_b128 a[76:79], v5 offset:49152
    v_exp_f32 v112, v112
    v_fma_f32 v113, v113, s20, v23
    v_add_f32 v44, v44, v103
    v_cvt_pk_bf16_f32 v99, v102, v103
    v_permlane32_swap_b32 v48, v50
    v_mfma_f32_32x32x16_bf16 v[64:79], a[64:67], a[96:99], 0
    v_exp_f32 v113, v113
    v_fma_f32 v114, v114, s20, v23
    v_add_f32 v45, v45, v112
    v_permlane32_swap_b32 v49, v51
    v_mfma_f32_32x32x16_bf16 v[80:95], a[64:67], a[32:35], 0
    s_waitcnt lgkmcnt(1)
    ds_read_b128 a[80:83], v6 offset:49152
    ds_write_b128 v26, v[48:51]
    v_exp_f32 v114, v114
    v_fma_f32 v115, v115, s20, v23
    v_add_f32 v45, v45, v113
    v_cvt_pk_bf16_f32 v112, v112, v113
    v_mfma_f32_32x32x16_bf16 v[64:79], a[68:71], a[100:103], v[64:79]
    s_add_u32 m0, s22, 81920
    s_add_u32 s33, s22, 81920
    v_exp_f32 v115, v115
    v_fma_f32 v116, v116, s20, v23
    v_add_f32 v45, v45, v114
    v_xor_b32 v27, 160, v19
    v_mfma_f32_32x32x16_bf16 v[80:95], a[68:71], a[36:39], v[80:95]
    ds_read_b128 a[84:87], v7 offset:49152
    v_exp_f32 v116, v116
    v_fma_f32 v117, v117, s20, v23
    v_add_f32 v45, v45, v115
    v_cvt_pk_bf16_f32 v113, v114, v115
    v_accvgpr_read_b32 v56, a168
    v_mfma_f32_32x32x16_bf16 v[64:79], a[72:75], a[104:107], v[64:79]
    buffer_load_dwordx4 v18, s[12:15], s33 offen offset:0 lds
    v_exp_f32 v117, v117
    v_fma_f32 v118, v118, s20, v23
    v_add_f32 v45, v45, v116
    v_accvgpr_read_b32 v57, a169
    v_accvgpr_read_b32 v58, a170
    v_mfma_f32_32x32x16_bf16 v[80:95], a[72:75], a[40:43], v[80:95]
    s_waitcnt lgkmcnt(1)
    ds_read_b128 a[88:91], v8 offset:49152
    v_exp_f32 v118, v118
    v_fma_f32 v119, v119, s20, v23
    v_add_f32 v45, v45, v117
    v_cvt_pk_bf16_f32 v114, v116, v117
    v_mfma_f32_32x32x16_bf16 v[64:79], a[76:79], a[108:111], v[64:79]
    buffer_load_dwordx4 v18, s[12:15], s33 offen offset:1024 lds
    v_exp_f32 v119, v119
    v_fma_f32 v104, v104, s20, v22
    v_add_f32 v45, v45, v118
    v_accvgpr_read_b32 v59, a171
    v_accvgpr_read_b32 v60, a172
    v_mfma_f32_32x32x16_bf16 v[80:95], a[76:79], a[44:47], v[80:95]
    ds_read_b128 a[92:95], v9 offset:49152
    v_exp_f32 v104, v104
    v_fma_f32 v105, v105, s20, v22
    v_add_f32 v45, v45, v119
    v_cvt_pk_bf16_f32 v115, v118, v119
    v_accvgpr_read_b32 v61, a173
    v_mfma_f32_32x32x16_bf16 v[64:79], a[80:83], a[112:115], v[64:79]
    buffer_load_dwordx4 v18, s[12:15], s33 offen offset:2048 lds
    v_exp_f32 v105, v105
    v_fma_f32 v106, v106, s20, v22
    v_add_f32 v44, v44, v104
    v_accvgpr_read_b32 v62, a174
    v_accvgpr_read_b32 v63, a175
    v_mfma_f32_32x32x16_bf16 v[80:95], a[80:83], a[48:51], v[80:95]
    s_waitcnt lgkmcnt(1)
    ds_read_b64_tr_b16 a[64:65], v10 offset:40960
    ds_read_b64_tr_b16 a[66:67], v10 offset:43008
    v_exp_f32 v106, v106
    v_fma_f32 v107, v107, s20, v22
    v_add_f32 v44, v44, v105
    v_cvt_pk_bf16_f32 v104, v104, v105
    v_mfma_f32_32x32x16_bf16 v[64:79], a[84:87], a[116:119], v[64:79]
    buffer_load_dwordx4 v18, s[12:15], s33 offen offset:3072 lds
    v_exp_f32 v107, v107
    v_fma_f32 v108, v108, s20, v22
    v_add_f32 v44, v44, v106
    v_mul_f32 v56, v56, v24
    v_mul_f32 v57, v57, v24
    v_mfma_f32_32x32x16_bf16 v[80:95], a[84:87], a[52:55], v[80:95]
    ds_read_b64_tr_b16 a[68:69], v11 offset:40960
    ds_read_b64_tr_b16 a[70:71], v11 offset:43008
    v_exp_f32 v108, v108
    v_fma_f32 v109, v109, s20, v22
    v_add_f32 v44, v44, v107
    v_cvt_pk_bf16_f32 v105, v106, v107
    v_mfma_f32_32x32x16_bf16 v[64:79], a[88:91], a[120:123], v[64:79]
    v_exp_f32 v109, v109
    v_fma_f32 v110, v110, s20, v22
    v_add_f32 v44, v44, v108
    v_mul_f32 v58, v58, v24
    v_mul_f32 v59, v59, v24
    v_mfma_f32_32x32x16_bf16 v[80:95], a[88:91], a[56:59], v[80:95]
    s_waitcnt lgkmcnt(2)
    ds_read_b64_tr_b16 a[72:73], v12 offset:40960
    ds_read_b64_tr_b16 a[74:75], v12 offset:43008
    v_exp_f32 v110, v110
    v_fma_f32 v111, v111, s20, v22
    v_add_f32 v44, v44, v109
    v_cvt_pk_bf16_f32 v106, v108, v109
    v_mfma_f32_32x32x16_bf16 v[64:79], a[92:95], a[124:127], v[64:79]
    v_exp_f32 v111, v111
    v_fma_f32 v120, v120, s20, v23
    v_add_f32 v44, v44, v110
    v_mul_f32 v60, v60, v24
    v_mul_f32 v61, v61, v24
    v_mfma_f32_32x32x16_bf16 v[80:95], a[92:95], a[60:63], v[80:95]
    ds_read_b64_tr_b16 a[76:77], v13 offset:40960
    ds_read_b64_tr_b16 a[78:79], v13 offset:43008
    v_exp_f32 v120, v120
    v_fma_f32 v121, v121, s20, v23
    v_add_f32 v44, v44, v111
    v_cvt_pk_bf16_f32 v107, v110, v111
    v_mfma_f32_32x32x16_bf16 v[128:143], a[64:67], v[96:99], v[128:143]
    v_exp_f32 v121, v121
    v_fma_f32 v122, v122, s20, v23
    v_add_f32 v45, v45, v120
    v_mul_f32 v62, v62, v24
    v_mul_f32 v63, v63, v24
    v_mfma_f32_32x32x16_bf16 v[192:207], a[64:67], v[112:115], v[192:207]
    s_waitcnt lgkmcnt(2)
    ds_read_b64_tr_b16 a[80:81], v10 offset:45056
    ds_read_b64_tr_b16 a[82:83], v10 offset:47104
    v_exp_f32 v122, v122
    v_fma_f32 v123, v123, s20, v23
    v_add_f32 v45, v45, v121
    v_cvt_pk_bf16_f32 v120, v120, v121
    v_mfma_f32_32x32x16_bf16 v[144:159], a[68:71], v[96:99], v[144:159]
    v_exp_f32 v123, v123
    v_fma_f32 v124, v124, s20, v23
    v_add_f32 v45, v45, v122
    v_cvt_pk_bf16_f32 v56, v56, v57
    v_cvt_pk_bf16_f32 v57, v58, v59
    v_mfma_f32_32x32x16_bf16 v[208:223], a[68:71], v[112:115], v[208:223]
    ds_read_b64_tr_b16 a[84:85], v11 offset:45056
    ds_read_b64_tr_b16 a[86:87], v11 offset:47104
    v_exp_f32 v124, v124
    v_fma_f32 v125, v125, s20, v23
    v_add_f32 v45, v45, v123
    v_cvt_pk_bf16_f32 v121, v122, v123
    v_mfma_f32_32x32x16_bf16 v[160:175], a[72:75], v[96:99], v[160:175]
    v_exp_f32 v125, v125
    v_fma_f32 v126, v126, s20, v23
    v_add_f32 v45, v45, v124
    v_cvt_pk_bf16_f32 v58, v60, v61
    v_cvt_pk_bf16_f32 v59, v62, v63
    v_mfma_f32_32x32x16_bf16 v[224:239], a[72:75], v[112:115], v[224:239]
    s_waitcnt lgkmcnt(2)
    ds_read_b64_tr_b16 a[88:89], v12 offset:45056
    ds_read_b64_tr_b16 a[90:91], v12 offset:47104
    v_exp_f32 v126, v126
    v_fma_f32 v127, v127, s20, v23
    v_add_f32 v45, v45, v125
    v_cvt_pk_bf16_f32 v122, v124, v125
    v_mfma_f32_32x32x16_bf16 v[176:191], a[76:79], v[96:99], v[176:191]
    v_exp_f32 v127, v127
    v_add_f32 v45, v45, v126
    v_add_f32 v45, v45, v127
    v_cvt_pk_bf16_f32 v123, v126, v127
    s_nop 0
    v_mfma_f32_32x32x16_bf16 v[240:255], a[76:79], v[112:115], v[240:255]
    ds_read_b64_tr_b16 a[92:93], v13 offset:45056
    ds_read_b64_tr_b16 a[94:95], v13 offset:47104
    v_fma_f32 v64, v64, s20, v22
    v_exp_f32 v64, v64
    v_fma_f32 v65, v65, s20, v22
    v_permlane32_swap_b32 v56, v58
    v_mfma_f32_32x32x16_bf16 v[128:143], a[80:83], v[104:107], v[128:143]
    v_exp_f32 v65, v65
    v_fma_f32 v66, v66, s20, v22
    v_add_f32 v44, v44, v64
    v_permlane32_swap_b32 v57, v59
    v_mfma_f32_32x32x16_bf16 v[192:207], a[80:83], v[120:123], v[192:207]
    s_waitcnt lgkmcnt(2)
    ds_read_b128 a[64:67], v2 offset:57344
    ds_write_b128 v27, v[56:59]
    v_exp_f32 v66, v66
    v_fma_f32 v67, v67, s20, v22
    v_add_f32 v44, v44, v65
    v_cvt_pk_bf16_f32 v64, v64, v65
    v_mfma_f32_32x32x16_bf16 v[144:159], a[84:87], v[104:107], v[144:159]
    v_exp_f32 v67, v67
    v_fma_f32 v68, v68, s20, v22
    v_add_f32 v44, v44, v66
    v_xor_b32 v26, 192, v19
    v_accvgpr_read_b32 v48, a176
    v_mfma_f32_32x32x16_bf16 v[208:223], a[84:87], v[120:123], v[208:223]
    ds_read_b128 a[68:71], v3 offset:57344
    v_exp_f32 v68, v68
    v_fma_f32 v69, v69, s20, v22
    v_add_f32 v44, v44, v67
    v_cvt_pk_bf16_f32 v65, v66, v67
    v_accvgpr_read_b32 v49, a177
    v_mfma_f32_32x32x16_bf16 v[160:175], a[88:91], v[104:107], v[160:175]
    v_exp_f32 v69, v69
    v_fma_f32 v70, v70, s20, v22
    v_add_f32 v44, v44, v68
    v_accvgpr_read_b32 v50, a178
    v_accvgpr_read_b32 v51, a179
    v_mfma_f32_32x32x16_bf16 v[224:239], a[88:91], v[120:123], v[224:239]
    s_waitcnt lgkmcnt(1)
    ds_read_b128 a[72:75], v4 offset:57344
    v_exp_f32 v70, v70
    v_fma_f32 v71, v71, s20, v22
    v_add_f32 v44, v44, v69
    v_cvt_pk_bf16_f32 v66, v68, v69
    v_mfma_f32_32x32x16_bf16 v[176:191], a[92:95], v[104:107], v[176:191]
    v_exp_f32 v71, v71
    v_fma_f32 v80, v80, s20, v23
    v_add_f32 v44, v44, v70
    v_accvgpr_read_b32 v52, a180
    v_accvgpr_read_b32 v53, a181
    v_mfma_f32_32x32x16_bf16 v[240:255], a[92:95], v[120:123], v[240:255]
    ds_read_b128 a[76:79], v5 offset:57344
    v_exp_f32 v80, v80
    v_fma_f32 v81, v81, s20, v23
    v_add_f32 v44, v44, v71
    v_cvt_pk_bf16_f32 v67, v70, v71
    v_accvgpr_read_b32 v54, a182
    v_mfma_f32_32x32x16_bf16 v[96:111], a[64:67], a[96:99], 0
    v_exp_f32 v81, v81
    v_fma_f32 v82, v82, s20, v23
    v_add_f32 v45, v45, v80
    v_accvgpr_read_b32 v55, a183
    v_mul_f32 v48, v48, v24
    v_mfma_f32_32x32x16_bf16 v[112:127], a[64:67], a[32:35], 0
    s_waitcnt lgkmcnt(1)
    s_waitcnt vmcnt(12)
    ds_read_b128 a[80:83], v6 offset:57344
    v_exp_f32 v82, v82
    v_fma_f32 v83, v83, s20, v23
    v_add_f32 v45, v45, v81
    v_cvt_pk_bf16_f32 v80, v80, v81
    v_mfma_f32_32x32x16_bf16 v[96:111], a[68:71], a[100:103], v[96:111]
    s_barrier
    v_exp_f32 v83, v83
    v_fma_f32 v84, v84, s20, v23
    v_add_f32 v45, v45, v82
    v_mul_f32 v49, v49, v24
    v_mul_f32 v50, v50, v24
    v_mfma_f32_32x32x16_bf16 v[112:127], a[68:71], a[36:39], v[112:127]
    ds_read_b128 a[84:87], v7 offset:57344
    v_exp_f32 v84, v84
    v_fma_f32 v85, v85, s20, v23
    v_add_f32 v45, v45, v83
    v_cvt_pk_bf16_f32 v81, v82, v83
    v_mul_f32 v51, v51, v24
    v_mfma_f32_32x32x16_bf16 v[96:111], a[72:75], a[104:107], v[96:111]
    s_add_u32 m0, s22, 32768
    s_add_u32 s23, s22, 98304
    v_exp_f32 v85, v85
    v_fma_f32 v86, v86, s20, v23
    v_add_f32 v45, v45, v84
    v_mul_f32 v52, v52, v24
    v_mfma_f32_32x32x16_bf16 v[112:127], a[72:75], a[40:43], v[112:127]
    s_waitcnt lgkmcnt(1)
    ds_read_b128 a[88:91], v8 offset:57344
    v_exp_f32 v86, v86
    v_fma_f32 v87, v87, s20, v23
    v_add_f32 v45, v45, v85
    v_cvt_pk_bf16_f32 v82, v84, v85
    v_mfma_f32_32x32x16_bf16 v[96:111], a[76:79], a[108:111], v[96:111]
    buffer_load_dwordx4 v14, s[8:11], s23 offen offset:0 lds
    v_exp_f32 v87, v87
    v_fma_f32 v72, v72, s20, v22
    v_mul_f32 v53, v53, v24
    v_add_f32 v45, v45, v86
    v_mul_f32 v54, v54, v24
    v_mfma_f32_32x32x16_bf16 v[112:127], a[76:79], a[44:47], v[112:127]
    ds_read_b128 a[92:95], v9 offset:57344
    v_exp_f32 v72, v72
    v_fma_f32 v73, v73, s20, v22
    v_add_f32 v45, v45, v87
    v_cvt_pk_bf16_f32 v83, v86, v87
    v_mul_f32 v55, v55, v24
    v_mfma_f32_32x32x16_bf16 v[96:111], a[80:83], a[112:115], v[96:111]
    buffer_load_dwordx4 v15, s[8:11], s23 offen offset:1024 lds
    v_exp_f32 v73, v73
    v_fma_f32 v74, v74, s20, v22
    v_add_f32 v44, v44, v72
    v_cvt_pk_bf16_f32 v48, v48, v49
    v_cvt_pk_bf16_f32 v49, v50, v51
    v_mfma_f32_32x32x16_bf16 v[112:127], a[80:83], a[48:51], v[112:127]
    s_waitcnt lgkmcnt(1)
    ds_read_b64_tr_b16 a[64:65], v10 offset:49152
    ds_read_b64_tr_b16 a[66:67], v10 offset:51200
    v_exp_f32 v74, v74
    v_fma_f32 v75, v75, s20, v22
    v_add_f32 v44, v44, v73
    v_cvt_pk_bf16_f32 v72, v72, v73
    v_mfma_f32_32x32x16_bf16 v[96:111], a[84:87], a[116:119], v[96:111]
    buffer_load_dwordx4 v16, s[8:11], s23 offen offset:2048 lds
    v_exp_f32 v75, v75
    v_fma_f32 v76, v76, s20, v22
    v_cvt_pk_bf16_f32 v50, v52, v53
    v_add_f32 v44, v44, v74
    v_cvt_pk_bf16_f32 v51, v54, v55
    v_mfma_f32_32x32x16_bf16 v[112:127], a[84:87], a[52:55], v[112:127]
    ds_read_b64_tr_b16 a[68:69], v11 offset:49152
    ds_read_b64_tr_b16 a[70:71], v11 offset:51200
    v_exp_f32 v76, v76
    v_fma_f32 v77, v77, s20, v22
    v_add_f32 v44, v44, v75
    v_cvt_pk_bf16_f32 v73, v74, v75
    v_mfma_f32_32x32x16_bf16 v[96:111], a[88:91], a[120:123], v[96:111]
    buffer_load_dwordx4 v17, s[8:11], s23 offen offset:3072 lds
    s_nop 0
    v_exp_f32 v77, v77
    v_fma_f32 v78, v78, s20, v22
    v_add_f32 v44, v44, v76
    v_permlane32_swap_b32 v48, v50
    v_mfma_f32_32x32x16_bf16 v[112:127], a[88:91], a[56:59], v[112:127]
    s_waitcnt lgkmcnt(2)
    ds_read_b64_tr_b16 a[72:73], v12 offset:49152
    ds_read_b64_tr_b16 a[74:75], v12 offset:51200
    v_exp_f32 v78, v78
    v_fma_f32 v79, v79, s20, v22
    v_add_f32 v44, v44, v77
    v_cvt_pk_bf16_f32 v74, v76, v77
    v_mfma_f32_32x32x16_bf16 v[96:111], a[92:95], a[124:127], v[96:111]
    v_permlane32_swap_b32 v49, v51
    v_exp_f32 v79, v79
    v_fma_f32 v88, v88, s20, v23
    v_add_f32 v44, v44, v78
    v_mfma_f32_32x32x16_bf16 v[112:127], a[92:95], a[60:63], v[112:127]
    ds_read_b64_tr_b16 a[76:77], v13 offset:49152
    ds_read_b64_tr_b16 a[78:79], v13 offset:51200
    ds_write_b128 v26, v[48:51]
    v_exp_f32 v88, v88
    v_fma_f32 v89, v89, s20, v23
    v_xor_b32 v27, 224, v19
    v_add_f32 v44, v44, v79
    v_cvt_pk_bf16_f32 v75, v78, v79
    v_mfma_f32_32x32x16_bf16 v[128:143], a[64:67], v[64:67], v[128:143]
    v_accvgpr_read_b32 v56, a184
    v_exp_f32 v89, v89
    v_fma_f32 v90, v90, s20, v23
    v_add_f32 v45, v45, v88
    v_accvgpr_read_b32 v57, a185
    v_mfma_f32_32x32x16_bf16 v[192:207], a[64:67], v[80:83], v[192:207]
    s_waitcnt lgkmcnt(3)
    ds_read_b64_tr_b16 a[80:81], v10 offset:53248
    ds_read_b64_tr_b16 a[82:83], v10 offset:55296
    v_exp_f32 v90, v90
    v_fma_f32 v91, v91, s20, v23
    v_add_f32 v45, v45, v89
    v_cvt_pk_bf16_f32 v88, v88, v89
    v_mfma_f32_32x32x16_bf16 v[144:159], a[68:71], v[64:67], v[144:159]
    v_accvgpr_read_b32 v58, a186
    v_exp_f32 v91, v91
    v_fma_f32 v92, v92, s20, v23
    v_accvgpr_read_b32 v59, a187
    v_add_f32 v45, v45, v90
    v_mfma_f32_32x32x16_bf16 v[208:223], a[68:71], v[80:83], v[208:223]
    ds_read_b64_tr_b16 a[84:85], v11 offset:53248
    ds_read_b64_tr_b16 a[86:87], v11 offset:55296
    v_exp_f32 v92, v92
    v_fma_f32 v93, v93, s20, v23
    v_accvgpr_read_b32 v60, a188
    v_add_f32 v45, v45, v91
    v_cvt_pk_bf16_f32 v89, v90, v91
    v_mfma_f32_32x32x16_bf16 v[160:175], a[72:75], v[64:67], v[160:175]
    v_accvgpr_read_b32 v61, a189
    v_exp_f32 v93, v93
    v_fma_f32 v94, v94, s20, v23
    v_add_f32 v45, v45, v92
    v_accvgpr_read_b32 v62, a190
    v_mfma_f32_32x32x16_bf16 v[224:239], a[72:75], v[80:83], v[224:239]
    s_waitcnt lgkmcnt(2)
    ds_read_b64_tr_b16 a[88:89], v12 offset:53248
    ds_read_b64_tr_b16 a[90:91], v12 offset:55296
    v_exp_f32 v94, v94
    v_fma_f32 v95, v95, s20, v23
    v_add_f32 v45, v45, v93
    v_cvt_pk_bf16_f32 v90, v92, v93
    v_mfma_f32_32x32x16_bf16 v[176:191], a[76:79], v[64:67], v[176:191]
    v_accvgpr_read_b32 v63, a191
    v_exp_f32 v95, v95
    v_add_f32 v45, v45, v94
    v_add_f32 v45, v45, v95
    v_mul_f32 v56, v56, v24
    v_cvt_pk_bf16_f32 v91, v94, v95
    v_mfma_f32_32x32x16_bf16 v[240:255], a[76:79], v[80:83], v[240:255]
    ds_read_b64_tr_b16 a[92:93], v13 offset:53248
    ds_read_b64_tr_b16 a[94:95], v13 offset:55296
    v_fma_f32 v96, v96, s20, v22
    v_mul_f32 v57, v57, v24
    v_exp_f32 v96, v96
    v_fma_f32 v97, v97, s20, v22
    v_mfma_f32_32x32x16_bf16 v[128:143], a[80:83], v[72:75], v[128:143]
    v_mul_f32 v58, v58, v24
    v_exp_f32 v97, v97
    v_fma_f32 v98, v98, s20, v22
    v_add_f32 v44, v44, v96
    v_mul_f32 v59, v59, v24
    v_mfma_f32_32x32x16_bf16 v[192:207], a[80:83], v[88:91], v[192:207]
    s_waitcnt lgkmcnt(2)
    ds_read_b128 a[64:67], v2 offset:0
    v_exp_f32 v98, v98
    v_fma_f32 v99, v99, s20, v22
    v_add_f32 v44, v44, v97
    v_cvt_pk_bf16_f32 v96, v96, v97
    v_mfma_f32_32x32x16_bf16 v[144:159], a[84:87], v[72:75], v[144:159]
    v_mul_f32 v60, v60, v24
    v_exp_f32 v99, v99
    v_fma_f32 v100, v100, s20, v22
    v_mul_f32 v61, v61, v24
    v_add_f32 v44, v44, v98
    v_mfma_f32_32x32x16_bf16 v[208:223], a[84:87], v[88:91], v[208:223]
    ds_read_b128 a[68:71], v3 offset:0
    v_exp_f32 v100, v100
    v_fma_f32 v101, v101, s20, v22
    v_mul_f32 v62, v62, v24
    v_add_f32 v44, v44, v99
    v_cvt_pk_bf16_f32 v97, v98, v99
    v_mfma_f32_32x32x16_bf16 v[160:175], a[88:91], v[72:75], v[160:175]
    v_mul_f32 v63, v63, v24
    v_exp_f32 v101, v101
    v_fma_f32 v102, v102, s20, v22
    v_add_f32 v44, v44, v100
    v_cvt_pk_bf16_f32 v56, v56, v57
    v_mfma_f32_32x32x16_bf16 v[224:239], a[88:91], v[88:91], v[224:239]
    s_waitcnt lgkmcnt(1)
    ds_read_b128 a[72:75], v4 offset:0
    v_exp_f32 v102, v102
    v_fma_f32 v103, v103, s20, v22
    v_add_f32 v44, v44, v101
    v_cvt_pk_bf16_f32 v98, v100, v101
    v_mfma_f32_32x32x16_bf16 v[176:191], a[92:95], v[72:75], v[176:191]
    v_cvt_pk_bf16_f32 v57, v58, v59
    v_exp_f32 v103, v103
    v_fma_f32 v112, v112, s20, v23
    v_add_f32 v44, v44, v102
    v_cvt_pk_bf16_f32 v58, v60, v61
    v_mfma_f32_32x32x16_bf16 v[240:255], a[92:95], v[88:91], v[240:255]
    ds_read_b128 a[76:79], v5 offset:0
    v_exp_f32 v112, v112
    v_fma_f32 v113, v113, s20, v23
    v_cvt_pk_bf16_f32 v59, v62, v63
    v_add_f32 v44, v44, v103
    v_cvt_pk_bf16_f32 v99, v102, v103
    v_mfma_f32_32x32x16_bf16 v[64:79], a[64:67], a[96:99], 0
    s_nop 0
    v_exp_f32 v113, v113
    v_fma_f32 v114, v114, s20, v23
    v_add_f32 v45, v45, v112
    v_permlane32_swap_b32 v56, v58
    v_mfma_f32_32x32x16_bf16 v[80:95], a[64:67], a[32:35], 0
    s_waitcnt lgkmcnt(1)
    ds_read_b128 a[80:83], v6 offset:0
    v_exp_f32 v114, v114
    v_fma_f32 v115, v115, s20, v23
    v_add_f32 v45, v45, v113
    v_cvt_pk_bf16_f32 v112, v112, v113
    v_mfma_f32_32x32x16_bf16 v[64:79], a[68:71], a[100:103], v[64:79]
    s_add_u32 m0, s22, 98304
    s_add_u32 s33, s22, 98304
    v_permlane32_swap_b32 v57, v59
    v_exp_f32 v115, v115
    v_fma_f32 v116, v116, s20, v23
    v_add_f32 v45, v45, v114
    v_mfma_f32_32x32x16_bf16 v[80:95], a[68:71], a[36:39], v[80:95]
    ds_read_b128 a[84:87], v7 offset:0
    v_exp_f32 v116, v116
    v_fma_f32 v117, v117, s20, v23
    v_add_f32 v45, v45, v115
    v_cvt_pk_bf16_f32 v113, v114, v115
    v_mfma_f32_32x32x16_bf16 v[64:79], a[72:75], a[104:107], v[64:79]
    buffer_load_dwordx4 v18, s[12:15], s33 offen offset:0 lds
    ds_write_b128 v27, v[56:59]
    v_xor_b32 v26, 0, v19
    v_exp_f32 v117, v117
    v_fma_f32 v118, v118, s20, v23
    v_add_f32 v45, v45, v116
    v_accvgpr_read_b32 v48, a192
    v_mfma_f32_32x32x16_bf16 v[80:95], a[72:75], a[40:43], v[80:95]
    s_waitcnt lgkmcnt(2)
    ds_read_b128 a[88:91], v8 offset:0
    ds_read_b128 a[128:131], v0 offset:0
    v_exp_f32 v118, v118
    v_fma_f32 v119, v119, s20, v23
    v_add_f32 v45, v45, v117
    v_cvt_pk_bf16_f32 v114, v116, v117
    v_mfma_f32_32x32x16_bf16 v[64:79], a[76:79], a[108:111], v[64:79]
    buffer_load_dwordx4 v18, s[12:15], s33 offen offset:1024 lds
    ds_read_b128 a[132:135], v0 offset:1024
    v_accvgpr_read_b32 v49, a193
    v_exp_f32 v119, v119
    v_fma_f32 v104, v104, s20, v22
    v_add_f32 v45, v45, v118
    v_accvgpr_read_b32 v50, a194
    v_mfma_f32_32x32x16_bf16 v[80:95], a[76:79], a[44:47], v[80:95]
    ds_read_b128 a[92:95], v9 offset:0
    ds_read_b128 a[136:139], v0 offset:2048
    v_exp_f32 v104, v104
    v_fma_f32 v105, v105, s20, v22
    v_add_f32 v45, v45, v119
    v_accvgpr_read_b32 v51, a195
    v_cvt_pk_bf16_f32 v115, v118, v119
    v_mfma_f32_32x32x16_bf16 v[64:79], a[80:83], a[112:115], v[64:79]
    buffer_load_dwordx4 v18, s[12:15], s33 offen offset:2048 lds
    ds_read_b128 a[140:143], v0 offset:3072
    v_accvgpr_read_b32 v52, a196
    v_exp_f32 v105, v105
    v_fma_f32 v106, v106, s20, v22
    v_add_f32 v44, v44, v104
    v_accvgpr_read_b32 v53, a197
    v_mfma_f32_32x32x16_bf16 v[80:95], a[80:83], a[48:51], v[80:95]
    s_waitcnt lgkmcnt(3)
    ds_read_b64_tr_b16 a[64:65], v10 offset:57344
    ds_read_b64_tr_b16 a[66:67], v10 offset:59392
    ds_read_b128 a[144:147], v0 offset:4096
    v_exp_f32 v106, v106
    v_fma_f32 v107, v107, s20, v22
    v_add_f32 v44, v44, v105
    v_cvt_pk_bf16_f32 v104, v104, v105
    v_mfma_f32_32x32x16_bf16 v[64:79], a[84:87], a[116:119], v[64:79]
    buffer_load_dwordx4 v18, s[12:15], s33 offen offset:3072 lds
    ds_read_b128 a[148:151], v0 offset:5120
    v_accvgpr_read_b32 v54, a198
    v_exp_f32 v107, v107
    v_fma_f32 v108, v108, s20, v22
    v_add_f32 v44, v44, v106
    v_accvgpr_read_b32 v55, a199
    v_mfma_f32_32x32x16_bf16 v[80:95], a[84:87], a[52:55], v[80:95]
    ds_read_b64_tr_b16 a[68:69], v11 offset:57344
    ds_read_b64_tr_b16 a[70:71], v11 offset:59392
    ds_read_b128 a[152:155], v0 offset:6144
    v_exp_f32 v108, v108
    v_fma_f32 v109, v109, s20, v22
    v_add_f32 v44, v44, v107
    v_mul_f32 v48, v48, v25
    v_cvt_pk_bf16_f32 v105, v106, v107
    v_mfma_f32_32x32x16_bf16 v[64:79], a[88:91], a[120:123], v[64:79]
    ds_read_b128 a[156:159], v0 offset:7168
    v_mul_f32 v49, v49, v25
    v_exp_f32 v109, v109
    v_fma_f32 v110, v110, s20, v22
    v_add_f32 v44, v44, v108
    v_mul_f32 v50, v50, v25
    v_mfma_f32_32x32x16_bf16 v[80:95], a[88:91], a[56:59], v[80:95]
    s_waitcnt lgkmcnt(4)
    ds_read_b64_tr_b16 a[72:73], v12 offset:57344
    ds_read_b64_tr_b16 a[74:75], v12 offset:59392
    v_exp_f32 v110, v110
    v_fma_f32 v111, v111, s20, v22
    v_add_f32 v44, v44, v109
    v_cvt_pk_bf16_f32 v106, v108, v109
    v_mfma_f32_32x32x16_bf16 v[64:79], a[92:95], a[124:127], v[64:79]
    v_mul_f32 v51, v51, v25
    v_exp_f32 v111, v111
    v_fma_f32 v120, v120, s20, v23
    v_add_f32 v44, v44, v110
    v_mul_f32 v52, v52, v25
    v_mfma_f32_32x32x16_bf16 v[80:95], a[92:95], a[60:63], v[80:95]
    ds_read_b64_tr_b16 a[76:77], v13 offset:57344
    ds_read_b64_tr_b16 a[78:79], v13 offset:59392
    buffer_store_dwordx4 a[128:131], v14, s[16:19], s25 offen offset:0 sc1
    v_exp_f32 v120, v120
    v_fma_f32 v121, v121, s20, v23
    v_add_f32 v44, v44, v111
    v_mul_f32 v53, v53, v25
    v_cvt_pk_bf16_f32 v107, v110, v111
    v_mfma_f32_32x32x16_bf16 v[128:143], a[64:67], v[96:99], v[128:143]
    v_exp_f32 v121, v121
    v_mul_f32 v54, v54, v25
    v_fma_f32 v122, v122, s20, v23
    v_add_f32 v45, v45, v120
    v_mul_f32 v55, v55, v25
    v_mfma_f32_32x32x16_bf16 v[192:207], a[64:67], v[112:115], v[192:207]
    s_waitcnt lgkmcnt(2)
    ds_read_b64_tr_b16 a[80:81], v10 offset:61440
    ds_read_b64_tr_b16 a[82:83], v10 offset:63488
    v_exp_f32 v122, v122
    v_fma_f32 v123, v123, s20, v23
    v_add_f32 v45, v45, v121
    v_cvt_pk_bf16_f32 v120, v120, v121
    v_mfma_f32_32x32x16_bf16 v[144:159], a[68:71], v[96:99], v[144:159]
    v_cvt_pk_bf16_f32 v48, v48, v49
    v_exp_f32 v123, v123
    v_fma_f32 v124, v124, s20, v23
    v_add_f32 v45, v45, v122
    v_cvt_pk_bf16_f32 v49, v50, v51
    v_mfma_f32_32x32x16_bf16 v[208:223], a[68:71], v[112:115], v[208:223]
    ds_read_b64_tr_b16 a[84:85], v11 offset:61440
    ds_read_b64_tr_b16 a[86:87], v11 offset:63488
    v_exp_f32 v124, v124
    v_fma_f32 v125, v125, s20, v23
    v_add_f32 v45, v45, v123
    v_cvt_pk_bf16_f32 v50, v52, v53
    v_cvt_pk_bf16_f32 v121, v122, v123
    v_mfma_f32_32x32x16_bf16 v[160:175], a[72:75], v[96:99], v[160:175]
    v_exp_f32 v125, v125
    v_cvt_pk_bf16_f32 v51, v54, v55
    v_fma_f32 v126, v126, s20, v23
    v_add_f32 v45, v45, v124
    s_nop 0
    v_mfma_f32_32x32x16_bf16 v[224:239], a[72:75], v[112:115], v[224:239]
    s_waitcnt lgkmcnt(2)
    ds_read_b64_tr_b16 a[88:89], v12 offset:61440
    ds_read_b64_tr_b16 a[90:91], v12 offset:63488
    buffer_store_dwordx4 a[132:135], v15, s[16:19], s25 offen offset:1024 sc1
    v_exp_f32 v126, v126
    v_fma_f32 v127, v127, s20, v23
    v_add_f32 v45, v45, v125
    v_cvt_pk_bf16_f32 v122, v124, v125
    v_mfma_f32_32x32x16_bf16 v[176:191], a[76:79], v[96:99], v[176:191]
    v_permlane32_swap_b32 v48, v50
    v_exp_f32 v127, v127
    v_add_f32 v45, v45, v126
    v_add_f32 v45, v45, v127
    v_cvt_pk_bf16_f32 v123, v126, v127
    v_mfma_f32_32x32x16_bf16 v[240:255], a[76:79], v[112:115], v[240:255]
    ds_read_b64_tr_b16 a[92:93], v13 offset:61440
    ds_read_b64_tr_b16 a[94:95], v13 offset:63488
    v_permlane32_swap_b32 v49, v51
    v_fma_f32 v64, v64, s20, v22
    v_exp_f32 v64, v64
    v_fma_f32 v65, v65, s20, v22
    v_mfma_f32_32x32x16_bf16 v[128:143], a[80:83], v[104:107], v[128:143]
    ds_write_b128 v26, v[48:51]
    v_exp_f32 v65, v65
    v_xor_b32 v27, 32, v19
    v_fma_f32 v66, v66, s20, v22
    v_add_f32 v44, v44, v64
    v_accvgpr_read_b32 v56, a200
    v_mfma_f32_32x32x16_bf16 v[192:207], a[80:83], v[120:123], v[192:207]
    s_waitcnt lgkmcnt(3)
    ds_read_b128 a[64:67], v2 offset:8192
    v_exp_f32 v66, v66
    v_fma_f32 v67, v67, s20, v22
    v_add_f32 v44, v44, v65
    v_cvt_pk_bf16_f32 v64, v64, v65
    v_mfma_f32_32x32x16_bf16 v[144:159], a[84:87], v[104:107], v[144:159]
    v_accvgpr_read_b32 v57, a201
    v_exp_f32 v67, v67
    v_fma_f32 v68, v68, s20, v22
    v_add_f32 v44, v44, v66
    v_accvgpr_read_b32 v58, a202
    v_mfma_f32_32x32x16_bf16 v[208:223], a[84:87], v[120:123], v[208:223]
    ds_read_b128 a[68:71], v3 offset:8192
    buffer_store_dwordx4 a[136:139], v16, s[16:19], s25 offen offset:2048 sc1
    v_exp_f32 v68, v68
    v_fma_f32 v69, v69, s20, v22
    v_add_f32 v44, v44, v67
    v_accvgpr_read_b32 v59, a203
    v_cvt_pk_bf16_f32 v65, v66, v67
    v_mfma_f32_32x32x16_bf16 v[160:175], a[88:91], v[104:107], v[160:175]
    v_exp_f32 v69, v69
    v_accvgpr_read_b32 v60, a204
    v_fma_f32 v70, v70, s20, v22
    v_add_f32 v44, v44, v68
    v_accvgpr_read_b32 v61, a205
    v_mfma_f32_32x32x16_bf16 v[224:239], a[88:91], v[120:123], v[224:239]
    s_waitcnt lgkmcnt(1)
    ds_read_b128 a[72:75], v4 offset:8192
    v_exp_f32 v70, v70
    v_fma_f32 v71, v71, s20, v22
    v_add_f32 v44, v44, v69
    v_cvt_pk_bf16_f32 v66, v68, v69
    v_mfma_f32_32x32x16_bf16 v[176:191], a[92:95], v[104:107], v[176:191]
    v_accvgpr_read_b32 v62, a206
    v_exp_f32 v71, v71
    v_fma_f32 v80, v80, s20, v23
    v_add_f32 v44, v44, v70
    v_accvgpr_read_b32 v63, a207
    v_mfma_f32_32x32x16_bf16 v[240:255], a[92:95], v[120:123], v[240:255]
    ds_read_b128 a[76:79], v5 offset:8192
    v_exp_f32 v80, v80
    v_fma_f32 v81, v81, s20, v23
    v_add_f32 v44, v44, v71
    v_mul_f32 v56, v56, v25
    v_cvt_pk_bf16_f32 v67, v70, v71
    v_mfma_f32_32x32x16_bf16 v[96:111], a[64:67], a[96:99], 0
    v_exp_f32 v81, v81
    v_mul_f32 v57, v57, v25
    v_fma_f32 v82, v82, s20, v23
    v_add_f32 v45, v45, v80
    v_mul_f32 v58, v58, v25
    v_mfma_f32_32x32x16_bf16 v[112:127], a[64:67], a[32:35], 0
    s_waitcnt lgkmcnt(1)
    s_waitcnt vmcnt(15)
    ds_read_b128 a[80:83], v6 offset:8192
    buffer_store_dwordx4 a[140:143], v17, s[16:19], s25 offen offset:3072 sc1
    v_exp_f32 v82, v82
    v_fma_f32 v83, v83, s20, v23
    v_add_f32 v45, v45, v81
    v_cvt_pk_bf16_f32 v80, v80, v81
    v_mfma_f32_32x32x16_bf16 v[96:111], a[68:71], a[100:103], v[96:111]
    s_barrier
    v_mul_f32 v59, v59, v25
    v_exp_f32 v83, v83
    v_fma_f32 v84, v84, s20, v23
    v_add_f32 v45, v45, v82
    v_mul_f32 v60, v60, v25
    v_mfma_f32_32x32x16_bf16 v[112:127], a[68:71], a[36:39], v[112:127]
    ds_read_b128 a[84:87], v7 offset:8192
    v_exp_f32 v84, v84
    v_fma_f32 v85, v85, s20, v23
    v_add_f32 v45, v45, v83
    v_mul_f32 v61, v61, v25
    v_cvt_pk_bf16_f32 v81, v82, v83
    v_mfma_f32_32x32x16_bf16 v[96:111], a[72:75], a[104:107], v[96:111]
    s_add_u32 m0, s22, 49152
    s_add_u32 s23, s22, 114688
    v_exp_f32 v85, v85
    v_mul_f32 v62, v62, v25
    v_fma_f32 v86, v86, s20, v23
    v_add_f32 v45, v45, v84
    v_mfma_f32_32x32x16_bf16 v[112:127], a[72:75], a[40:43], v[112:127]
    s_waitcnt lgkmcnt(1)
    ds_read_b128 a[88:91], v8 offset:8192
    v_exp_f32 v86, v86
    v_mul_f32 v63, v63, v25
    v_fma_f32 v87, v87, s20, v23
    v_add_f32 v45, v45, v85
    v_cvt_pk_bf16_f32 v82, v84, v85
    v_mfma_f32_32x32x16_bf16 v[96:111], a[76:79], a[108:111], v[96:111]
    buffer_load_dwordx4 v14, s[8:11], s23 offen offset:0 lds
    v_cvt_pk_bf16_f32 v56, v56, v57
    v_exp_f32 v87, v87
    v_fma_f32 v72, v72, s20, v22
    v_add_f32 v45, v45, v86
    v_cvt_pk_bf16_f32 v57, v58, v59
    v_mfma_f32_32x32x16_bf16 v[112:127], a[76:79], a[44:47], v[112:127]
    ds_read_b128 a[92:95], v9 offset:8192
    buffer_store_dwordx4 a[144:147], v14, s[16:19], s68 offen offset:0 sc1
    v_exp_f32 v72, v72
    v_fma_f32 v73, v73, s20, v22
    v_add_f32 v45, v45, v87
    v_cvt_pk_bf16_f32 v58, v60, v61
    v_cvt_pk_bf16_f32 v83, v86, v87
    v_mfma_f32_32x32x16_bf16 v[96:111], a[80:83], a[112:115], v[96:111]
    buffer_load_dwordx4 v15, s[8:11], s23 offen offset:1024 lds
    v_exp_f32 v73, v73
    v_cvt_pk_bf16_f32 v59, v62, v63
    v_fma_f32 v74, v74, s20, v22
    v_add_f32 v44, v44, v72
    s_nop 0
    v_mfma_f32_32x32x16_bf16 v[112:127], a[80:83], a[48:51], v[112:127]
    s_waitcnt lgkmcnt(1)
    ds_read_b64_tr_b16 a[64:65], v10 offset:0
    ds_read_b64_tr_b16 a[66:67], v10 offset:2048
    v_exp_f32 v74, v74
    v_fma_f32 v75, v75, s20, v22
    v_add_f32 v44, v44, v73
    v_cvt_pk_bf16_f32 v72, v72, v73
    v_mfma_f32_32x32x16_bf16 v[96:111], a[84:87], a[116:119], v[96:111]
    buffer_load_dwordx4 v16, s[8:11], s23 offen offset:2048 lds
    v_permlane32_swap_b32 v56, v58
    v_exp_f32 v75, v75
    v_fma_f32 v76, v76, s20, v22
    v_add_f32 v44, v44, v74
    v_permlane32_swap_b32 v57, v59
    v_mfma_f32_32x32x16_bf16 v[112:127], a[84:87], a[52:55], v[112:127]
    ds_read_b64_tr_b16 a[68:69], v11 offset:0
    ds_read_b64_tr_b16 a[70:71], v11 offset:2048
    v_exp_f32 v76, v76
    v_fma_f32 v77, v77, s20, v22
    v_add_f32 v44, v44, v75
    v_cvt_pk_bf16_f32 v73, v74, v75
    v_mfma_f32_32x32x16_bf16 v[96:111], a[88:91], a[120:123], v[96:111]
    buffer_load_dwordx4 v17, s[8:11], s23 offen offset:3072 lds
    ds_write_b128 v27, v[56:59]
    v_exp_f32 v77, v77
    v_xor_b32 v26, 64, v19
    v_fma_f32 v78, v78, s20, v22
    v_add_f32 v44, v44, v76
    v_accvgpr_read_b32 v48, a208
    v_mfma_f32_32x32x16_bf16 v[112:127], a[88:91], a[56:59], v[112:127]
    s_waitcnt lgkmcnt(3)
    ds_read_b64_tr_b16 a[72:73], v12 offset:0
    ds_read_b64_tr_b16 a[74:75], v12 offset:2048
    buffer_store_dwordx4 a[148:151], v15, s[16:19], s68 offen offset:1024 sc1
    v_exp_f32 v78, v78
    v_fma_f32 v79, v79, s20, v22
    v_add_f32 v44, v44, v77
    v_cvt_pk_bf16_f32 v74, v76, v77
    v_mfma_f32_32x32x16_bf16 v[96:111], a[92:95], a[124:127], v[96:111]
    v_accvgpr_read_b32 v49, a209
    v_exp_f32 v79, v79
    v_fma_f32 v88, v88, s20, v23
    v_add_f32 v44, v44, v78
    v_accvgpr_read_b32 v50, a210
    v_mfma_f32_32x32x16_bf16 v[112:127], a[92:95], a[60:63], v[112:127]
    ds_read_b64_tr_b16 a[76:77], v13 offset:0
    ds_read_b64_tr_b16 a[78:79], v13 offset:2048
    v_exp_f32 v88, v88
    v_fma_f32 v89, v89, s20, v23
    v_add_f32 v44, v44, v79
    v_accvgpr_read_b32 v51, a211
    v_cvt_pk_bf16_f32 v75, v78, v79
    v_mfma_f32_32x32x16_bf16 v[128:143], a[64:67], v[64:67], v[128:143]
    v_exp_f32 v89, v89
    v_accvgpr_read_b32 v52, a212
    v_fma_f32 v90, v90, s20, v23
    v_add_f32 v45, v45, v88
    v_accvgpr_read_b32 v53, a213
    v_mfma_f32_32x32x16_bf16 v[192:207], a[64:67], v[80:83], v[192:207]
    s_waitcnt lgkmcnt(2)
    ds_read_b64_tr_b16 a[80:81], v10 offset:4096
    ds_read_b64_tr_b16 a[82:83], v10 offset:6144
    v_exp_f32 v90, v90
    v_fma_f32 v91, v91, s20, v23
    v_add_f32 v45, v45, v89
    v_cvt_pk_bf16_f32 v88, v88, v89
    v_mfma_f32_32x32x16_bf16 v[144:159], a[68:71], v[64:67], v[144:159]
    v_accvgpr_read_b32 v54, a214
    v_exp_f32 v91, v91
    v_fma_f32 v92, v92, s20, v23
    v_add_f32 v45, v45, v90
    v_accvgpr_read_b32 v55, a215
    v_mfma_f32_32x32x16_bf16 v[208:223], a[68:71], v[80:83], v[208:223]
    ds_read_b64_tr_b16 a[84:85], v11 offset:4096
    ds_read_b64_tr_b16 a[86:87], v11 offset:6144
    buffer_store_dwordx4 a[152:155], v16, s[16:19], s68 offen offset:2048 sc1
    v_exp_f32 v92, v92
    v_fma_f32 v93, v93, s20, v23
    v_add_f32 v45, v45, v91
    v_mul_f32 v48, v48, v25
    v_cvt_pk_bf16_f32 v89, v90, v91
    v_mfma_f32_32x32x16_bf16 v[160:175], a[72:75], v[64:67], v[160:175]
    v_exp_f32 v93, v93
    v_mul_f32 v49, v49, v25
    v_fma_f32 v94, v94, s20, v23
    v_add_f32 v45, v45, v92
    v_mul_f32 v50, v50, v25
    v_mfma_f32_32x32x16_bf16 v[224:239], a[72:75], v[80:83], v[224:239]
    s_waitcnt lgkmcnt(2)
    ds_read_b64_tr_b16 a[88:89], v12 offset:4096
    ds_read_b64_tr_b16 a[90:91], v12 offset:6144
    v_exp_f32 v94, v94
    v_fma_f32 v95, v95, s20, v23
    v_add_f32 v45, v45, v93
    v_cvt_pk_bf16_f32 v90, v92, v93
    v_mfma_f32_32x32x16_bf16 v[176:191], a[76:79], v[64:67], v[176:191]
    v_mul_f32 v51, v51, v25
    v_exp_f32 v95, v95
    v_add_f32 v45, v45, v94
    v_add_f32 v45, v45, v95
    v_cvt_pk_bf16_f32 v91, v94, v95
    v_mfma_f32_32x32x16_bf16 v[240:255], a[76:79], v[80:83], v[240:255]
    ds_read_b64_tr_b16 a[92:93], v13 offset:4096
    ds_read_b64_tr_b16 a[94:95], v13 offset:6144
    v_mul_f32 v52, v52, v25
    v_fma_f32 v96, v96, s20, v22
    v_exp_f32 v96, v96
    v_mul_f32 v53, v53, v25
    v_fma_f32 v97, v97, s20, v22
    v_mfma_f32_32x32x16_bf16 v[128:143], a[80:83], v[72:75], v[128:143]
    v_exp_f32 v97, v97
    v_mul_f32 v54, v54, v25
    v_fma_f32 v98, v98, s20, v22
    v_add_f32 v44, v44, v96
    v_mul_f32 v55, v55, v25
    v_mfma_f32_32x32x16_bf16 v[192:207], a[80:83], v[88:91], v[192:207]
    s_waitcnt lgkmcnt(2)
    ds_read_b128 a[64:67], v2 offset:16384
    buffer_store_dwordx4 a[156:159], v17, s[16:19], s68 offen offset:3072 sc1
    v_exp_f32 v98, v98
    v_fma_f32 v99, v99, s20, v22
    v_add_f32 v44, v44, v97
    v_cvt_pk_bf16_f32 v96, v96, v97
    v_mfma_f32_32x32x16_bf16 v[144:159], a[84:87], v[72:75], v[144:159]
    v_cvt_pk_bf16_f32 v48, v48, v49
    v_exp_f32 v99, v99
    v_fma_f32 v100, v100, s20, v22
    v_add_f32 v44, v44, v98
    v_cvt_pk_bf16_f32 v49, v50, v51
    v_mfma_f32_32x32x16_bf16 v[208:223], a[84:87], v[88:91], v[208:223]
    ds_read_b128 a[68:71], v3 offset:16384
    v_exp_f32 v100, v100
    v_fma_f32 v101, v101, s20, v22
    v_add_f32 v44, v44, v99
    v_cvt_pk_bf16_f32 v50, v52, v53
    v_cvt_pk_bf16_f32 v97, v98, v99
    v_mfma_f32_32x32x16_bf16 v[160:175], a[88:91], v[72:75], v[160:175]
    v_exp_f32 v101, v101
    v_cvt_pk_bf16_f32 v51, v54, v55
    v_fma_f32 v102, v102, s20, v22
    v_add_f32 v44, v44, v100
    s_nop 0
    v_mfma_f32_32x32x16_bf16 v[224:239], a[88:91], v[88:91], v[224:239]
    s_waitcnt lgkmcnt(1)
    ds_read_b128 a[72:75], v4 offset:16384
    v_exp_f32 v102, v102
    v_fma_f32 v103, v103, s20, v22
    v_add_f32 v44, v44, v101
    v_cvt_pk_bf16_f32 v98, v100, v101
    v_mfma_f32_32x32x16_bf16 v[176:191], a[92:95], v[72:75], v[176:191]
    v_permlane32_swap_b32 v48, v50
    v_exp_f32 v103, v103
    v_fma_f32 v112, v112, s20, v23
    v_add_f32 v44, v44, v102
    v_permlane32_swap_b32 v49, v51
    v_mfma_f32_32x32x16_bf16 v[240:255], a[92:95], v[88:91], v[240:255]
    ds_read_b128 a[76:79], v5 offset:16384
    v_exp_f32 v112, v112
    v_fma_f32 v113, v113, s20, v23
    v_add_f32 v44, v44, v103
    v_cvt_pk_bf16_f32 v99, v102, v103
    v_mfma_f32_32x32x16_bf16 v[64:79], a[64:67], a[96:99], 0
    ds_write_b128 v26, v[48:51]
    v_exp_f32 v113, v113
    v_xor_b32 v27, 96, v19
    v_fma_f32 v114, v114, s20, v23
    v_add_f32 v45, v45, v112
    v_accvgpr_read_b32 v56, a216
    v_mfma_f32_32x32x16_bf16 v[80:95], a[64:67], a[32:35], 0
    s_waitcnt lgkmcnt(2)
    ds_read_b128 a[80:83], v6 offset:16384
    v_exp_f32 v114, v114
    v_fma_f32 v115, v115, s20, v23
    v_add_f32 v45, v45, v113
    v_cvt_pk_bf16_f32 v112, v112, v113
    v_mfma_f32_32x32x16_bf16 v[64:79], a[68:71], a[100:103], v[64:79]
    s_add_u32 m0, s22, 114688
    s_add_u32 s33, s22, 114688
    v_accvgpr_read_b32 v57, a217
    v_exp_f32 v115, v115
    v_fma_f32 v116, v116, s20, v23
    v_add_f32 v45, v45, v114
    v_mfma_f32_32x32x16_bf16 v[80:95], a[68:71], a[36:39], v[80:95]
    ds_read_b128 a[84:87], v7 offset:16384
    v_accvgpr_read_b32 v58, a218
    v_exp_f32 v116, v116
    v_fma_f32 v117, v117, s20, v23
    v_add_f32 v45, v45, v115
    v_accvgpr_read_b32 v59, a219
    v_cvt_pk_bf16_f32 v113, v114, v115
    v_mfma_f32_32x32x16_bf16 v[64:79], a[72:75], a[104:107], v[64:79]
    buffer_load_dwordx4 v18, s[12:15], s33 offen offset:0 lds
    v_exp_f32 v117, v117
    v_accvgpr_read_b32 v60, a220
    v_fma_f32 v118, v118, s20, v23
    v_add_f32 v45, v45, v116
    v_accvgpr_read_b32 v61, a221
    v_mfma_f32_32x32x16_bf16 v[80:95], a[72:75], a[40:43], v[80:95]
    s_waitcnt lgkmcnt(1)
    ds_read_b128 a[88:91], v8 offset:16384
    v_exp_f32 v118, v118
    v_fma_f32 v119, v119, s20, v23
    v_add_f32 v45, v45, v117
    v_cvt_pk_bf16_f32 v114, v116, v117
    v_mfma_f32_32x32x16_bf16 v[64:79], a[76:79], a[108:111], v[64:79]
    buffer_load_dwordx4 v18, s[12:15], s33 offen offset:1024 lds
    v_accvgpr_read_b32 v62, a222
    v_exp_f32 v119, v119
    v_fma_f32 v104, v104, s20, v22
    v_add_f32 v45, v45, v118
    v_accvgpr_read_b32 v63, a223
    v_mfma_f32_32x32x16_bf16 v[80:95], a[76:79], a[44:47], v[80:95]
    ds_read_b128 a[92:95], v9 offset:16384
    v_exp_f32 v104, v104
    v_fma_f32 v105, v105, s20, v22
    v_add_f32 v45, v45, v119
    v_mul_f32 v56, v56, v25
    v_cvt_pk_bf16_f32 v115, v118, v119
    v_mfma_f32_32x32x16_bf16 v[64:79], a[80:83], a[112:115], v[64:79]
    buffer_load_dwordx4 v18, s[12:15], s33 offen offset:2048 lds
    v_exp_f32 v105, v105
    v_mul_f32 v57, v57, v25
    v_fma_f32 v106, v106, s20, v22
    v_add_f32 v44, v44, v104
    v_mul_f32 v58, v58, v25
    v_mfma_f32_32x32x16_bf16 v[80:95], a[80:83], a[48:51], v[80:95]
    s_waitcnt lgkmcnt(1)
    ds_read_b64_tr_b16 a[64:65], v10 offset:8192
    ds_read_b64_tr_b16 a[66:67], v10 offset:10240
    v_exp_f32 v106, v106
    v_fma_f32 v107, v107, s20, v22
    v_add_f32 v44, v44, v105
    v_cvt_pk_bf16_f32 v104, v104, v105
    v_mfma_f32_32x32x16_bf16 v[64:79], a[84:87], a[116:119], v[64:79]
    buffer_load_dwordx4 v18, s[12:15], s33 offen offset:3072 lds
    v_mul_f32 v59, v59, v25
    v_exp_f32 v107, v107
    v_fma_f32 v108, v108, s20, v22
    v_add_f32 v44, v44, v106
    v_mul_f32 v60, v60, v25
    v_mfma_f32_32x32x16_bf16 v[80:95], a[84:87], a[52:55], v[80:95]
    ds_read_b64_tr_b16 a[68:69], v11 offset:8192
    ds_read_b64_tr_b16 a[70:71], v11 offset:10240
    v_exp_f32 v108, v108
    v_fma_f32 v109, v109, s20, v22
    v_add_f32 v44, v44, v107
    v_mul_f32 v61, v61, v25
    v_cvt_pk_bf16_f32 v105, v106, v107
    v_mfma_f32_32x32x16_bf16 v[64:79], a[88:91], a[120:123], v[64:79]
    v_exp_f32 v109, v109
    v_mul_f32 v62, v62, v25
    v_fma_f32 v110, v110, s20, v22
    v_add_f32 v44, v44, v108
    v_mul_f32 v63, v63, v25
    v_mfma_f32_32x32x16_bf16 v[80:95], a[88:91], a[56:59], v[80:95]
    s_waitcnt lgkmcnt(2)
    ds_read_b64_tr_b16 a[72:73], v12 offset:8192
    ds_read_b64_tr_b16 a[74:75], v12 offset:10240
    v_exp_f32 v110, v110
    v_fma_f32 v111, v111, s20, v22
    v_add_f32 v44, v44, v109
    v_cvt_pk_bf16_f32 v106, v108, v109
    v_mfma_f32_32x32x16_bf16 v[64:79], a[92:95], a[124:127], v[64:79]
    v_cvt_pk_bf16_f32 v56, v56, v57
    v_exp_f32 v111, v111
    v_fma_f32 v120, v120, s20, v23
    v_add_f32 v44, v44, v110
    v_cvt_pk_bf16_f32 v57, v58, v59
    v_mfma_f32_32x32x16_bf16 v[80:95], a[92:95], a[60:63], v[80:95]
    ds_read_b64_tr_b16 a[76:77], v13 offset:8192
    ds_read_b64_tr_b16 a[78:79], v13 offset:10240
    v_exp_f32 v120, v120
    v_fma_f32 v121, v121, s20, v23
    v_add_f32 v44, v44, v111
    v_cvt_pk_bf16_f32 v58, v60, v61
    v_cvt_pk_bf16_f32 v107, v110, v111
    v_mfma_f32_32x32x16_bf16 v[128:143], a[64:67], v[96:99], v[128:143]
    v_exp_f32 v121, v121
    v_cvt_pk_bf16_f32 v59, v62, v63
    v_fma_f32 v122, v122, s20, v23
    v_add_f32 v45, v45, v120
    s_nop 0
    v_mfma_f32_32x32x16_bf16 v[192:207], a[64:67], v[112:115], v[192:207]
    s_waitcnt lgkmcnt(2)
    ds_read_b64_tr_b16 a[80:81], v10 offset:12288
    ds_read_b64_tr_b16 a[82:83], v10 offset:14336
    v_exp_f32 v122, v122
    v_fma_f32 v123, v123, s20, v23
    v_add_f32 v45, v45, v121
    v_cvt_pk_bf16_f32 v120, v120, v121
    v_mfma_f32_32x32x16_bf16 v[144:159], a[68:71], v[96:99], v[144:159]
    v_permlane32_swap_b32 v56, v58
    v_exp_f32 v123, v123
    v_fma_f32 v124, v124, s20, v23
    v_add_f32 v45, v45, v122
    v_permlane32_swap_b32 v57, v59
    v_mfma_f32_32x32x16_bf16 v[208:223], a[68:71], v[112:115], v[208:223]
    ds_read_b64_tr_b16 a[84:85], v11 offset:12288
    ds_read_b64_tr_b16 a[86:87], v11 offset:14336
    v_exp_f32 v124, v124
    v_fma_f32 v125, v125, s20, v23
    v_add_f32 v45, v45, v123
    v_cvt_pk_bf16_f32 v121, v122, v123
    v_mfma_f32_32x32x16_bf16 v[160:175], a[72:75], v[96:99], v[160:175]
    v_exp_f32 v125, v125
    v_xor_b32 v26, 128, v19
    v_fma_f32 v126, v126, s20, v23
    v_add_f32 v45, v45, v124
    v_mfma_f32_32x32x16_bf16 v[224:239], a[72:75], v[112:115], v[224:239]
    s_waitcnt lgkmcnt(2)
    ds_read_b64_tr_b16 a[88:89], v12 offset:12288
    ds_read_b64_tr_b16 a[90:91], v12 offset:14336
    ds_write_b128 v27, v[56:59]
    v_exp_f32 v126, v126
    v_accvgpr_read_b32 v48, a224
    v_fma_f32 v127, v127, s20, v23
    v_add_f32 v45, v45, v125
    v_cvt_pk_bf16_f32 v122, v124, v125
    v_mfma_f32_32x32x16_bf16 v[176:191], a[76:79], v[96:99], v[176:191]
    v_accvgpr_read_b32 v49, a225
    v_exp_f32 v127, v127
    v_add_f32 v45, v45, v126
    v_add_f32 v45, v45, v127
    v_cvt_pk_bf16_f32 v123, v126, v127
    v_mfma_f32_32x32x16_bf16 v[240:255], a[76:79], v[112:115], v[240:255]
    ds_read_b64_tr_b16 a[92:93], v13 offset:12288
    ds_read_b64_tr_b16 a[94:95], v13 offset:14336
    v_accvgpr_read_b32 v50, a226
    v_fma_f32 v64, v64, s20, v22
    v_exp_f32 v64, v64
    v_fma_f32 v65, v65, s20, v22
    v_mfma_f32_32x32x16_bf16 v[128:143], a[80:83], v[104:107], v[128:143]
    v_accvgpr_read_b32 v51, a227
    v_exp_f32 v65, v65
    v_accvgpr_read_b32 v52, a228
    v_fma_f32 v66, v66, s20, v22
    v_add_f32 v44, v44, v64
    v_mfma_f32_32x32x16_bf16 v[192:207], a[80:83], v[120:123], v[192:207]
    s_waitcnt lgkmcnt(2)
    ds_read_b128 a[64:67], v2 offset:24576
    v_exp_f32 v66, v66
    v_accvgpr_read_b32 v53, a229
    v_fma_f32 v67, v67, s20, v22
    v_add_f32 v44, v44, v65
    v_cvt_pk_bf16_f32 v64, v64, v65
    v_mfma_f32_32x32x16_bf16 v[144:159], a[84:87], v[104:107], v[144:159]
    v_accvgpr_read_b32 v54, a230
    v_exp_f32 v67, v67
    v_fma_f32 v68, v68, s20, v22
    v_add_f32 v44, v44, v66
    v_accvgpr_read_b32 v55, a231
    v_mfma_f32_32x32x16_bf16 v[208:223], a[84:87], v[120:123], v[208:223]
    ds_read_b128 a[68:71], v3 offset:24576
    v_exp_f32 v68, v68
    v_fma_f32 v69, v69, s20, v22
    v_add_f32 v44, v44, v67
    v_cvt_pk_bf16_f32 v65, v66, v67
    v_mul_f32 v48, v48, v25
    v_mfma_f32_32x32x16_bf16 v[160:175], a[88:91], v[104:107], v[160:175]
    v_exp_f32 v69, v69
    v_fma_f32 v70, v70, s20, v22
    v_mul_f32 v49, v49, v25
    v_add_f32 v44, v44, v68
    v_mul_f32 v50, v50, v25
    v_mfma_f32_32x32x16_bf16 v[224:239], a[88:91], v[120:123], v[224:239]
    s_waitcnt lgkmcnt(1)
    ds_read_b128 a[72:75], v4 offset:24576
    v_exp_f32 v70, v70
    v_fma_f32 v71, v71, s20, v22
    v_add_f32 v44, v44, v69
    v_cvt_pk_bf16_f32 v66, v68, v69
    v_mfma_f32_32x32x16_bf16 v[176:191], a[92:95], v[104:107], v[176:191]
    v_mul_f32 v51, v51, v25
    v_exp_f32 v71, v71
    v_fma_f32 v80, v80, s20, v23
    v_add_f32 v44, v44, v70
    v_mul_f32 v52, v52, v25
    v_mfma_f32_32x32x16_bf16 v[240:255], a[92:95], v[120:123], v[240:255]
    ds_read_b128 a[76:79], v5 offset:24576
    v_exp_f32 v80, v80
    v_fma_f32 v81, v81, s20, v23
    v_add_f32 v44, v44, v71
    v_cvt_pk_bf16_f32 v67, v70, v71
    v_mul_f32 v53, v53, v25
    v_mfma_f32_32x32x16_bf16 v[96:111], a[64:67], a[96:99], 0
    v_exp_f32 v81, v81
    v_fma_f32 v82, v82, s20, v23
    v_mul_f32 v54, v54, v25
    v_add_f32 v45, v45, v80
    v_mul_f32 v55, v55, v25
    v_mfma_f32_32x32x16_bf16 v[112:127], a[64:67], a[32:35], 0
    s_waitcnt lgkmcnt(1)
    s_waitcnt vmcnt(20)
    ds_read_b128 a[80:83], v6 offset:24576
    v_exp_f32 v82, v82
    v_fma_f32 v83, v83, s20, v23
    v_add_f32 v45, v45, v81
    v_cvt_pk_bf16_f32 v80, v80, v81
    v_mfma_f32_32x32x16_bf16 v[96:111], a[68:71], a[100:103], v[96:111]
    s_barrier
    v_cvt_pk_bf16_f32 v48, v48, v49
    v_exp_f32 v83, v83
    v_fma_f32 v84, v84, s20, v23
    v_add_f32 v45, v45, v82
    v_cvt_pk_bf16_f32 v49, v50, v51
    v_mfma_f32_32x32x16_bf16 v[112:127], a[68:71], a[36:39], v[112:127]
    ds_read_b128 a[84:87], v7 offset:24576
    v_exp_f32 v84, v84
    v_fma_f32 v85, v85, s20, v23
    v_add_f32 v45, v45, v83
    v_cvt_pk_bf16_f32 v81, v82, v83
    v_cvt_pk_bf16_f32 v50, v52, v53
    v_mfma_f32_32x32x16_bf16 v[96:111], a[72:75], a[104:107], v[96:111]
    v_exp_f32 v85, v85
    v_fma_f32 v86, v86, s20, v23
    v_cvt_pk_bf16_f32 v51, v54, v55
    v_add_f32 v45, v45, v84
    s_nop 0
    v_mfma_f32_32x32x16_bf16 v[112:127], a[72:75], a[40:43], v[112:127]
    s_waitcnt lgkmcnt(1)
    ds_read_b128 a[88:91], v8 offset:24576
    v_exp_f32 v86, v86
    v_fma_f32 v87, v87, s20, v23
    v_add_f32 v45, v45, v85
    v_cvt_pk_bf16_f32 v82, v84, v85
    v_mfma_f32_32x32x16_bf16 v[96:111], a[76:79], a[108:111], v[96:111]
    v_permlane32_swap_b32 v48, v50
    v_exp_f32 v87, v87
    v_fma_f32 v72, v72, s20, v22
    v_add_f32 v45, v45, v86
    v_permlane32_swap_b32 v49, v51
    v_mfma_f32_32x32x16_bf16 v[112:127], a[76:79], a[44:47], v[112:127]
    ds_read_b128 a[92:95], v9 offset:24576
    v_exp_f32 v72, v72
    v_fma_f32 v73, v73, s20, v22
    v_add_f32 v45, v45, v87
    v_cvt_pk_bf16_f32 v83, v86, v87
    v_mfma_f32_32x32x16_bf16 v[96:111], a[80:83], a[112:115], v[96:111]
    ds_write_b128 v26, v[48:51]
    v_exp_f32 v73, v73
    v_fma_f32 v74, v74, s20, v22
    v_xor_b32 v27, 160, v19
    v_add_f32 v44, v44, v72
    v_accvgpr_read_b32 v56, a232
    v_mfma_f32_32x32x16_bf16 v[112:127], a[80:83], a[48:51], v[112:127]
    s_waitcnt lgkmcnt(2)
    ds_read_b64_tr_b16 a[64:65], v10 offset:16384
    ds_read_b64_tr_b16 a[66:67], v10 offset:18432
    v_exp_f32 v74, v74
    v_fma_f32 v75, v75, s20, v22
    v_add_f32 v44, v44, v73
    v_cvt_pk_bf16_f32 v72, v72, v73
    v_mfma_f32_32x32x16_bf16 v[96:111], a[84:87], a[116:119], v[96:111]
    v_accvgpr_read_b32 v57, a233
    v_exp_f32 v75, v75
    v_fma_f32 v76, v76, s20, v22
    v_add_f32 v44, v44, v74
    v_accvgpr_read_b32 v58, a234
    v_mfma_f32_32x32x16_bf16 v[112:127], a[84:87], a[52:55], v[112:127]
    ds_read_b64_tr_b16 a[68:69], v11 offset:16384
    ds_read_b64_tr_b16 a[70:71], v11 offset:18432
    v_exp_f32 v76, v76
    v_fma_f32 v77, v77, s20, v22
    v_add_f32 v44, v44, v75
    v_cvt_pk_bf16_f32 v73, v74, v75
    v_mfma_f32_32x32x16_bf16 v[96:111], a[88:91], a[120:123], v[96:111]
    v_accvgpr_read_b32 v59, a235
    v_exp_f32 v77, v77
    v_fma_f32 v78, v78, s20, v22
    v_accvgpr_read_b32 v60, a236
    v_add_f32 v44, v44, v76
    v_mfma_f32_32x32x16_bf16 v[112:127], a[88:91], a[56:59], v[112:127]
    s_waitcnt lgkmcnt(2)
    ds_read_b64_tr_b16 a[72:73], v12 offset:16384
    ds_read_b64_tr_b16 a[74:75], v12 offset:18432
    v_exp_f32 v78, v78
    v_fma_f32 v79, v79, s20, v22
    v_accvgpr_read_b32 v61, a237
    v_add_f32 v44, v44, v77
    v_cvt_pk_bf16_f32 v74, v76, v77
    v_mfma_f32_32x32x16_bf16 v[96:111], a[92:95], a[124:127], v[96:111]
    v_accvgpr_read_b32 v62, a238
    v_exp_f32 v79, v79
    v_fma_f32 v88, v88, s20, v23
    v_add_f32 v44, v44, v78
    v_accvgpr_read_b32 v63, a239
    v_mfma_f32_32x32x16_bf16 v[112:127], a[92:95], a[60:63], v[112:127]
    ds_read_b64_tr_b16 a[76:77], v13 offset:16384
    ds_read_b64_tr_b16 a[78:79], v13 offset:18432
    v_exp_f32 v88, v88
    v_fma_f32 v89, v89, s20, v23
    v_add_f32 v44, v44, v79
    v_cvt_pk_bf16_f32 v75, v78, v79
    v_mfma_f32_32x32x16_bf16 v[128:143], a[64:67], v[64:67], v[128:143]
    v_mul_f32 v56, v56, v25
    v_exp_f32 v89, v89
    v_fma_f32 v90, v90, s20, v23
    v_mul_f32 v57, v57, v25
    v_add_f32 v45, v45, v88
    v_mfma_f32_32x32x16_bf16 v[192:207], a[64:67], v[80:83], v[192:207]
    s_waitcnt lgkmcnt(2)
    ds_read_b64_tr_b16 a[80:81], v10 offset:20480
    ds_read_b64_tr_b16 a[82:83], v10 offset:22528
    v_exp_f32 v90, v90
    v_fma_f32 v91, v91, s20, v23
    v_mul_f32 v58, v58, v25
    v_add_f32 v45, v45, v89
    v_cvt_pk_bf16_f32 v88, v88, v89
    v_mfma_f32_32x32x16_bf16 v[144:159], a[68:71], v[64:67], v[144:159]
    v_mul_f32 v59, v59, v25
    v_exp_f32 v91, v91
    v_fma_f32 v92, v92, s20, v23
    v_add_f32 v45, v45, v90
    v_mul_f32 v60, v60, v25
    v_mfma_f32_32x32x16_bf16 v[208:223], a[68:71], v[80:83], v[208:223]
    ds_read_b64_tr_b16 a[84:85], v11 offset:20480
    ds_read_b64_tr_b16 a[86:87], v11 offset:22528
    v_exp_f32 v92, v92
    v_fma_f32 v93, v93, s20, v23
    v_add_f32 v45, v45, v91
    v_cvt_pk_bf16_f32 v89, v90, v91
    v_mfma_f32_32x32x16_bf16 v[160:175], a[72:75], v[64:67], v[160:175]
    v_mul_f32 v61, v61, v25
    v_exp_f32 v93, v93
    v_fma_f32 v94, v94, s20, v23
    v_mul_f32 v62, v62, v25
    v_add_f32 v45, v45, v92
    v_mfma_f32_32x32x16_bf16 v[224:239], a[72:75], v[80:83], v[224:239]
    s_waitcnt lgkmcnt(2)
    ds_read_b64_tr_b16 a[88:89], v12 offset:20480
    ds_read_b64_tr_b16 a[90:91], v12 offset:22528
    v_exp_f32 v94, v94
    v_fma_f32 v95, v95, s20, v23
    v_mul_f32 v63, v63, v25
    v_add_f32 v45, v45, v93
    v_cvt_pk_bf16_f32 v90, v92, v93
    v_mfma_f32_32x32x16_bf16 v[176:191], a[76:79], v[64:67], v[176:191]
    v_exp_f32 v95, v95
    v_cvt_pk_bf16_f32 v56, v56, v57
    v_add_f32 v45, v45, v94
    v_add_f32 v45, v45, v95
    v_cvt_pk_bf16_f32 v91, v94, v95
    v_mfma_f32_32x32x16_bf16 v[240:255], a[76:79], v[80:83], v[240:255]
    ds_read_b64_tr_b16 a[92:93], v13 offset:20480
    ds_read_b64_tr_b16 a[94:95], v13 offset:22528
    v_cvt_pk_bf16_f32 v57, v58, v59
    v_fma_f32 v96, v96, s20, v22
    v_exp_f32 v96, v96
    v_fma_f32 v97, v97, s20, v22
    v_mfma_f32_32x32x16_bf16 v[128:143], a[80:83], v[72:75], v[128:143]
    v_cvt_pk_bf16_f32 v58, v60, v61
    v_exp_f32 v97, v97
    v_fma_f32 v98, v98, s20, v22
    v_cvt_pk_bf16_f32 v59, v62, v63
    v_add_f32 v44, v44, v96
    v_mfma_f32_32x32x16_bf16 v[192:207], a[80:83], v[88:91], v[192:207]
    s_waitcnt lgkmcnt(2)
    ds_read_b128 a[64:67], v2 offset:32768
    v_exp_f32 v98, v98
    v_fma_f32 v99, v99, s20, v22
    s_nop 0
    v_add_f32 v44, v44, v97
    v_cvt_pk_bf16_f32 v96, v96, v97
    v_mfma_f32_32x32x16_bf16 v[144:159], a[84:87], v[72:75], v[144:159]
    v_permlane32_swap_b32 v56, v58
    v_exp_f32 v99, v99
    v_fma_f32 v100, v100, s20, v22
    v_add_f32 v44, v44, v98
    v_permlane32_swap_b32 v57, v59
    v_mfma_f32_32x32x16_bf16 v[208:223], a[84:87], v[88:91], v[208:223]
    ds_read_b128 a[68:71], v3 offset:32768
    v_exp_f32 v100, v100
    v_fma_f32 v101, v101, s20, v22
    v_add_f32 v44, v44, v99
    v_cvt_pk_bf16_f32 v97, v98, v99
    v_mfma_f32_32x32x16_bf16 v[160:175], a[88:91], v[72:75], v[160:175]
    ds_write_b128 v27, v[56:59]
    v_exp_f32 v101, v101
    v_fma_f32 v102, v102, s20, v22
    v_xor_b32 v26, 192, v19
    v_add_f32 v44, v44, v100
    v_accvgpr_read_b32 v48, a240
    v_mfma_f32_32x32x16_bf16 v[224:239], a[88:91], v[88:91], v[224:239]
    s_waitcnt lgkmcnt(2)
    ds_read_b128 a[72:75], v4 offset:32768
    v_exp_f32 v102, v102
    v_fma_f32 v103, v103, s20, v22
    v_add_f32 v44, v44, v101
    v_cvt_pk_bf16_f32 v98, v100, v101
    v_mfma_f32_32x32x16_bf16 v[176:191], a[92:95], v[72:75], v[176:191]
    v_accvgpr_read_b32 v49, a241
    v_exp_f32 v103, v103
    v_fma_f32 v112, v112, s20, v23
    v_add_f32 v44, v44, v102
    v_accvgpr_read_b32 v50, a242
    v_mfma_f32_32x32x16_bf16 v[240:255], a[92:95], v[88:91], v[240:255]
    ds_read_b128 a[76:79], v5 offset:32768
    v_exp_f32 v112, v112
    v_fma_f32 v113, v113, s20, v23
    v_add_f32 v44, v44, v103
    v_cvt_pk_bf16_f32 v99, v102, v103
    v_accvgpr_read_b32 v51, a243
    v_mfma_f32_32x32x16_bf16 v[64:79], a[64:67], a[96:99], 0
    v_exp_f32 v113, v113
    v_fma_f32 v114, v114, s20, v23
    v_accvgpr_read_b32 v52, a244
    v_add_f32 v45, v45, v112
    v_accvgpr_read_b32 v53, a245
    v_mfma_f32_32x32x16_bf16 v[80:95], a[64:67], a[32:35], 0
    s_waitcnt lgkmcnt(1)
    ds_read_b128 a[80:83], v6 offset:32768
    v_exp_f32 v114, v114
    v_fma_f32 v115, v115, s20, v23
    v_add_f32 v45, v45, v113
    v_cvt_pk_bf16_f32 v112, v112, v113
    v_mfma_f32_32x32x16_bf16 v[64:79], a[68:71], a[100:103], v[64:79]
    v_accvgpr_read_b32 v54, a246
    v_exp_f32 v115, v115
    v_fma_f32 v116, v116, s20, v23
    v_add_f32 v45, v45, v114
    v_accvgpr_read_b32 v55, a247
    v_mfma_f32_32x32x16_bf16 v[80:95], a[68:71], a[36:39], v[80:95]
    ds_read_b128 a[84:87], v7 offset:32768
    v_exp_f32 v116, v116
    v_fma_f32 v117, v117, s20, v23
    v_add_f32 v45, v45, v115
    v_cvt_pk_bf16_f32 v113, v114, v115
    v_mul_f32 v48, v48, v25
    v_mfma_f32_32x32x16_bf16 v[64:79], a[72:75], a[104:107], v[64:79]
    v_exp_f32 v117, v117
    v_fma_f32 v118, v118, s20, v23
    v_mul_f32 v49, v49, v25
    v_add_f32 v45, v45, v116
    v_mul_f32 v50, v50, v25
    v_mfma_f32_32x32x16_bf16 v[80:95], a[72:75], a[40:43], v[80:95]
    s_waitcnt lgkmcnt(1)
    ds_read_b128 a[88:91], v8 offset:32768
    v_exp_f32 v118, v118
    v_fma_f32 v119, v119, s20, v23
    v_add_f32 v45, v45, v117
    v_cvt_pk_bf16_f32 v114, v116, v117
    v_mfma_f32_32x32x16_bf16 v[64:79], a[76:79], a[108:111], v[64:79]
    v_mul_f32 v51, v51, v25
    v_exp_f32 v119, v119
    v_fma_f32 v104, v104, s20, v22
    v_add_f32 v45, v45, v118
    v_mul_f32 v52, v52, v25
    v_mfma_f32_32x32x16_bf16 v[80:95], a[76:79], a[44:47], v[80:95]
    ds_read_b128 a[92:95], v9 offset:32768
    v_exp_f32 v104, v104
    v_fma_f32 v105, v105, s20, v22
    v_add_f32 v45, v45, v119
    v_cvt_pk_bf16_f32 v115, v118, v119
    v_mul_f32 v53, v53, v25
    v_mfma_f32_32x32x16_bf16 v[64:79], a[80:83], a[112:115], v[64:79]
    v_exp_f32 v105, v105
    v_fma_f32 v106, v106, s20, v22
    v_mul_f32 v54, v54, v25
    v_add_f32 v44, v44, v104
    v_mul_f32 v55, v55, v25
    v_mfma_f32_32x32x16_bf16 v[80:95], a[80:83], a[48:51], v[80:95]
    s_waitcnt lgkmcnt(1)
    ds_read_b64_tr_b16 a[64:65], v10 offset:24576
    ds_read_b64_tr_b16 a[66:67], v10 offset:26624
    v_exp_f32 v106, v106
    v_fma_f32 v107, v107, s20, v22
    v_add_f32 v44, v44, v105
    v_cvt_pk_bf16_f32 v104, v104, v105
    v_mfma_f32_32x32x16_bf16 v[64:79], a[84:87], a[116:119], v[64:79]
    v_cvt_pk_bf16_f32 v48, v48, v49
    v_exp_f32 v107, v107
    v_fma_f32 v108, v108, s20, v22
    v_add_f32 v44, v44, v106
    v_cvt_pk_bf16_f32 v49, v50, v51
    v_mfma_f32_32x32x16_bf16 v[80:95], a[84:87], a[52:55], v[80:95]
    ds_read_b64_tr_b16 a[68:69], v11 offset:24576
    ds_read_b64_tr_b16 a[70:71], v11 offset:26624
    v_exp_f32 v108, v108
    v_fma_f32 v109, v109, s20, v22
    v_add_f32 v44, v44, v107
    v_cvt_pk_bf16_f32 v105, v106, v107
    v_mfma_f32_32x32x16_bf16 v[64:79], a[88:91], a[120:123], v[64:79]
    v_cvt_pk_bf16_f32 v50, v52, v53
    v_exp_f32 v109, v109
    v_fma_f32 v110, v110, s20, v22
    v_cvt_pk_bf16_f32 v51, v54, v55
    v_add_f32 v44, v44, v108
    v_mfma_f32_32x32x16_bf16 v[80:95], a[88:91], a[56:59], v[80:95]
    s_waitcnt lgkmcnt(2)
    ds_read_b64_tr_b16 a[72:73], v12 offset:24576
    ds_read_b64_tr_b16 a[74:75], v12 offset:26624
    v_exp_f32 v110, v110
    v_fma_f32 v111, v111, s20, v22
    s_nop 0
    v_add_f32 v44, v44, v109
    v_cvt_pk_bf16_f32 v106, v108, v109
    v_mfma_f32_32x32x16_bf16 v[64:79], a[92:95], a[124:127], v[64:79]
    v_permlane32_swap_b32 v48, v50
    v_exp_f32 v111, v111
    v_fma_f32 v120, v120, s20, v23
    v_add_f32 v44, v44, v110
    v_permlane32_swap_b32 v49, v51
    v_mfma_f32_32x32x16_bf16 v[80:95], a[92:95], a[60:63], v[80:95]
    ds_read_b64_tr_b16 a[76:77], v13 offset:24576
    ds_read_b64_tr_b16 a[78:79], v13 offset:26624
    v_exp_f32 v120, v120
    v_fma_f32 v121, v121, s20, v23
    v_add_f32 v44, v44, v111
    v_cvt_pk_bf16_f32 v107, v110, v111
    v_mfma_f32_32x32x16_bf16 v[128:143], a[64:67], v[96:99], v[128:143]
    v_exp_f32 v121, v121
    v_fma_f32 v122, v122, s20, v23
    v_xor_b32 v27, 224, v19
    v_add_f32 v45, v45, v120
    v_mfma_f32_32x32x16_bf16 v[192:207], a[64:67], v[112:115], v[192:207]
    s_waitcnt lgkmcnt(2)
    ds_read_b64_tr_b16 a[80:81], v10 offset:28672
    ds_read_b64_tr_b16 a[82:83], v10 offset:30720
    ds_write_b128 v26, v[48:51]
    v_exp_f32 v122, v122
    v_fma_f32 v123, v123, s20, v23
    v_accvgpr_read_b32 v56, a248
    v_add_f32 v45, v45, v121
    v_cvt_pk_bf16_f32 v120, v120, v121
    v_mfma_f32_32x32x16_bf16 v[144:159], a[68:71], v[96:99], v[144:159]
    v_accvgpr_read_b32 v57, a249
    v_exp_f32 v123, v123
    v_fma_f32 v124, v124, s20, v23
    v_add_f32 v45, v45, v122
    v_accvgpr_read_b32 v58, a250
    v_mfma_f32_32x32x16_bf16 v[208:223], a[68:71], v[112:115], v[208:223]
    ds_read_b64_tr_b16 a[84:85], v11 offset:28672
    ds_read_b64_tr_b16 a[86:87], v11 offset:30720
    v_exp_f32 v124, v124
    v_fma_f32 v125, v125, s20, v23
    v_add_f32 v45, v45, v123
    v_cvt_pk_bf16_f32 v121, v122, v123
    v_mfma_f32_32x32x16_bf16 v[160:175], a[72:75], v[96:99], v[160:175]
    v_accvgpr_read_b32 v59, a251
    v_exp_f32 v125, v125
    v_fma_f32 v126, v126, s20, v23
    v_accvgpr_read_b32 v60, a252
    v_add_f32 v45, v45, v124
    v_mfma_f32_32x32x16_bf16 v[224:239], a[72:75], v[112:115], v[224:239]
    s_waitcnt lgkmcnt(2)
    ds_read_b64_tr_b16 a[88:89], v12 offset:28672
    ds_read_b64_tr_b16 a[90:91], v12 offset:30720
    v_exp_f32 v126, v126
    v_fma_f32 v127, v127, s20, v23
    v_accvgpr_read_b32 v61, a253
    v_add_f32 v45, v45, v125
    v_cvt_pk_bf16_f32 v122, v124, v125
    v_mfma_f32_32x32x16_bf16 v[176:191], a[76:79], v[96:99], v[176:191]
    v_exp_f32 v127, v127
    v_accvgpr_read_b32 v62, a254
    v_add_f32 v45, v45, v126
    v_add_f32 v45, v45, v127
    v_cvt_pk_bf16_f32 v123, v126, v127
    v_mfma_f32_32x32x16_bf16 v[240:255], a[76:79], v[112:115], v[240:255]
    ds_read_b64_tr_b16 a[92:93], v13 offset:28672
    ds_read_b64_tr_b16 a[94:95], v13 offset:30720
    v_accvgpr_read_b32 v63, a255
    v_fma_f32 v64, v64, s20, v22
    v_exp_f32 v64, v64
    v_fma_f32 v65, v65, s20, v22
    v_mfma_f32_32x32x16_bf16 v[128:143], a[80:83], v[104:107], v[128:143]
    v_mul_f32 v56, v56, v25
    v_exp_f32 v65, v65
    v_fma_f32 v66, v66, s20, v22
    v_mul_f32 v57, v57, v25
    v_add_f32 v44, v44, v64
    v_mfma_f32_32x32x16_bf16 v[192:207], a[80:83], v[120:123], v[192:207]
    s_waitcnt lgkmcnt(2)
    ds_read_b128 a[64:67], v2 offset:40960
    v_exp_f32 v66, v66
    v_fma_f32 v67, v67, s20, v22
    v_mul_f32 v58, v58, v25
    v_add_f32 v44, v44, v65
    v_cvt_pk_bf16_f32 v64, v64, v65
    v_mfma_f32_32x32x16_bf16 v[144:159], a[84:87], v[104:107], v[144:159]
    v_mul_f32 v59, v59, v25
    v_exp_f32 v67, v67
    v_fma_f32 v68, v68, s20, v22
    v_add_f32 v44, v44, v66
    v_mul_f32 v60, v60, v25
    v_mfma_f32_32x32x16_bf16 v[208:223], a[84:87], v[120:123], v[208:223]
    ds_read_b128 a[68:71], v3 offset:40960
    v_exp_f32 v68, v68
    v_fma_f32 v69, v69, s20, v22
    v_add_f32 v44, v44, v67
    v_cvt_pk_bf16_f32 v65, v66, v67
    v_mul_f32 v61, v61, v25
    v_mfma_f32_32x32x16_bf16 v[160:175], a[88:91], v[104:107], v[160:175]
    v_exp_f32 v69, v69
    v_fma_f32 v70, v70, s20, v22
    v_mul_f32 v62, v62, v25
    v_add_f32 v44, v44, v68
    v_mul_f32 v63, v63, v25
    v_mfma_f32_32x32x16_bf16 v[224:239], a[88:91], v[120:123], v[224:239]
    s_waitcnt lgkmcnt(1)
    ds_read_b128 a[72:75], v4 offset:40960
    v_exp_f32 v70, v70
    v_fma_f32 v71, v71, s20, v22
    v_add_f32 v44, v44, v69
    v_cvt_pk_bf16_f32 v66, v68, v69
    v_mfma_f32_32x32x16_bf16 v[176:191], a[92:95], v[104:107], v[176:191]
    v_cvt_pk_bf16_f32 v56, v56, v57
    v_exp_f32 v71, v71
    v_fma_f32 v80, v80, s20, v23
    v_add_f32 v44, v44, v70
    v_cvt_pk_bf16_f32 v57, v58, v59
    v_mfma_f32_32x32x16_bf16 v[240:255], a[92:95], v[120:123], v[240:255]
    ds_read_b128 a[76:79], v5 offset:40960
    v_exp_f32 v80, v80
    v_fma_f32 v81, v81, s20, v23
    v_add_f32 v44, v44, v71
    v_cvt_pk_bf16_f32 v67, v70, v71
    v_cvt_pk_bf16_f32 v58, v60, v61
    v_mfma_f32_32x32x16_bf16 v[96:111], a[64:67], a[96:99], 0
    v_exp_f32 v81, v81
    v_fma_f32 v82, v82, s20, v23
    v_cvt_pk_bf16_f32 v59, v62, v63
    v_add_f32 v45, v45, v80
    s_nop 0
    v_mfma_f32_32x32x16_bf16 v[112:127], a[64:67], a[32:35], 0
    s_waitcnt lgkmcnt(1)
    s_waitcnt vmcnt(7)
    ds_read_b128 a[80:83], v6 offset:40960
    v_exp_f32 v82, v82
    v_fma_f32 v83, v83, s20, v23
    v_add_f32 v45, v45, v81
    v_cvt_pk_bf16_f32 v80, v80, v81
    v_mfma_f32_32x32x16_bf16 v[96:111], a[68:71], a[100:103], v[96:111]
    s_barrier
    v_permlane32_swap_b32 v56, v58
    v_exp_f32 v83, v83
    v_fma_f32 v84, v84, s20, v23
    v_add_f32 v45, v45, v82
    v_permlane32_swap_b32 v57, v59
    v_mfma_f32_32x32x16_bf16 v[112:127], a[68:71], a[36:39], v[112:127]
    ds_read_b128 a[84:87], v7 offset:40960
    v_exp_f32 v84, v84
    v_fma_f32 v85, v85, s20, v23
    v_add_f32 v45, v45, v83
    v_cvt_pk_bf16_f32 v81, v82, v83
    v_mfma_f32_32x32x16_bf16 v[96:111], a[72:75], a[104:107], v[96:111]
    ds_write_b128 v27, v[56:59]
    v_exp_f32 v85, v85
    v_fma_f32 v86, v86, s20, v23
    v_add_f32 v45, v45, v84
    v_mfma_f32_32x32x16_bf16 v[112:127], a[72:75], a[40:43], v[112:127]
    s_waitcnt lgkmcnt(2)
    ds_read_b128 a[88:91], v8 offset:40960
    ds_read_b128 a[192:195], v0 offset:0
    v_exp_f32 v86, v86
    v_fma_f32 v87, v87, s20, v23
    v_add_f32 v45, v45, v85
    v_cvt_pk_bf16_f32 v82, v84, v85
    v_mfma_f32_32x32x16_bf16 v[96:111], a[76:79], a[108:111], v[96:111]
    ds_read_b128 a[196:199], v0 offset:1024
    v_exp_f32 v87, v87
    v_fma_f32 v72, v72, s20, v22
    v_add_f32 v45, v45, v86
    v_mfma_f32_32x32x16_bf16 v[112:127], a[76:79], a[44:47], v[112:127]
    ds_read_b128 a[92:95], v9 offset:40960
    ds_read_b128 a[200:203], v0 offset:2048
    v_exp_f32 v72, v72
    v_fma_f32 v73, v73, s20, v22
    v_add_f32 v45, v45, v87
    v_cvt_pk_bf16_f32 v83, v86, v87
    v_mfma_f32_32x32x16_bf16 v[96:111], a[80:83], a[112:115], v[96:111]
    ds_read_b128 a[204:207], v0 offset:3072
    v_exp_f32 v73, v73
    v_fma_f32 v74, v74, s20, v22
    v_add_f32 v44, v44, v72
    v_mfma_f32_32x32x16_bf16 v[112:127], a[80:83], a[48:51], v[112:127]
    s_waitcnt lgkmcnt(3)
    ds_read_b64_tr_b16 a[64:65], v10 offset:32768
    ds_read_b64_tr_b16 a[66:67], v10 offset:34816
    ds_read_b128 a[208:211], v0 offset:4096
    v_exp_f32 v74, v74
    v_fma_f32 v75, v75, s20, v22
    v_add_f32 v44, v44, v73
    v_cvt_pk_bf16_f32 v72, v72, v73
    v_mfma_f32_32x32x16_bf16 v[96:111], a[84:87], a[116:119], v[96:111]
    ds_read_b128 a[212:215], v0 offset:5120
    v_exp_f32 v75, v75
    v_fma_f32 v76, v76, s20, v22
    v_add_f32 v44, v44, v74
    v_mfma_f32_32x32x16_bf16 v[112:127], a[84:87], a[52:55], v[112:127]
    ds_read_b64_tr_b16 a[68:69], v11 offset:32768
    ds_read_b64_tr_b16 a[70:71], v11 offset:34816
    ds_read_b128 a[216:219], v0 offset:6144
    v_exp_f32 v76, v76
    v_fma_f32 v77, v77, s20, v22
    v_add_f32 v44, v44, v75
    v_cvt_pk_bf16_f32 v73, v74, v75
    v_mfma_f32_32x32x16_bf16 v[96:111], a[88:91], a[120:123], v[96:111]
    ds_read_b128 a[220:223], v0 offset:7168
    v_exp_f32 v77, v77
    v_fma_f32 v78, v78, s20, v22
    v_add_f32 v44, v44, v76
    v_mfma_f32_32x32x16_bf16 v[112:127], a[88:91], a[56:59], v[112:127]
    s_waitcnt lgkmcnt(4)
    ds_read_b64_tr_b16 a[72:73], v12 offset:32768
    ds_read_b64_tr_b16 a[74:75], v12 offset:34816
    v_exp_f32 v78, v78
    v_fma_f32 v79, v79, s20, v22
    v_add_f32 v44, v44, v77
    v_cvt_pk_bf16_f32 v74, v76, v77
    v_mfma_f32_32x32x16_bf16 v[96:111], a[92:95], a[124:127], v[96:111]
    v_exp_f32 v79, v79
    v_fma_f32 v88, v88, s20, v23
    v_add_f32 v44, v44, v78
    v_mfma_f32_32x32x16_bf16 v[112:127], a[92:95], a[60:63], v[112:127]
    ds_read_b64_tr_b16 a[76:77], v13 offset:32768
    ds_read_b64_tr_b16 a[78:79], v13 offset:34816
    buffer_store_dwordx4 a[192:195], v14, s[16:19], s26 offen offset:0 sc1
    v_exp_f32 v88, v88
    v_fma_f32 v89, v89, s20, v23
    v_add_f32 v44, v44, v79
    v_cvt_pk_bf16_f32 v75, v78, v79
    v_mfma_f32_32x32x16_bf16 v[128:143], a[64:67], v[64:67], v[128:143]
    v_exp_f32 v89, v89
    v_fma_f32 v90, v90, s20, v23
    v_add_f32 v45, v45, v88
    v_mfma_f32_32x32x16_bf16 v[192:207], a[64:67], v[80:83], v[192:207]
    s_waitcnt lgkmcnt(2)
    ds_read_b64_tr_b16 a[80:81], v10 offset:36864
    ds_read_b64_tr_b16 a[82:83], v10 offset:38912
    v_exp_f32 v90, v90
    v_fma_f32 v91, v91, s20, v23
    v_add_f32 v45, v45, v89
    v_cvt_pk_bf16_f32 v88, v88, v89
    v_mfma_f32_32x32x16_bf16 v[144:159], a[68:71], v[64:67], v[144:159]
    v_exp_f32 v91, v91
    v_fma_f32 v92, v92, s20, v23
    v_add_f32 v45, v45, v90
    v_mfma_f32_32x32x16_bf16 v[208:223], a[68:71], v[80:83], v[208:223]
    ds_read_b64_tr_b16 a[84:85], v11 offset:36864
    ds_read_b64_tr_b16 a[86:87], v11 offset:38912
    v_exp_f32 v92, v92
    v_fma_f32 v93, v93, s20, v23
    v_add_f32 v45, v45, v91
    v_cvt_pk_bf16_f32 v89, v90, v91
    v_mfma_f32_32x32x16_bf16 v[160:175], a[72:75], v[64:67], v[160:175]
    v_exp_f32 v93, v93
    v_fma_f32 v94, v94, s20, v23
    v_add_f32 v45, v45, v92
    v_mfma_f32_32x32x16_bf16 v[224:239], a[72:75], v[80:83], v[224:239]
    s_waitcnt lgkmcnt(2)
    ds_read_b64_tr_b16 a[88:89], v12 offset:36864
    ds_read_b64_tr_b16 a[90:91], v12 offset:38912
    buffer_store_dwordx4 a[196:199], v15, s[16:19], s26 offen offset:1024 sc1
    v_exp_f32 v94, v94
    v_fma_f32 v95, v95, s20, v23
    v_add_f32 v45, v45, v93
    v_cvt_pk_bf16_f32 v90, v92, v93
    v_mfma_f32_32x32x16_bf16 v[176:191], a[76:79], v[64:67], v[176:191]
    v_exp_f32 v95, v95
    v_add_f32 v45, v45, v94
    v_add_f32 v45, v45, v95
    v_cvt_pk_bf16_f32 v91, v94, v95
    v_mfma_f32_32x32x16_bf16 v[240:255], a[76:79], v[80:83], v[240:255]
    ds_read_b64_tr_b16 a[92:93], v13 offset:36864
    ds_read_b64_tr_b16 a[94:95], v13 offset:38912
    v_fma_f32 v96, v96, s20, v22
    v_exp_f32 v96, v96
    v_fma_f32 v97, v97, s20, v22
    v_mfma_f32_32x32x16_bf16 v[128:143], a[80:83], v[72:75], v[128:143]
    v_exp_f32 v97, v97
    v_fma_f32 v98, v98, s20, v22
    v_add_f32 v44, v44, v96
    v_mfma_f32_32x32x16_bf16 v[192:207], a[80:83], v[88:91], v[192:207]
    s_waitcnt lgkmcnt(2)
    ds_read_b128 a[64:67], v2 offset:49152
    v_exp_f32 v98, v98
    v_fma_f32 v99, v99, s20, v22
    v_add_f32 v44, v44, v97
    v_cvt_pk_bf16_f32 v96, v96, v97
    v_mfma_f32_32x32x16_bf16 v[144:159], a[84:87], v[72:75], v[144:159]
    v_exp_f32 v99, v99
    v_fma_f32 v100, v100, s20, v22
    v_add_f32 v44, v44, v98
    v_mfma_f32_32x32x16_bf16 v[208:223], a[84:87], v[88:91], v[208:223]
    ds_read_b128 a[68:71], v3 offset:49152
    buffer_store_dwordx4 a[200:203], v16, s[16:19], s26 offen offset:2048 sc1
    v_exp_f32 v100, v100
    v_fma_f32 v101, v101, s20, v22
    v_add_f32 v44, v44, v99
    v_cvt_pk_bf16_f32 v97, v98, v99
    v_mfma_f32_32x32x16_bf16 v[160:175], a[88:91], v[72:75], v[160:175]
    v_exp_f32 v101, v101
    v_fma_f32 v102, v102, s20, v22
    v_add_f32 v44, v44, v100
    v_mfma_f32_32x32x16_bf16 v[224:239], a[88:91], v[88:91], v[224:239]
    s_waitcnt lgkmcnt(1)
    ds_read_b128 a[72:75], v4 offset:49152
    v_exp_f32 v102, v102
    v_fma_f32 v103, v103, s20, v22
    v_add_f32 v44, v44, v101
    v_cvt_pk_bf16_f32 v98, v100, v101
    v_mfma_f32_32x32x16_bf16 v[176:191], a[92:95], v[72:75], v[176:191]
    v_exp_f32 v103, v103
    v_fma_f32 v112, v112, s20, v23
    v_add_f32 v44, v44, v102
    v_mfma_f32_32x32x16_bf16 v[240:255], a[92:95], v[88:91], v[240:255]
    ds_read_b128 a[76:79], v5 offset:49152
    v_exp_f32 v112, v112
    v_fma_f32 v113, v113, s20, v23
    v_add_f32 v44, v44, v103
    v_cvt_pk_bf16_f32 v99, v102, v103
    v_mfma_f32_32x32x16_bf16 v[64:79], a[64:67], a[96:99], 0
    v_exp_f32 v113, v113
    v_fma_f32 v114, v114, s20, v23
    v_add_f32 v45, v45, v112
    v_mfma_f32_32x32x16_bf16 v[80:95], a[64:67], a[32:35], 0
    s_waitcnt lgkmcnt(1)
    ds_read_b128 a[80:83], v6 offset:49152
    buffer_store_dwordx4 a[204:207], v17, s[16:19], s26 offen offset:3072 sc1
    v_exp_f32 v114, v114
    v_fma_f32 v115, v115, s20, v23
    v_add_f32 v45, v45, v113
    v_cvt_pk_bf16_f32 v112, v112, v113
    v_mfma_f32_32x32x16_bf16 v[64:79], a[68:71], a[100:103], v[64:79]
    v_exp_f32 v115, v115
    v_fma_f32 v116, v116, s20, v23
    v_add_f32 v45, v45, v114
    v_mfma_f32_32x32x16_bf16 v[80:95], a[68:71], a[36:39], v[80:95]
    ds_read_b128 a[84:87], v7 offset:49152
    v_exp_f32 v116, v116
    v_fma_f32 v117, v117, s20, v23
    v_add_f32 v45, v45, v115
    v_cvt_pk_bf16_f32 v113, v114, v115
    v_mfma_f32_32x32x16_bf16 v[64:79], a[72:75], a[104:107], v[64:79]
    v_exp_f32 v117, v117
    v_fma_f32 v118, v118, s20, v23
    v_add_f32 v45, v45, v116
    v_mfma_f32_32x32x16_bf16 v[80:95], a[72:75], a[40:43], v[80:95]
    s_waitcnt lgkmcnt(1)
    ds_read_b128 a[88:91], v8 offset:49152
    v_exp_f32 v118, v118
    v_fma_f32 v119, v119, s20, v23
    v_add_f32 v45, v45, v117
    v_cvt_pk_bf16_f32 v114, v116, v117
    v_mfma_f32_32x32x16_bf16 v[64:79], a[76:79], a[108:111], v[64:79]
    v_exp_f32 v119, v119
    v_fma_f32 v104, v104, s20, v22
    v_add_f32 v45, v45, v118
    v_mfma_f32_32x32x16_bf16 v[80:95], a[76:79], a[44:47], v[80:95]
    ds_read_b128 a[92:95], v9 offset:49152
    buffer_store_dwordx4 a[208:211], v14, s[16:19], s69 offen offset:0 sc1
    v_exp_f32 v104, v104
    v_fma_f32 v105, v105, s20, v22
    v_add_f32 v45, v45, v119
    v_cvt_pk_bf16_f32 v115, v118, v119
    v_mfma_f32_32x32x16_bf16 v[64:79], a[80:83], a[112:115], v[64:79]
    v_exp_f32 v105, v105
    v_fma_f32 v106, v106, s20, v22
    v_add_f32 v44, v44, v104
    v_mfma_f32_32x32x16_bf16 v[80:95], a[80:83], a[48:51], v[80:95]
    s_waitcnt lgkmcnt(1)
    ds_read_b64_tr_b16 a[64:65], v10 offset:40960
    ds_read_b64_tr_b16 a[66:67], v10 offset:43008
    v_exp_f32 v106, v106
    v_fma_f32 v107, v107, s20, v22
    v_add_f32 v44, v44, v105
    v_cvt_pk_bf16_f32 v104, v104, v105
    v_mfma_f32_32x32x16_bf16 v[64:79], a[84:87], a[116:119], v[64:79]
    v_exp_f32 v107, v107
    v_fma_f32 v108, v108, s20, v22
    v_add_f32 v44, v44, v106
    v_mfma_f32_32x32x16_bf16 v[80:95], a[84:87], a[52:55], v[80:95]
    ds_read_b64_tr_b16 a[68:69], v11 offset:40960
    ds_read_b64_tr_b16 a[70:71], v11 offset:43008
    v_exp_f32 v108, v108
    v_fma_f32 v109, v109, s20, v22
    v_add_f32 v44, v44, v107
    v_cvt_pk_bf16_f32 v105, v106, v107
    v_mfma_f32_32x32x16_bf16 v[64:79], a[88:91], a[120:123], v[64:79]
    v_exp_f32 v109, v109
    v_fma_f32 v110, v110, s20, v22
    v_add_f32 v44, v44, v108
    v_mfma_f32_32x32x16_bf16 v[80:95], a[88:91], a[56:59], v[80:95]
    s_waitcnt lgkmcnt(2)
    ds_read_b64_tr_b16 a[72:73], v12 offset:40960
    ds_read_b64_tr_b16 a[74:75], v12 offset:43008
    buffer_store_dwordx4 a[212:215], v15, s[16:19], s69 offen offset:1024 sc1
    v_exp_f32 v110, v110
    v_fma_f32 v111, v111, s20, v22
    v_add_f32 v44, v44, v109
    v_cvt_pk_bf16_f32 v106, v108, v109
    v_mfma_f32_32x32x16_bf16 v[64:79], a[92:95], a[124:127], v[64:79]
    v_exp_f32 v111, v111
    v_fma_f32 v120, v120, s20, v23
    v_add_f32 v44, v44, v110
    v_mfma_f32_32x32x16_bf16 v[80:95], a[92:95], a[60:63], v[80:95]
    ds_read_b64_tr_b16 a[76:77], v13 offset:40960
    ds_read_b64_tr_b16 a[78:79], v13 offset:43008
    v_exp_f32 v120, v120
    v_fma_f32 v121, v121, s20, v23
    v_add_f32 v44, v44, v111
    v_cvt_pk_bf16_f32 v107, v110, v111
    v_mfma_f32_32x32x16_bf16 v[128:143], a[64:67], v[96:99], v[128:143]
    v_exp_f32 v121, v121
    v_fma_f32 v122, v122, s20, v23
    v_add_f32 v45, v45, v120
    v_mfma_f32_32x32x16_bf16 v[192:207], a[64:67], v[112:115], v[192:207]
    s_waitcnt lgkmcnt(2)
    ds_read_b64_tr_b16 a[80:81], v10 offset:45056
    ds_read_b64_tr_b16 a[82:83], v10 offset:47104
    v_exp_f32 v122, v122
    v_fma_f32 v123, v123, s20, v23
    v_add_f32 v45, v45, v121
    v_cvt_pk_bf16_f32 v120, v120, v121
    v_mfma_f32_32x32x16_bf16 v[144:159], a[68:71], v[96:99], v[144:159]
    v_exp_f32 v123, v123
    v_fma_f32 v124, v124, s20, v23
    v_add_f32 v45, v45, v122
    v_mfma_f32_32x32x16_bf16 v[208:223], a[68:71], v[112:115], v[208:223]
    ds_read_b64_tr_b16 a[84:85], v11 offset:45056
    ds_read_b64_tr_b16 a[86:87], v11 offset:47104
    buffer_store_dwordx4 a[216:219], v16, s[16:19], s69 offen offset:2048 sc1
    v_exp_f32 v124, v124
    v_fma_f32 v125, v125, s20, v23
    v_add_f32 v45, v45, v123
    v_cvt_pk_bf16_f32 v121, v122, v123
    v_mfma_f32_32x32x16_bf16 v[160:175], a[72:75], v[96:99], v[160:175]
    v_exp_f32 v125, v125
    v_fma_f32 v126, v126, s20, v23
    v_add_f32 v45, v45, v124
    v_mfma_f32_32x32x16_bf16 v[224:239], a[72:75], v[112:115], v[224:239]
    s_waitcnt lgkmcnt(2)
    ds_read_b64_tr_b16 a[88:89], v12 offset:45056
    ds_read_b64_tr_b16 a[90:91], v12 offset:47104
    v_exp_f32 v126, v126
    v_fma_f32 v127, v127, s20, v23
    v_add_f32 v45, v45, v125
    v_cvt_pk_bf16_f32 v122, v124, v125
    v_mfma_f32_32x32x16_bf16 v[176:191], a[76:79], v[96:99], v[176:191]
    v_exp_f32 v127, v127
    v_add_f32 v45, v45, v126
    v_add_f32 v45, v45, v127
    v_cvt_pk_bf16_f32 v123, v126, v127
    v_mfma_f32_32x32x16_bf16 v[240:255], a[76:79], v[112:115], v[240:255]
    ds_read_b64_tr_b16 a[92:93], v13 offset:45056
    ds_read_b64_tr_b16 a[94:95], v13 offset:47104
    v_fma_f32 v64, v64, s20, v22
    v_exp_f32 v64, v64
    v_fma_f32 v65, v65, s20, v22
    v_mfma_f32_32x32x16_bf16 v[128:143], a[80:83], v[104:107], v[128:143]
    v_exp_f32 v65, v65
    v_fma_f32 v66, v66, s20, v22
    v_add_f32 v44, v44, v64
    v_mfma_f32_32x32x16_bf16 v[192:207], a[80:83], v[120:123], v[192:207]
    s_waitcnt lgkmcnt(2)
    ds_read_b128 a[64:67], v2 offset:57344
    buffer_store_dwordx4 a[220:223], v17, s[16:19], s69 offen offset:3072 sc1
    v_exp_f32 v66, v66
    v_fma_f32 v67, v67, s20, v22
    v_add_f32 v44, v44, v65
    v_cvt_pk_bf16_f32 v64, v64, v65
    v_mfma_f32_32x32x16_bf16 v[144:159], a[84:87], v[104:107], v[144:159]
    v_exp_f32 v67, v67
    v_fma_f32 v68, v68, s20, v22
    v_add_f32 v44, v44, v66
    v_mfma_f32_32x32x16_bf16 v[208:223], a[84:87], v[120:123], v[208:223]
    ds_read_b128 a[68:71], v3 offset:57344
    v_exp_f32 v68, v68
    v_fma_f32 v69, v69, s20, v22
    v_add_f32 v44, v44, v67
    v_cvt_pk_bf16_f32 v65, v66, v67
    v_mfma_f32_32x32x16_bf16 v[160:175], a[88:91], v[104:107], v[160:175]
    v_exp_f32 v69, v69
    v_fma_f32 v70, v70, s20, v22
    v_add_f32 v44, v44, v68
    v_mfma_f32_32x32x16_bf16 v[224:239], a[88:91], v[120:123], v[224:239]
    s_waitcnt lgkmcnt(1)
    ds_read_b128 a[72:75], v4 offset:57344
    v_exp_f32 v70, v70
    v_fma_f32 v71, v71, s20, v22
    v_add_f32 v44, v44, v69
    v_cvt_pk_bf16_f32 v66, v68, v69
    v_mfma_f32_32x32x16_bf16 v[176:191], a[92:95], v[104:107], v[176:191]
    v_exp_f32 v71, v71
    v_fma_f32 v80, v80, s20, v23
    v_add_f32 v44, v44, v70
    v_mfma_f32_32x32x16_bf16 v[240:255], a[92:95], v[120:123], v[240:255]
    ds_read_b128 a[76:79], v5 offset:57344
    v_exp_f32 v80, v80
    v_fma_f32 v81, v81, s20, v23
    v_add_f32 v44, v44, v71
    v_cvt_pk_bf16_f32 v67, v70, v71
    v_mfma_f32_32x32x16_bf16 v[96:111], a[64:67], a[96:99], 0
    v_exp_f32 v81, v81
    v_fma_f32 v82, v82, s20, v23
    v_add_f32 v45, v45, v80
    v_mfma_f32_32x32x16_bf16 v[112:127], a[64:67], a[32:35], 0
    s_waitcnt lgkmcnt(1)
    s_waitcnt vmcnt(8)
    ds_read_b128 a[80:83], v6 offset:57344
    v_exp_f32 v82, v82
    v_fma_f32 v83, v83, s20, v23
    v_add_f32 v45, v45, v81
    v_cvt_pk_bf16_f32 v80, v80, v81
    v_mfma_f32_32x32x16_bf16 v[96:111], a[68:71], a[100:103], v[96:111]
    s_barrier
    v_exp_f32 v83, v83
    v_fma_f32 v84, v84, s20, v23
    v_add_f32 v45, v45, v82
    v_mfma_f32_32x32x16_bf16 v[112:127], a[68:71], a[36:39], v[112:127]
    ds_read_b128 a[84:87], v7 offset:57344
    v_exp_f32 v84, v84
    v_fma_f32 v85, v85, s20, v23
    v_add_f32 v45, v45, v83
    v_cvt_pk_bf16_f32 v81, v82, v83
    v_mfma_f32_32x32x16_bf16 v[96:111], a[72:75], a[104:107], v[96:111]
    v_exp_f32 v85, v85
    v_fma_f32 v86, v86, s20, v23
    v_add_f32 v45, v45, v84
    v_mfma_f32_32x32x16_bf16 v[112:127], a[72:75], a[40:43], v[112:127]
    s_waitcnt lgkmcnt(1)
    ds_read_b128 a[88:91], v8 offset:57344
    v_exp_f32 v86, v86
    v_fma_f32 v87, v87, s20, v23
    v_add_f32 v45, v45, v85
    v_cvt_pk_bf16_f32 v82, v84, v85
    v_mfma_f32_32x32x16_bf16 v[96:111], a[76:79], a[108:111], v[96:111]
    v_exp_f32 v87, v87
    v_fma_f32 v72, v72, s20, v22
    v_add_f32 v45, v45, v86
    v_mfma_f32_32x32x16_bf16 v[112:127], a[76:79], a[44:47], v[112:127]
    ds_read_b128 a[92:95], v9 offset:57344
    v_exp_f32 v72, v72
    v_fma_f32 v73, v73, s20, v22
    v_add_f32 v45, v45, v87
    v_cvt_pk_bf16_f32 v83, v86, v87
    v_mfma_f32_32x32x16_bf16 v[96:111], a[80:83], a[112:115], v[96:111]
    v_exp_f32 v73, v73
    v_fma_f32 v74, v74, s20, v22
    v_add_f32 v44, v44, v72
    v_mfma_f32_32x32x16_bf16 v[112:127], a[80:83], a[48:51], v[112:127]
    s_waitcnt lgkmcnt(1)
    ds_read_b64_tr_b16 a[64:65], v10 offset:49152
    ds_read_b64_tr_b16 a[66:67], v10 offset:51200
    v_exp_f32 v74, v74
    v_fma_f32 v75, v75, s20, v22
    v_add_f32 v44, v44, v73
    v_cvt_pk_bf16_f32 v72, v72, v73
    v_mfma_f32_32x32x16_bf16 v[96:111], a[84:87], a[116:119], v[96:111]
    v_exp_f32 v75, v75
    v_fma_f32 v76, v76, s20, v22
    v_add_f32 v44, v44, v74
    v_mfma_f32_32x32x16_bf16 v[112:127], a[84:87], a[52:55], v[112:127]
    ds_read_b64_tr_b16 a[68:69], v11 offset:49152
    ds_read_b64_tr_b16 a[70:71], v11 offset:51200
    v_exp_f32 v76, v76
    v_fma_f32 v77, v77, s20, v22
    v_add_f32 v44, v44, v75
    v_cvt_pk_bf16_f32 v73, v74, v75
    v_mfma_f32_32x32x16_bf16 v[96:111], a[88:91], a[120:123], v[96:111]
    v_exp_f32 v77, v77
    v_fma_f32 v78, v78, s20, v22
    v_add_f32 v44, v44, v76
    v_mfma_f32_32x32x16_bf16 v[112:127], a[88:91], a[56:59], v[112:127]
    s_waitcnt lgkmcnt(2)
    ds_read_b64_tr_b16 a[72:73], v12 offset:49152
    ds_read_b64_tr_b16 a[74:75], v12 offset:51200
    v_exp_f32 v78, v78
    v_fma_f32 v79, v79, s20, v22
    v_add_f32 v44, v44, v77
    v_cvt_pk_bf16_f32 v74, v76, v77
    v_mfma_f32_32x32x16_bf16 v[96:111], a[92:95], a[124:127], v[96:111]
    v_exp_f32 v79, v79
    v_fma_f32 v88, v88, s20, v23
    v_add_f32 v44, v44, v78
    v_mfma_f32_32x32x16_bf16 v[112:127], a[92:95], a[60:63], v[112:127]
    ds_read_b64_tr_b16 a[76:77], v13 offset:49152
    ds_read_b64_tr_b16 a[78:79], v13 offset:51200
    v_exp_f32 v88, v88
    v_fma_f32 v89, v89, s20, v23
    v_add_f32 v44, v44, v79
    v_cvt_pk_bf16_f32 v75, v78, v79
    v_mfma_f32_32x32x16_bf16 v[128:143], a[64:67], v[64:67], v[128:143]
    v_exp_f32 v89, v89
    v_fma_f32 v90, v90, s20, v23
    v_add_f32 v45, v45, v88
    v_mfma_f32_32x32x16_bf16 v[192:207], a[64:67], v[80:83], v[192:207]
    s_waitcnt lgkmcnt(2)
    ds_read_b64_tr_b16 a[80:81], v10 offset:53248
    ds_read_b64_tr_b16 a[82:83], v10 offset:55296
    v_exp_f32 v90, v90
    v_fma_f32 v91, v91, s20, v23
    v_add_f32 v45, v45, v89
    v_cvt_pk_bf16_f32 v88, v88, v89
    v_mfma_f32_32x32x16_bf16 v[144:159], a[68:71], v[64:67], v[144:159]
    v_exp_f32 v91, v91
    v_fma_f32 v92, v92, s20, v23
    v_add_f32 v45, v45, v90
    v_mfma_f32_32x32x16_bf16 v[208:223], a[68:71], v[80:83], v[208:223]
    ds_read_b64_tr_b16 a[84:85], v11 offset:53248
    ds_read_b64_tr_b16 a[86:87], v11 offset:55296
    v_exp_f32 v92, v92
    v_fma_f32 v93, v93, s20, v23
    v_add_f32 v45, v45, v91
    v_cvt_pk_bf16_f32 v89, v90, v91
    v_mfma_f32_32x32x16_bf16 v[160:175], a[72:75], v[64:67], v[160:175]
    v_exp_f32 v93, v93
    v_fma_f32 v94, v94, s20, v23
    v_add_f32 v45, v45, v92
    v_mfma_f32_32x32x16_bf16 v[224:239], a[72:75], v[80:83], v[224:239]
    s_waitcnt lgkmcnt(2)
    ds_read_b64_tr_b16 a[88:89], v12 offset:53248
    ds_read_b64_tr_b16 a[90:91], v12 offset:55296
    v_exp_f32 v94, v94
    v_fma_f32 v95, v95, s20, v23
    v_add_f32 v45, v45, v93
    v_cvt_pk_bf16_f32 v90, v92, v93
    v_mfma_f32_32x32x16_bf16 v[176:191], a[76:79], v[64:67], v[176:191]
    v_exp_f32 v95, v95
    v_add_f32 v45, v45, v94
    v_add_f32 v45, v45, v95
    v_cvt_pk_bf16_f32 v91, v94, v95
    v_mfma_f32_32x32x16_bf16 v[240:255], a[76:79], v[80:83], v[240:255]
    ds_read_b64_tr_b16 a[92:93], v13 offset:53248
    ds_read_b64_tr_b16 a[94:95], v13 offset:55296
    v_fma_f32 v96, v96, s20, v22
    v_exp_f32 v96, v96
    v_fma_f32 v97, v97, s20, v22
    v_mfma_f32_32x32x16_bf16 v[128:143], a[80:83], v[72:75], v[128:143]
    v_exp_f32 v97, v97
    v_fma_f32 v98, v98, s20, v22
    v_add_f32 v44, v44, v96
    v_mfma_f32_32x32x16_bf16 v[192:207], a[80:83], v[88:91], v[192:207]
    s_waitcnt lgkmcnt(2)
    ds_read_b128 a[64:67], v32 offset:0
    v_exp_f32 v98, v98
    v_fma_f32 v99, v99, s20, v22
    v_add_f32 v44, v44, v97
    v_cvt_pk_bf16_f32 v96, v96, v97
    v_mfma_f32_32x32x16_bf16 v[144:159], a[84:87], v[72:75], v[144:159]
    ds_read_b128 a[68:71], v32 offset:16384
    v_exp_f32 v99, v99
    v_fma_f32 v100, v100, s20, v22
    v_add_f32 v44, v44, v98
    v_mfma_f32_32x32x16_bf16 v[208:223], a[84:87], v[88:91], v[208:223]
    ds_read_b128 a[72:75], v33 offset:0
    v_exp_f32 v100, v100
    v_fma_f32 v101, v101, s20, v22
    v_add_f32 v44, v44, v99
    v_cvt_pk_bf16_f32 v97, v98, v99
    v_mfma_f32_32x32x16_bf16 v[160:175], a[88:91], v[72:75], v[160:175]
    ds_read_b128 a[76:79], v33 offset:16384
    v_exp_f32 v101, v101
    v_fma_f32 v102, v102, s20, v22
    v_add_f32 v44, v44, v100
    v_mfma_f32_32x32x16_bf16 v[224:239], a[88:91], v[88:91], v[224:239]
    s_waitcnt lgkmcnt(2)
    ds_read_b128 a[80:83], v34 offset:0
    v_exp_f32 v102, v102
    v_fma_f32 v103, v103, s20, v22
    v_add_f32 v44, v44, v101
    v_cvt_pk_bf16_f32 v98, v100, v101
    v_mfma_f32_32x32x16_bf16 v[176:191], a[92:95], v[72:75], v[176:191]
    ds_read_b128 a[84:87], v34 offset:16384
    v_exp_f32 v103, v103
    v_fma_f32 v112, v112, s20, v23
    v_add_f32 v44, v44, v102
    v_mfma_f32_32x32x16_bf16 v[240:255], a[92:95], v[88:91], v[240:255]
    ds_read_b128 a[88:91], v35 offset:0
    v_exp_f32 v112, v112
    v_fma_f32 v113, v113, s20, v23
    v_add_f32 v44, v44, v103
    v_cvt_pk_bf16_f32 v99, v102, v103
    v_mfma_f32_32x32x16_bf16 v[64:79], a[64:67], a[0:3], 0
    ds_read_b128 a[92:95], v35 offset:16384
    v_exp_f32 v113, v113
    v_fma_f32 v114, v114, s20, v23
    v_add_f32 v45, v45, v112
    v_mfma_f32_32x32x16_bf16 v[80:95], a[68:71], a[0:3], 0
    s_waitcnt lgkmcnt(2)
    ds_read_b128 a[64:67], v36 offset:0
    v_exp_f32 v114, v114
    v_fma_f32 v115, v115, s20, v23
    v_add_f32 v45, v45, v113
    v_cvt_pk_bf16_f32 v112, v112, v113
    v_mfma_f32_32x32x16_bf16 v[64:79], a[72:75], a[4:7], v[64:79]
    ds_read_b128 a[68:71], v36 offset:16384
    v_exp_f32 v115, v115
    v_fma_f32 v116, v116, s20, v23
    v_add_f32 v45, v45, v114
    v_mfma_f32_32x32x16_bf16 v[80:95], a[76:79], a[4:7], v[80:95]
    ds_read_b128 a[72:75], v37 offset:0
    v_exp_f32 v116, v116
    v_fma_f32 v117, v117, s20, v23
    v_add_f32 v45, v45, v115
    v_cvt_pk_bf16_f32 v113, v114, v115
    v_mfma_f32_32x32x16_bf16 v[64:79], a[80:83], a[8:11], v[64:79]
    ds_read_b128 a[76:79], v37 offset:16384
    v_exp_f32 v117, v117
    v_fma_f32 v118, v118, s20, v23
    v_add_f32 v45, v45, v116
    v_mfma_f32_32x32x16_bf16 v[80:95], a[84:87], a[8:11], v[80:95]
    s_waitcnt lgkmcnt(2)
    ds_read_b128 a[80:83], v38 offset:0
    v_exp_f32 v118, v118
    v_fma_f32 v119, v119, s20, v23
    v_add_f32 v45, v45, v117
    v_cvt_pk_bf16_f32 v114, v116, v117
    v_mfma_f32_32x32x16_bf16 v[64:79], a[88:91], a[12:15], v[64:79]
    ds_read_b128 a[84:87], v38 offset:16384
    v_exp_f32 v119, v119
    v_fma_f32 v104, v104, s20, v22
    v_add_f32 v45, v45, v118
    v_mfma_f32_32x32x16_bf16 v[80:95], a[92:95], a[12:15], v[80:95]
    ds_read_b128 a[88:91], v39 offset:0
    v_exp_f32 v104, v104
    v_fma_f32 v105, v105, s20, v22
    v_add_f32 v45, v45, v119
    v_cvt_pk_bf16_f32 v115, v118, v119
    v_mfma_f32_32x32x16_bf16 v[64:79], a[64:67], a[16:19], v[64:79]
    ds_read_b128 a[92:95], v39 offset:16384
    v_exp_f32 v105, v105
    v_fma_f32 v106, v106, s20, v22
    v_add_f32 v44, v44, v104
    v_mfma_f32_32x32x16_bf16 v[80:95], a[68:71], a[16:19], v[80:95]
    s_waitcnt lgkmcnt(2)
    ds_read_b64_tr_b16 a[64:65], v10 offset:57344
    ds_read_b64_tr_b16 a[66:67], v10 offset:59392
    v_exp_f32 v106, v106
    v_fma_f32 v107, v107, s20, v22
    v_add_f32 v44, v44, v105
    v_cvt_pk_bf16_f32 v104, v104, v105
    v_mfma_f32_32x32x16_bf16 v[64:79], a[72:75], a[20:23], v[64:79]
    v_exp_f32 v107, v107
    v_fma_f32 v108, v108, s20, v22
    v_add_f32 v44, v44, v106
    v_mfma_f32_32x32x16_bf16 v[80:95], a[76:79], a[20:23], v[80:95]
    ds_read_b64_tr_b16 a[68:69], v11 offset:57344
    ds_read_b64_tr_b16 a[70:71], v11 offset:59392
    v_exp_f32 v108, v108
    v_fma_f32 v109, v109, s20, v22
    v_add_f32 v44, v44, v107
    v_cvt_pk_bf16_f32 v105, v106, v107
    v_mfma_f32_32x32x16_bf16 v[64:79], a[80:83], a[24:27], v[64:79]
    v_exp_f32 v109, v109
    v_fma_f32 v110, v110, s20, v22
    v_add_f32 v44, v44, v108
    v_mfma_f32_32x32x16_bf16 v[80:95], a[84:87], a[24:27], v[80:95]
    s_waitcnt lgkmcnt(2)
    ds_read_b64_tr_b16 a[72:73], v12 offset:57344
    ds_read_b64_tr_b16 a[74:75], v12 offset:59392
    v_exp_f32 v110, v110
    v_fma_f32 v111, v111, s20, v22
    v_add_f32 v44, v44, v109
    v_cvt_pk_bf16_f32 v106, v108, v109
    v_mfma_f32_32x32x16_bf16 v[64:79], a[88:91], a[28:31], v[64:79]
    v_exp_f32 v111, v111
    v_fma_f32 v120, v120, s20, v23
    v_add_f32 v44, v44, v110
    v_mfma_f32_32x32x16_bf16 v[80:95], a[92:95], a[28:31], v[80:95]
    ds_read_b64_tr_b16 a[76:77], v13 offset:57344
    ds_read_b64_tr_b16 a[78:79], v13 offset:59392
    v_exp_f32 v120, v120
    v_fma_f32 v121, v121, s20, v23
    v_add_f32 v44, v44, v111
    v_cvt_pk_bf16_f32 v107, v110, v111
    v_mfma_f32_32x32x16_bf16 v[128:143], a[64:67], v[96:99], v[128:143]
    v_exp_f32 v121, v121
    v_fma_f32 v122, v122, s20, v23
    v_add_f32 v45, v45, v120
    v_mfma_f32_32x32x16_bf16 v[192:207], a[64:67], v[112:115], v[192:207]
    s_waitcnt lgkmcnt(2)
    s_barrier
    ds_read_b64_tr_b16 a[80:81], v10 offset:61440
    v_exp_f32 v122, v122
    v_fma_f32 v123, v123, s20, v23
    v_add_f32 v45, v45, v121
    v_cvt_pk_bf16_f32 v120, v120, v121
    v_mfma_f32_32x32x16_bf16 v[144:159], a[68:71], v[96:99], v[144:159]
    s_add_u32 m0, s22, 0
    s_add_u32 s23, s22, 0
    ds_read_b64_tr_b16 a[82:83], v10 offset:63488
    v_exp_f32 v123, v123
    v_fma_f32 v124, v124, s20, v23
    v_add_f32 v45, v45, v122
    v_mfma_f32_32x32x16_bf16 v[208:223], a[68:71], v[112:115], v[208:223]
    buffer_load_dwordx4 v14, s[8:11], s23 offen offset:0 lds
    ds_read_b64_tr_b16 a[84:85], v11 offset:61440
    v_exp_f32 v124, v124
    v_fma_f32 v125, v125, s20, v23
    v_add_f32 v45, v45, v123
    v_cvt_pk_bf16_f32 v121, v122, v123
    v_mfma_f32_32x32x16_bf16 v[160:175], a[72:75], v[96:99], v[160:175]
    buffer_load_dwordx4 v15, s[8:11], s23 offen offset:1024 lds
    ds_read_b64_tr_b16 a[86:87], v11 offset:63488
    v_exp_f32 v125, v125
    v_fma_f32 v126, v126, s20, v23
    v_add_f32 v45, v45, v124
    v_mfma_f32_32x32x16_bf16 v[224:239], a[72:75], v[112:115], v[224:239]
    s_waitcnt lgkmcnt(2)
    buffer_load_dwordx4 v16, s[8:11], s23 offen offset:2048 lds
    ds_read_b64_tr_b16 a[88:89], v12 offset:61440
    v_exp_f32 v126, v126
    v_fma_f32 v127, v127, s20, v23
    v_add_f32 v45, v45, v125
    v_cvt_pk_bf16_f32 v122, v124, v125
    v_mfma_f32_32x32x16_bf16 v[176:191], a[76:79], v[96:99], v[176:191]
    buffer_load_dwordx4 v17, s[8:11], s23 offen offset:3072 lds
    ds_read_b64_tr_b16 a[90:91], v12 offset:63488
    v_exp_f32 v127, v127
    v_add_f32 v45, v45, v126
    v_add_f32 v45, v45, v127
    v_cvt_pk_bf16_f32 v123, v126, v127
    v_mfma_f32_32x32x16_bf16 v[240:255], a[76:79], v[112:115], v[240:255]
    s_add_u32 m0, s22, 16384
    s_add_u32 s23, s22, 16384
    ds_read_b64_tr_b16 a[92:93], v13 offset:61440
    v_max3_f32 v56, v64, v65, v66
    v_max3_f32 v56, v56, v67, v68
    v_max3_f32 v56, v56, v69, v70
    v_max3_f32 v56, v56, v71, v72
    v_mfma_f32_32x32x16_bf16 v[128:143], a[80:83], v[104:107], v[128:143]
    buffer_load_dwordx4 v14, s[8:11], s23 offen offset:0 lds
    ds_read_b64_tr_b16 a[94:95], v13 offset:63488
    v_max3_f32 v56, v56, v73, v74
    v_max3_f32 v56, v56, v75, v76
    v_max3_f32 v56, v56, v77, v78
    v_max_f32 v56, v56, v79
    v_mov_b32 v57, v56
    v_mfma_f32_32x32x16_bf16 v[192:207], a[80:83], v[120:123], v[192:207]
    s_waitcnt lgkmcnt(2)
    buffer_load_dwordx4 v15, s[8:11], s23 offen offset:1024 lds
    ds_read_b128 a[64:67], v32 offset:32768
    s_nop 1
    v_permlane32_swap_b32 v56, v57
    v_max_f32 v56, v56, v57
    v_mul_f32 v22, s32, v56
    v_mfma_f32_32x32x16_bf16 v[144:159], a[84:87], v[104:107], v[144:159]
    buffer_load_dwordx4 v16, s[8:11], s23 offen offset:2048 lds
    ds_read_b64_tr_b16 a[68:69], v40 offset:0
    v_fma_f32 v64, v64, s20, v22
    v_exp_f32 v64, v64
    v_fma_f32 v65, v65, s20, v22
    v_mov_b32 v28, v44
    v_mfma_f32_32x32x16_bf16 v[208:223], a[84:87], v[120:123], v[208:223]
    buffer_load_dwordx4 v17, s[8:11], s23 offen offset:3072 lds
    ds_read_b64_tr_b16 a[70:71], v40 offset:2048
    v_exp_f32 v65, v65
    v_fma_f32 v66, v66, s20, v22
    v_mov_b32 v20, v64
    s_nop 1
    v_mfma_f32_32x32x16_bf16 v[160:175], a[88:91], v[104:107], v[160:175]
    ds_read_b128 a[72:75], v33 offset:32768
    ds_read_b64_tr_b16 a[76:77], v41 offset:0
    v_exp_f32 v66, v66
    v_fma_f32 v67, v67, s20, v22
    v_add_f32 v20, v20, v65
    v_cvt_pk_bf16_f32 v64, v64, v65
    v_mfma_f32_32x32x16_bf16 v[224:239], a[88:91], v[120:123], v[224:239]
    s_waitcnt lgkmcnt(3)
    ds_read_b64_tr_b16 a[78:79], v41 offset:2048
    ds_read_b128 a[80:83], v34 offset:32768
    v_exp_f32 v67, v67
    v_fma_f32 v68, v68, s20, v22
    v_add_f32 v20, v20, v66
    v_mfma_f32_32x32x16_bf16 v[176:191], a[92:95], v[104:107], v[176:191]
    ds_read_b64_tr_b16 a[84:85], v42 offset:0
    ds_read_b64_tr_b16 a[86:87], v42 offset:2048
    v_exp_f32 v68, v68
    v_fma_f32 v69, v69, s20, v22
    v_add_f32 v20, v20, v67
    v_cvt_pk_bf16_f32 v65, v66, v67
    v_exp_f32 v69, v69
    v_fma_f32 v70, v70, s20, v22
    v_add_f32 v20, v20, v68
    v_exp_f32 v70, v70
    v_fma_f32 v71, v71, s20, v22
    v_add_f32 v20, v20, v69
    v_cvt_pk_bf16_f32 v66, v68, v69
    v_exp_f32 v71, v71
    v_fma_f32 v72, v72, s20, v22
    v_add_f32 v20, v20, v70
    v_mfma_f32_32x32x16_bf16 v[240:255], a[92:95], v[120:123], v[240:255]
    ds_read_b128 a[88:91], v35 offset:32768
    v_exp_f32 v72, v72
    v_fma_f32 v73, v73, s20, v22
    v_add_f32 v20, v20, v71
    v_cvt_pk_bf16_f32 v67, v70, v71
    v_permlane32_swap_b32 v28, v44
    v_mfma_f32_32x32x16_bf16 v[96:111], a[64:67], a[0:3], 0
    s_waitcnt lgkmcnt(3)
    ds_read_b64_tr_b16 a[92:93], v43 offset:0
    ds_read_b64_tr_b16 a[94:95], v43 offset:2048
    v_exp_f32 v73, v73
    v_fma_f32 v74, v74, s20, v22
    v_add_f32 v20, v20, v72
    v_mfma_f32_32x32x16_bf16 a[128:143], a[68:71], v[64:67], 0
    ds_read_b128 a[64:67], v36 offset:32768
    v_exp_f32 v74, v74
    v_fma_f32 v75, v75, s20, v22
    v_add_f32 v20, v20, v73
    v_cvt_pk_bf16_f32 v72, v72, v73
    v_add_f32 v28, v28, v44
    v_mfma_f32_32x32x16_bf16 v[96:111], a[72:75], a[4:7], v[96:111]
    ds_read_b64_tr_b16 a[68:69], v40 offset:4096
    ds_read_b64_tr_b16 a[70:71], v40 offset:6144
    v_exp_f32 v75, v75
    v_fma_f32 v76, v76, s20, v22
    v_add_f32 v20, v20, v74
    v_cmp_nlt_f32_e64 s[44:45], v28, s30
    v_mfma_f32_32x32x16_bf16 a[144:159], a[76:79], v[64:67], 0
    ds_read_b128 a[72:75], v37 offset:32768
    v_exp_f32 v76, v76
    v_fma_f32 v77, v77, s20, v22
    v_add_f32 v20, v20, v75
    v_cvt_pk_bf16_f32 v73, v74, v75
    v_mfma_f32_32x32x16_bf16 v[96:111], a[80:83], a[8:11], v[96:111]
    s_waitcnt lgkmcnt(3)
    ds_read_b64_tr_b16 a[76:77], v41 offset:4096
    ds_read_b64_tr_b16 a[78:79], v41 offset:6144
    v_exp_f32 v77, v77
    v_fma_f32 v78, v78, s20, v22
    v_add_f32 v20, v20, v76
    v_mfma_f32_32x32x16_bf16 a[160:175], a[84:87], v[64:67], 0
    ds_read_b128 a[80:83], v38 offset:32768
    v_rcp_f32 v24, v28
    v_mov_b32 v29, v45
    s_nop 1
    v_exp_f32 v78, v78
    v_fma_f32 v79, v79, s20, v22
    v_add_f32 v20, v20, v77
    v_cvt_pk_bf16_f32 v74, v76, v77
    v_mfma_f32_32x32x16_bf16 v[96:111], a[88:91], a[12:15], v[96:111]
    ds_read_b64_tr_b16 a[84:85], v42 offset:4096
    ds_read_b64_tr_b16 a[86:87], v42 offset:6144
    v_permlane32_swap_b32 v29, v45
    v_add_f32 v29, v29, v45
    v_cmp_nlt_f32_e64 s[46:47], v29, s30
    v_rcp_f32 v25, v29
    v_xor_b32 v26, 0, v19
    v_exp_f32 v79, v79
    v_add_f32 v20, v20, v78
    v_mul_f32 v128, v128, v24
    v_add_f32 v20, v20, v79
    v_cvt_pk_bf16_f32 v75, v78, v79
    v_mfma_f32_32x32x16_bf16 a[176:191], a[92:95], v[64:67], 0
    ds_read_b128 a[88:91], v39 offset:32768
    v_mul_f32 v129, v129, v24
    v_mul_f32 v130, v130, v24
    v_fma_f32 v80, v80, s20, v22
    v_mul_f32 v131, v131, v24
    v_exp_f32 v80, v80
    v_fma_f32 v81, v81, s20, v22
    v_mfma_f32_32x32x16_bf16 v[96:111], a[64:67], a[16:19], v[96:111]
    s_waitcnt lgkmcnt(3)
    ds_read_b64_tr_b16 a[92:93], v43 offset:4096
    ds_read_b64_tr_b16 a[94:95], v43 offset:6144
    v_mul_f32 v132, v132, v24
    v_mul_f32 v133, v133, v24
    v_exp_f32 v81, v81
    v_mul_f32 v134, v134, v24
    v_fma_f32 v82, v82, s20, v22
    v_add_f32 v20, v20, v80
    v_mfma_f32_32x32x16_bf16 a[128:143], a[68:71], v[72:75], a[128:143]
    ds_read_b128 a[64:67], v32 offset:49152
    v_mul_f32 v135, v135, v24
    v_exp_f32 v82, v82
    v_cvt_pk_bf16_f32 v128, v128, v129
    v_fma_f32 v83, v83, s20, v22
    v_cvt_pk_bf16_f32 v129, v130, v131
    v_add_f32 v20, v20, v81
    v_cvt_pk_bf16_f32 v80, v80, v81
    v_mfma_f32_32x32x16_bf16 v[96:111], a[72:75], a[20:23], v[96:111]
    ds_read_b64_tr_b16 a[68:69], v40 offset:16384
    ds_read_b64_tr_b16 a[70:71], v40 offset:18432
    v_cvt_pk_bf16_f32 v130, v132, v133
    v_cvt_pk_bf16_f32 v131, v134, v135
    v_exp_f32 v83, v83
    v_fma_f32 v84, v84, s20, v22
    s_nop 0
    v_add_f32 v20, v20, v82
    v_mfma_f32_32x32x16_bf16 a[144:159], a[76:79], v[72:75], a[144:159]
    ds_read_b128 a[72:75], v33 offset:49152
    v_permlane32_swap_b32 v128, v130
    v_exp_f32 v84, v84
    v_permlane32_swap_b32 v129, v131
    v_fma_f32 v85, v85, s20, v22
    v_add_f32 v20, v20, v83
    v_cvt_pk_bf16_f32 v81, v82, v83
    v_mfma_f32_32x32x16_bf16 v[96:111], a[80:83], a[24:27], v[96:111]
    s_waitcnt lgkmcnt(3)
    ds_read_b64_tr_b16 a[76:77], v41 offset:16384
    ds_read_b64_tr_b16 a[78:79], v41 offset:18432
    ds_write_b128 v26, v[128:131]
    v_xor_b32 v27, 32, v19
    v_mul_f32 v136, v136, v24
    v_exp_f32 v85, v85
    v_fma_f32 v86, v86, s20, v22
    v_mul_f32 v137, v137, v24
    v_add_f32 v20, v20, v84
    v_mfma_f32_32x32x16_bf16 a[160:175], a[84:87], v[72:75], a[160:175]
    ds_read_b128 a[80:83], v34 offset:49152
    v_mul_f32 v138, v138, v24
    v_exp_f32 v86, v86
    v_mul_f32 v139, v139, v24
    v_fma_f32 v87, v87, s20, v22
    v_add_f32 v20, v20, v85
    v_mul_f32 v140, v140, v24
    v_cvt_pk_bf16_f32 v82, v84, v85
    v_mfma_f32_32x32x16_bf16 v[96:111], a[88:91], a[28:31], v[96:111]
    ds_read_b64_tr_b16 a[84:85], v42 offset:16384
    ds_read_b64_tr_b16 a[86:87], v42 offset:18432
    v_mul_f32 v141, v141, v24
    v_mul_f32 v142, v142, v24
    v_exp_f32 v87, v87
    v_fma_f32 v88, v88, s20, v22
    v_mul_f32 v143, v143, v24
    v_add_f32 v20, v20, v86
    v_mfma_f32_32x32x16_bf16 a[176:191], a[92:95], v[72:75], a[176:191]
    s_waitcnt vmcnt(4)
    ds_read_b128 a[88:91], v35 offset:49152
    v_cvt_pk_bf16_f32 v136, v136, v137
    v_exp_f32 v88, v88
    v_cvt_pk_bf16_f32 v137, v138, v139
    v_fma_f32 v89, v89, s20, v22
    v_add_f32 v20, v20, v87
    v_cvt_pk_bf16_f32 v138, v140, v141
    v_cvt_pk_bf16_f32 v83, v86, v87
    v_mfma_f32_32x32x16_bf16 v[112:127], a[64:67], a[0:3], 0
    s_waitcnt lgkmcnt(3)
    s_barrier
    ds_read_b64_tr_b16 a[92:93], v43 offset:16384
    v_cvt_pk_bf16_f32 v139, v142, v143
    s_nop 0
    v_exp_f32 v89, v89
    v_fma_f32 v90, v90, s20, v22
    v_permlane32_swap_b32 v136, v138
    v_add_f32 v20, v20, v88
    v_mfma_f32_32x32x16_bf16 a[128:143], a[68:71], v[80:83], a[128:143]
    s_add_u32 m0, s22, 32768
    s_add_u32 s23, s22, 32768
    ds_read_b64_tr_b16 a[94:95], v43 offset:18432
    v_permlane32_swap_b32 v137, v139
    v_exp_f32 v90, v90
    v_fma_f32 v91, v91, s20, v22
    v_add_f32 v20, v20, v89
    v_xor_b32 v26, 64, v19
    v_cvt_pk_bf16_f32 v88, v88, v89
    v_mfma_f32_32x32x16_bf16 v[112:127], a[72:75], a[4:7], v[112:127]
    buffer_load_dwordx4 v14, s[8:11], s23 offen offset:0 lds
    ds_read_b128 a[64:67], v36 offset:49152
    ds_write_b128 v27, v[136:139]
    v_mul_f32 v144, v144, v24
    v_mul_f32 v145, v145, v24
    v_exp_f32 v91, v91
    v_fma_f32 v92, v92, s20, v22
    v_mul_f32 v146, v146, v24
    v_add_f32 v20, v20, v90
    v_mfma_f32_32x32x16_bf16 a[144:159], a[76:79], v[80:83], a[144:159]
    buffer_load_dwordx4 v15, s[8:11], s23 offen offset:1024 lds
    ds_read_b64_tr_b16 a[68:69], v40 offset:20480
    v_mul_f32 v147, v147, v24
    v_exp_f32 v92, v92
    v_fma_f32 v93, v93, s20, v22
    v_mul_f32 v148, v148, v24
    v_add_f32 v20, v20, v91
    v_mul_f32 v149, v149, v24
    v_cvt_pk_bf16_f32 v89, v90, v91
    v_mfma_f32_32x32x16_bf16 v[112:127], a[80:83], a[8:11], v[112:127]
    s_waitcnt lgkmcnt(3)
    buffer_load_dwordx4 v16, s[8:11], s23 offen offset:2048 lds
    ds_read_b64_tr_b16 a[70:71], v40 offset:22528
    v_mul_f32 v150, v150, v24
    v_exp_f32 v93, v93
    v_mul_f32 v151, v151, v24
    v_fma_f32 v94, v94, s20, v22
    v_cvt_pk_bf16_f32 v144, v144, v145
    v_add_f32 v20, v20, v92
    v_mfma_f32_32x32x16_bf16 a[160:175], a[84:87], v[80:83], a[160:175]
    buffer_load_dwordx4 v17, s[8:11], s23 offen offset:3072 lds
    ds_read_b128 a[72:75], v37 offset:49152
    v_cvt_pk_bf16_f32 v145, v146, v147
    v_exp_f32 v94, v94
    v_fma_f32 v95, v95, s20, v22
    v_cvt_pk_bf16_f32 v146, v148, v149
    v_add_f32 v20, v20, v93
    v_cvt_pk_bf16_f32 v90, v92, v93
    v_mfma_f32_32x32x16_bf16 v[112:127], a[88:91], a[12:15], v[112:127]
    s_add_u32 m0, s22, 65536
    s_add_u32 s33, s22, 0
    ds_read_b64_tr_b16 a[76:77], v41 offset:20480
    v_cvt_pk_bf16_f32 v147, v150, v151
    s_nop 0
    v_exp_f32 v95, v95
    v_add_f32 v20, v20, v94
    v_permlane32_swap_b32 v144, v146
    v_add_f32 v20, v20, v95
    v_cvt_pk_bf16_f32 v91, v94, v95
    v_mfma_f32_32x32x16_bf16 a[176:191], a[92:95], v[80:83], a[176:191]
    s_waitcnt lgkmcnt(2)
    buffer_load_dwordx4 v18, s[12:15], s33 offen offset:0 lds
    ds_read_b64_tr_b16 a[78:79], v41 offset:22528
    v_permlane32_swap_b32 v145, v147
    v_fma_f32 v96, v96, s20, v22
    v_xor_b32 v27, 96, v19
    v_exp_f32 v96, v96
    v_fma_f32 v97, v97, s20, v22
    v_mfma_f32_32x32x16_bf16 v[112:127], a[64:67], a[16:19], v[112:127]
    buffer_load_dwordx4 v18, s[12:15], s33 offen offset:1024 lds
    ds_read_b128 a[80:83], v38 offset:49152
    ds_write_b128 v26, v[144:147]
    v_mul_f32 v152, v152, v24
    v_mul_f32 v153, v153, v24
    v_exp_f32 v97, v97
    v_mul_f32 v154, v154, v24
    v_fma_f32 v98, v98, s20, v22
    v_add_f32 v20, v20, v96
    v_mfma_f32_32x32x16_bf16 a[128:143], a[68:71], v[88:91], a[128:143]
    s_waitcnt lgkmcnt(3)
    buffer_load_dwordx4 v18, s[12:15], s33 offen offset:2048 lds
    ds_read_b64_tr_b16 a[84:85], v42 offset:20480
    ds_read_b64_tr_b16 a[86:87], v42 offset:22528
    v_mul_f32 v155, v155, v24
    v_mul_f32 v156, v156, v24
    v_exp_f32 v98, v98
    v_fma_f32 v99, v99, s20, v22
    v_mul_f32 v157, v157, v24
    v_add_f32 v20, v20, v97
    v_cvt_pk_bf16_f32 v96, v96, v97
    v_mfma_f32_32x32x16_bf16 v[112:127], a[72:75], a[20:23], v[112:127]
    s_waitcnt lgkmcnt(4)
    buffer_load_dwordx4 v18, s[12:15], s33 offen offset:3072 lds
    ds_read_b128 a[88:91], v39 offset:49152
    v_mul_f32 v158, v158, v24
    v_mul_f32 v159, v159, v24
    v_exp_f32 v99, v99
    v_cvt_pk_bf16_f32 v152, v152, v153
    v_fma_f32 v100, v100, s20, v22
    v_add_f32 v20, v20, v98
    v_mfma_f32_32x32x16_bf16 a[144:159], a[76:79], v[88:91], a[144:159]
    s_waitcnt lgkmcnt(3)
    ds_read_b64_tr_b16 a[92:93], v43 offset:20480
    ds_read_b64_tr_b16 a[94:95], v43 offset:22528
    v_cvt_pk_bf16_f32 v153, v154, v155
    v_cvt_pk_bf16_f32 v154, v156, v157
    v_exp_f32 v100, v100
    v_fma_f32 v101, v101, s20, v22
    v_cvt_pk_bf16_f32 v155, v158, v159
    v_add_f32 v20, v20, v99
    v_cvt_pk_bf16_f32 v97, v98, v99
    v_mfma_f32_32x32x16_bf16 v[112:127], a[80:83], a[24:27], v[112:127]
    s_waitcnt lgkmcnt(3)
    ds_read_b128 a[64:67], v32 offset:0
    ds_read_b64_tr_b16 a[68:69], v40 offset:32768
    s_nop 0
    v_permlane32_swap_b32 v152, v154
    v_exp_f32 v101, v101
    v_permlane32_swap_b32 v153, v155
    v_fma_f32 v102, v102, s20, v22
    v_add_f32 v20, v20, v100
    v_mfma_f32_32x32x16_bf16 a[160:175], a[84:87], v[88:91], a[160:175]
    s_waitcnt lgkmcnt(4)
    ds_read_b64_tr_b16 a[70:71], v40 offset:34816
    ds_read_b128 a[72:75], v33 offset:0
    v_exp_f32 v102, v102
    v_xor_b32 v26, 128, v19
    v_fma_f32 v103, v103, s20, v22
    v_mul_f32 v160, v160, v24
    v_add_f32 v20, v20, v101
    v_cvt_pk_bf16_f32 v98, v100, v101
    v_mfma_f32_32x32x16_bf16 v[112:127], a[88:91], a[28:31], v[112:127]
    s_waitcnt lgkmcnt(4)
    ds_read_b64_tr_b16 a[76:77], v41 offset:32768
    ds_read_b64_tr_b16 a[78:79], v41 offset:34816
    ds_write_b128 v27, v[152:155]
    v_mul_f32 v161, v161, v24
    v_mul_f32 v162, v162, v24
    v_exp_f32 v103, v103
    v_fma_f32 v104, v104, s20, v22
    v_mul_f32 v163, v163, v24
    v_add_f32 v20, v20, v102
    v_mfma_f32_32x32x16_bf16 a[176:191], a[92:95], v[88:91], a[176:191]
    s_waitcnt lgkmcnt(5)
    s_waitcnt vmcnt(8)
    ds_read_b128 a[80:83], v34 offset:0
    v_mul_f32 v164, v164, v24
    v_exp_f32 v104, v104
    v_mul_f32 v165, v165, v24
    v_fma_f32 v105, v105, s20, v22
    v_add_f32 v20, v20, v103
    v_mul_f32 v166, v166, v24
    v_cvt_pk_bf16_f32 v99, v102, v103
    v_mfma_f32_32x32x16_bf16 v[64:79], a[64:67], a[0:3], 0
    s_waitcnt lgkmcnt(4)
    s_barrier
    ds_read_b64_tr_b16 a[84:85], v42 offset:32768
    v_mul_f32 v167, v167, v24
    v_cvt_pk_bf16_f32 v160, v160, v161
    v_exp_f32 v105, v105
    v_fma_f32 v106, v106, s20, v22
    v_cvt_pk_bf16_f32 v161, v162, v163
    v_add_f32 v20, v20, v104
    v_mfma_f32_32x32x16_bf16 a[128:143], a[68:71], v[96:99], a[128:143]
    s_add_u32 m0, s22, 49152
    s_add_u32 s23, s22, 49152
    ds_read_b64_tr_b16 a[86:87], v42 offset:34816
    v_cvt_pk_bf16_f32 v162, v164, v165
    v_exp_f32 v106, v106
    v_cvt_pk_bf16_f32 v163, v166, v167
    v_fma_f32 v107, v107, s20, v22
    v_add_f32 v20, v20, v105
    s_nop 0
    v_cvt_pk_bf16_f32 v104, v104, v105
    v_mfma_f32_32x32x16_bf16 v[64:79], a[72:75], a[4:7], v[64:79]
    s_waitcnt lgkmcnt(2)
    buffer_load_dwordx4 v14, s[8:11], s23 offen offset:0 lds
    ds_read_b128 a[88:91], v35 offset:0
    v_permlane32_swap_b32 v160, v162
    v_permlane32_swap_b32 v161, v163
    v_exp_f32 v107, v107
    v_fma_f32 v108, v108, s20, v22
    v_add_f32 v20, v20, v106
    v_mfma_f32_32x32x16_bf16 a[144:159], a[76:79], v[96:99], a[144:159]
    buffer_load_dwordx4 v15, s[8:11], s23 offen offset:1024 lds
    ds_read_b64_tr_b16 a[92:93], v43 offset:32768
    ds_read_b64_tr_b16 a[94:95], v43 offset:34816
    ds_write_b128 v26, v[160:163]
    v_xor_b32 v27, 160, v19
    v_exp_f32 v108, v108
    v_mul_f32 v168, v168, v24
    v_fma_f32 v109, v109, s20, v22
    v_add_f32 v20, v20, v107
    v_mul_f32 v169, v169, v24
    v_cvt_pk_bf16_f32 v105, v106, v107
    v_mfma_f32_32x32x16_bf16 v[64:79], a[80:83], a[8:11], v[64:79]
    s_waitcnt lgkmcnt(4)
    buffer_load_dwordx4 v16, s[8:11], s23 offen offset:2048 lds
    ds_read_b128 a[64:67], v36 offset:0
    v_mul_f32 v170, v170, v24
    v_mul_f32 v171, v171, v24
    v_exp_f32 v109, v109
    v_fma_f32 v110, v110, s20, v22
    v_mul_f32 v172, v172, v24
    v_add_f32 v20, v20, v108
    v_mfma_f32_32x32x16_bf16 a[160:175], a[84:87], v[96:99], a[160:175]
    s_waitcnt lgkmcnt(4)
    buffer_load_dwordx4 v17, s[8:11], s23 offen offset:3072 lds
    ds_read_b64_tr_b16 a[68:69], v40 offset:36864
    ds_read_b64_tr_b16 a[70:71], v40 offset:38912
    v_mul_f32 v173, v173, v24
    v_exp_f32 v110, v110
    v_mul_f32 v174, v174, v24
    v_fma_f32 v111, v111, s20, v22
    v_add_f32 v20, v20, v109
    v_mul_f32 v175, v175, v24
    v_cvt_pk_bf16_f32 v106, v108, v109
    v_mfma_f32_32x32x16_bf16 v[64:79], a[88:91], a[12:15], v[64:79]
    s_waitcnt lgkmcnt(3)
    s_add_u32 m0, s22, 81920
    s_add_u32 s33, s22, 16384
    ds_read_b128 a[72:75], v37 offset:0
    v_cvt_pk_bf16_f32 v168, v168, v169
    v_exp_f32 v111, v111
    v_cvt_pk_bf16_f32 v169, v170, v171
    v_add_f32 v20, v20, v110
    v_add_f32 v20, v20, v111
    v_cvt_pk_bf16_f32 v170, v172, v173
    v_cvt_pk_bf16_f32 v107, v110, v111
    v_mfma_f32_32x32x16_bf16 a[176:191], a[92:95], v[96:99], a[176:191]
    s_waitcnt lgkmcnt(3)
    buffer_load_dwordx4 v18, s[12:15], s33 offen offset:0 lds
    ds_read_b64_tr_b16 a[76:77], v41 offset:36864
    ds_read_b64_tr_b16 a[78:79], v41 offset:38912
    v_cvt_pk_bf16_f32 v171, v174, v175
    v_fma_f32 v112, v112, s20, v22
    s_nop 0
    v_exp_f32 v112, v112
    v_permlane32_swap_b32 v168, v170
    v_fma_f32 v113, v113, s20, v22
    v_mfma_f32_32x32x16_bf16 v[64:79], a[64:67], a[16:19], v[64:79]
    s_waitcnt lgkmcnt(3)
    buffer_load_dwordx4 v18, s[12:15], s33 offen offset:1024 lds
    ds_read_b128 a[80:83], v38 offset:0
    v_permlane32_swap_b32 v169, v171
    v_exp_f32 v113, v113
    v_fma_f32 v114, v114, s20, v22
    v_add_f32 v20, v20, v112
    v_mfma_f32_32x32x16_bf16 a[128:143], a[68:71], v[104:107], a[128:143]
    s_waitcnt lgkmcnt(3)
    buffer_load_dwordx4 v18, s[12:15], s33 offen offset:2048 lds
    ds_read_b64_tr_b16 a[84:85], v42 offset:36864
    ds_read_b64_tr_b16 a[86:87], v42 offset:38912
    ds_write_b128 v27, v[168:171]
    v_xor_b32 v26, 192, v19
    v_mul_f32 v176, v176, v24
    v_exp_f32 v114, v114
    v_fma_f32 v115, v115, s20, v22
    v_mul_f32 v177, v177, v24
    v_add_f32 v20, v20, v113
    v_cvt_pk_bf16_f32 v112, v112, v113
    v_mfma_f32_32x32x16_bf16 v[64:79], a[72:75], a[20:23], v[64:79]
    s_waitcnt lgkmcnt(4)
    buffer_load_dwordx4 v18, s[12:15], s33 offen offset:3072 lds
    ds_read_b128 a[88:91], v39 offset:0
    v_mul_f32 v178, v178, v24
    v_mul_f32 v179, v179, v24
    v_exp_f32 v115, v115
    v_mul_f32 v180, v180, v24
    v_fma_f32 v116, v116, s20, v22
    v_add_f32 v20, v20, v114
    v_mfma_f32_32x32x16_bf16 a[144:159], a[76:79], v[104:107], a[144:159]
    s_waitcnt lgkmcnt(4)
    ds_read_b64_tr_b16 a[92:93], v43 offset:36864
    ds_read_b64_tr_b16 a[94:95], v43 offset:38912
    v_mul_f32 v181, v181, v24
    v_mul_f32 v182, v182, v24
    v_exp_f32 v116, v116
    v_fma_f32 v117, v117, s20, v22
    v_mul_f32 v183, v183, v24
    v_add_f32 v20, v20, v115
    v_cvt_pk_bf16_f32 v113, v114, v115
    v_mfma_f32_32x32x16_bf16 v[64:79], a[80:83], a[24:27], v[64:79]
    s_waitcnt lgkmcnt(3)
    ds_read_b128 a[64:67], v32 offset:16384
    ds_read_b64_tr_b16 a[68:69], v40 offset:49152
    v_cvt_pk_bf16_f32 v176, v176, v177
    v_cvt_pk_bf16_f32 v177, v178, v179
    v_exp_f32 v117, v117
    v_cvt_pk_bf16_f32 v178, v180, v181
    v_fma_f32 v118, v118, s20, v22
    v_add_f32 v20, v20, v116
    v_mfma_f32_32x32x16_bf16 a[160:175], a[84:87], v[104:107], a[160:175]
    s_waitcnt lgkmcnt(4)
    ds_read_b64_tr_b16 a[70:71], v40 offset:51200
    ds_read_b128 a[72:75], v33 offset:16384
    v_cvt_pk_bf16_f32 v179, v182, v183
    s_nop 0
    v_exp_f32 v118, v118
    v_fma_f32 v119, v119, s20, v22
    v_permlane32_swap_b32 v176, v178
    v_add_f32 v20, v20, v117
    v_cvt_pk_bf16_f32 v114, v116, v117
    v_mfma_f32_32x32x16_bf16 v[64:79], a[88:91], a[28:31], v[64:79]
    s_waitcnt lgkmcnt(4)
    ds_read_b64_tr_b16 a[76:77], v41 offset:49152
    ds_read_b64_tr_b16 a[78:79], v41 offset:51200
    v_permlane32_swap_b32 v177, v179
    v_exp_f32 v119, v119
    v_fma_f32 v120, v120, s20, v22
    v_xor_b32 v27, 224, v19
    v_add_f32 v20, v20, v118
    v_mfma_f32_32x32x16_bf16 a[176:191], a[92:95], v[104:107], a[176:191]
    s_waitcnt lgkmcnt(4)
    s_waitcnt vmcnt(8)
    ds_read_b128 a[80:83], v34 offset:16384
    ds_write_b128 v26, v[176:179]
    v_mul_f32 v184, v184, v24
    v_exp_f32 v120, v120
    v_mul_f32 v185, v185, v24
    v_fma_f32 v121, v121, s20, v22
    v_add_f32 v20, v20, v119
    v_mul_f32 v186, v186, v24
    v_cvt_pk_bf16_f32 v115, v118, v119
    v_mfma_f32_32x32x16_bf16 v[80:95], a[64:67], a[0:3], 0
    s_waitcnt lgkmcnt(4)
    s_barrier
    ds_read_b64_tr_b16 a[84:85], v42 offset:49152
    v_mul_f32 v187, v187, v24
    v_exp_f32 v121, v121
    v_fma_f32 v122, v122, s20, v22
    v_mul_f32 v188, v188, v24
    v_add_f32 v20, v20, v120
    v_mul_f32 v189, v189, v24
    v_mfma_f32_32x32x16_bf16 a[128:143], a[68:71], v[112:115], a[128:143]
    s_add_u32 m0, s22, 98304
    s_add_u32 s33, s22, 32768
    ds_read_b64_tr_b16 a[86:87], v42 offset:51200
    v_exp_f32 v122, v122
    v_fma_f32 v123, v123, s20, v22
    v_mul_f32 v190, v190, v24
    v_add_f32 v20, v20, v121
    v_cvt_pk_bf16_f32 v120, v120, v121
    v_mul_f32 v191, v191, v24
    v_cvt_pk_bf16_f32 v184, v184, v185
    v_mfma_f32_32x32x16_bf16 v[80:95], a[72:75], a[4:7], v[80:95]
    s_waitcnt lgkmcnt(2)
    buffer_load_dwordx4 v18, s[12:15], s33 offen offset:0 lds
    ds_read_b128 a[88:91], v35 offset:16384
    v_exp_f32 v123, v123
    v_fma_f32 v124, v124, s20, v22
    v_cvt_pk_bf16_f32 v185, v186, v187
    v_add_f32 v20, v20, v122
    v_cvt_pk_bf16_f32 v186, v188, v189
    v_cvt_pk_bf16_f32 v187, v190, v191
    v_mfma_f32_32x32x16_bf16 a[144:159], a[76:79], v[112:115], a[144:159]
    buffer_load_dwordx4 v18, s[12:15], s33 offen offset:1024 lds
    ds_read_b64_tr_b16 a[92:93], v43 offset:49152
    ds_read_b64_tr_b16 a[94:95], v43 offset:51200
    v_exp_f32 v124, v124
    v_fma_f32 v125, v125, s20, v22
    v_add_f32 v20, v20, v123
    v_cvt_pk_bf16_f32 v121, v122, v123
    s_nop 0
    v_permlane32_swap_b32 v184, v186
    v_permlane32_swap_b32 v185, v187
    v_mfma_f32_32x32x16_bf16 v[80:95], a[80:83], a[8:11], v[80:95]
    s_waitcnt lgkmcnt(3)
    buffer_load_dwordx4 v18, s[12:15], s33 offen offset:2048 lds
    ds_read_b128 a[64:67], v36 offset:16384
    v_exp_f32 v125, v125
    v_fma_f32 v126, v126, s20, v22
    v_add_f32 v20, v20, v124
    v_xor_b32 v26, 0, v19
    v_mfma_f32_32x32x16_bf16 a[160:175], a[84:87], v[112:115], a[160:175]
    s_waitcnt lgkmcnt(3)
    buffer_load_dwordx4 v18, s[12:15], s33 offen offset:3072 lds
    ds_read_b64_tr_b16 a[68:69], v40 offset:53248
    ds_read_b64_tr_b16 a[70:71], v40 offset:55296
    ds_write_b128 v27, v[184:187]
    ds_read_b128 v[128:131], v0 offset:0
    ds_read_b128 v[132:135], v0 offset:1024
    v_exp_f32 v126, v126
    v_fma_f32 v127, v127, s20, v22
    v_add_f32 v20, v20, v125
    v_cvt_pk_bf16_f32 v122, v124, v125
    v_mul_f32 v192, v192, v25
    v_mul_f32 v193, v193, v25
    v_mul_f32 v194, v194, v25
    v_mfma_f32_32x32x16_bf16 v[80:95], a[88:91], a[12:15], v[80:95]
    s_waitcnt lgkmcnt(6)
    ds_read_b128 a[72:75], v37 offset:16384
    ds_read_b64_tr_b16 a[76:77], v41 offset:53248
    ds_read_b128 v[136:139], v0 offset:2048
    ds_read_b128 v[140:143], v0 offset:3072
    v_exp_f32 v127, v127
    v_add_f32 v20, v20, v126
    v_add_f32 v20, v20, v127
    v_cvt_pk_bf16_f32 v123, v126, v127
    v_mul_f32 v195, v195, v25
    v_mul_f32 v196, v196, v25
    v_mul_f32 v197, v197, v25
    v_mfma_f32_32x32x16_bf16 a[176:191], a[92:95], v[112:115], a[176:191]
    s_waitcnt lgkmcnt(9)
    ds_read_b64_tr_b16 a[78:79], v41 offset:55296
    ds_read_b128 a[80:83], v38 offset:16384
    ds_read_b128 v[144:147], v0 offset:4096
    ds_read_b128 v[148:151], v0 offset:5120
    v_fma_f32 v64, v64, s20, v22
    v_exp_f32 v64, v64
    v_fma_f32 v65, v65, s20, v22
    v_mul_f32 v198, v198, v25
    v_mul_f32 v199, v199, v25
    v_cvt_pk_bf16_f32 v192, v192, v193
    v_mfma_f32_32x32x16_bf16 v[80:95], a[64:67], a[16:19], v[80:95]
    s_waitcnt lgkmcnt(8)
    ds_read_b64_tr_b16 a[84:85], v42 offset:53248
    ds_read_b64_tr_b16 a[86:87], v42 offset:55296
    ds_read_b128 v[152:155], v0 offset:6144
    ds_read_b128 v[156:159], v0 offset:7168
    v_exp_f32 v65, v65
    v_fma_f32 v66, v66, s20, v22
    v_add_f32 v20, v20, v64
    v_cvt_pk_bf16_f32 v193, v194, v195
    v_cvt_pk_bf16_f32 v194, v196, v197
    v_cvt_pk_bf16_f32 v195, v198, v199
    v_mfma_f32_32x32x16_bf16 a[128:143], a[68:71], v[120:123], a[128:143]
    s_waitcnt lgkmcnt(8)
    ds_read_b128 a[88:91], v39 offset:16384
    ds_read_b64_tr_b16 a[92:93], v43 offset:53248
    v_exp_f32 v66, v66
    v_fma_f32 v67, v67, s20, v22
    v_add_f32 v20, v20, v65
    v_cvt_pk_bf16_f32 v64, v64, v65
    s_nop 0
    v_permlane32_swap_b32 v192, v194
    v_permlane32_swap_b32 v193, v195
    v_mfma_f32_32x32x16_bf16 v[80:95], a[72:75], a[20:23], v[80:95]
    s_waitcnt lgkmcnt(6)
    ds_read_b64_tr_b16 a[94:95], v43 offset:55296
    ds_read_b128 a[64:67], v32 offset:32768
    v_exp_f32 v67, v67
    v_fma_f32 v68, v68, s20, v22
    v_add_f32 v20, v20, v66
    v_xor_b32 v27, 32, v19
    v_mul_f32 v200, v200, v25
    v_mfma_f32_32x32x16_bf16 a[144:159], a[76:79], v[120:123], a[144:159]
    ds_read_b64_tr_b16 a[68:69], v40 offset:0
    ds_read_b64_tr_b16 a[70:71], v40 offset:2048
    ds_write_b128 v26, v[192:195]
    v_exp_f32 v68, v68
    v_fma_f32 v69, v69, s20, v22
    v_add_f32 v20, v20, v67
    v_cvt_pk_bf16_f32 v65, v66, v67
    v_mul_f32 v201, v201, v25
    v_mul_f32 v202, v202, v25
    v_mul_f32 v203, v203, v25
    v_mfma_f32_32x32x16_bf16 v[80:95], a[80:83], a[24:27], v[80:95]
    s_waitcnt lgkmcnt(5)
    ds_read_b128 a[72:75], v33 offset:32768
    ds_read_b64_tr_b16 a[76:77], v41 offset:0
    v_exp_f32 v69, v69
    v_fma_f32 v70, v70, s20, v22
    v_add_f32 v20, v20, v68
    v_mul_f32 v204, v204, v25
    v_mul_f32 v205, v205, v25
    v_mfma_f32_32x32x16_bf16 a[160:175], a[84:87], v[120:123], a[160:175]
    ds_read_b64_tr_b16 a[78:79], v41 offset:2048
    ds_read_b128 a[80:83], v34 offset:32768
    v_exp_f32 v70, v70
    v_fma_f32 v71, v71, s20, v22
    v_add_f32 v20, v20, v69
    v_cvt_pk_bf16_f32 v66, v68, v69
    v_mul_f32 v206, v206, v25
    v_mul_f32 v207, v207, v25
    v_cvt_pk_bf16_f32 v200, v200, v201
    v_mfma_f32_32x32x16_bf16 v[80:95], a[88:91], a[28:31], v[80:95]
    s_waitcnt lgkmcnt(4)
    ds_read_b64_tr_b16 a[84:85], v42 offset:0
    ds_read_b64_tr_b16 a[86:87], v42 offset:2048
    v_exp_f32 v71, v71
    v_fma_f32 v72, v72, s20, v22
    v_add_f32 v20, v20, v70
    v_cvt_pk_bf16_f32 v201, v202, v203
    v_cvt_pk_bf16_f32 v202, v204, v205
    v_cvt_pk_bf16_f32 v203, v206, v207
    v_mfma_f32_32x32x16_bf16 a[176:191], a[92:95], v[120:123], a[176:191]
    s_waitcnt vmcnt(4)
    ds_read_b128 a[88:91], v35 offset:32768
    v_exp_f32 v72, v72
    v_fma_f32 v73, v73, s20, v22
    v_add_f32 v20, v20, v71
    v_cvt_pk_bf16_f32 v67, v70, v71
    s_nop 0
    v_permlane32_swap_b32 v200, v202
    v_permlane32_swap_b32 v201, v203
    v_mfma_f32_32x32x16_bf16 v[96:111], a[64:67], a[0:3], 0
    s_barrier
    ds_read_b64_tr_b16 a[92:93], v43 offset:0
    buffer_store_dwordx4 v[128:131], v14, s[16:19], s27 offen offset:0 sc1
    v_exp_f32 v73, v73
    v_fma_f32 v74, v74, s20, v22
    v_add_f32 v20, v20, v72
    v_xor_b32 v26, 64, v19
    v_mul_f32 v208, v208, v25
    v_mfma_f32_32x32x16_bf16 a[128:143], a[68:71], v[64:67], a[128:143]
    s_waitcnt lgkmcnt(2)
    s_add_u32 m0, s22, 114688
    s_add_u32 s33, s22, 49152
    ds_read_b64_tr_b16 a[94:95], v43 offset:2048
    ds_write_b128 v27, v[200:203]
    v_exp_f32 v74, v74
    v_fma_f32 v75, v75, s20, v22
    v_add_f32 v20, v20, v73
    v_cvt_pk_bf16_f32 v72, v72, v73
    v_mul_f32 v209, v209, v25
    v_mul_f32 v210, v210, v25
    v_mul_f32 v211, v211, v25
    v_mfma_f32_32x32x16_bf16 v[96:111], a[72:75], a[4:7], v[96:111]
    buffer_load_dwordx4 v18, s[12:15], s33 offen offset:0 lds
    ds_read_b128 a[64:67], v36 offset:32768
    v_exp_f32 v75, v75
    v_fma_f32 v76, v76, s20, v22
    v_add_f32 v20, v20, v74
    v_mul_f32 v212, v212, v25
    v_mul_f32 v213, v213, v25
    v_mul_f32 v214, v214, v25
    v_mfma_f32_32x32x16_bf16 a[144:159], a[76:79], v[64:67], a[144:159]
    buffer_load_dwordx4 v18, s[12:15], s33 offen offset:1024 lds
    ds_read_b64_tr_b16 a[68:69], v40 offset:4096
    buffer_store_dwordx4 v[132:135], v15, s[16:19], s27 offen offset:1024 sc1
    v_exp_f32 v76, v76
    v_fma_f32 v77, v77, s20, v22
    v_add_f32 v20, v20, v75
    v_cvt_pk_bf16_f32 v73, v74, v75
    v_mul_f32 v215, v215, v25
    v_cvt_pk_bf16_f32 v208, v208, v209
    v_cvt_pk_bf16_f32 v209, v210, v211
    v_mfma_f32_32x32x16_bf16 v[96:111], a[80:83], a[8:11], v[96:111]
    buffer_load_dwordx4 v18, s[12:15], s33 offen offset:2048 lds
    ds_read_b64_tr_b16 a[70:71], v40 offset:6144
    v_exp_f32 v77, v77
    v_fma_f32 v78, v78, s20, v22
    v_add_f32 v20, v20, v76
    v_cvt_pk_bf16_f32 v210, v212, v213
    v_cvt_pk_bf16_f32 v211, v214, v215
    s_nop 0
    v_mfma_f32_32x32x16_bf16 a[160:175], a[84:87], v[64:67], a[160:175]
    s_waitcnt lgkmcnt(2)
    buffer_load_dwordx4 v18, s[12:15], s33 offen offset:3072 lds
    ds_read_b128 a[72:75], v37 offset:32768
    v_exp_f32 v78, v78
    v_fma_f32 v79, v79, s20, v22
    v_add_f32 v20, v20, v77
    v_cvt_pk_bf16_f32 v74, v76, v77
    v_permlane32_swap_b32 v208, v210
    v_permlane32_swap_b32 v209, v211
    v_mfma_f32_32x32x16_bf16 v[96:111], a[88:91], a[12:15], v[96:111]
    ds_read_b64_tr_b16 a[76:77], v41 offset:4096
    ds_read_b64_tr_b16 a[78:79], v41 offset:6144
    buffer_store_dwordx4 v[136:139], v16, s[16:19], s27 offen offset:2048 sc1
    ds_write_b128 v26, v[208:211]
    v_exp_f32 v79, v79
    v_add_f32 v20, v20, v78
    v_add_f32 v20, v20, v79
    v_cvt_pk_bf16_f32 v75, v78, v79
    v_xor_b32 v27, 96, v19
    v_mul_f32 v216, v216, v25
    v_mul_f32 v217, v217, v25
    v_mfma_f32_32x32x16_bf16 a[176:191], a[92:95], v[64:67], a[176:191]
    ds_read_b128 a[80:83], v38 offset:32768
    ds_read_b64_tr_b16 a[84:85], v42 offset:4096
    v_fma_f32 v80, v80, s20, v22
    v_exp_f32 v80, v80
    v_fma_f32 v81, v81, s20, v22
    v_mul_f32 v218, v218, v25
    v_mul_f32 v219, v219, v25
    v_mul_f32 v220, v220, v25
    v_mfma_f32_32x32x16_bf16 v[96:111], a[64:67], a[16:19], v[96:111]
    s_waitcnt lgkmcnt(5)
    ds_read_b64_tr_b16 a[86:87], v42 offset:6144
    ds_read_b128 a[88:91], v39 offset:32768
    v_exp_f32 v81, v81
    v_fma_f32 v82, v82, s20, v22
    v_add_f32 v20, v20, v80
    v_mul_f32 v221, v221, v25
    v_mul_f32 v222, v222, v25
    v_mul_f32 v223, v223, v25
    v_mfma_f32_32x32x16_bf16 a[128:143], a[68:71], v[72:75], a[128:143]
    ds_read_b64_tr_b16 a[92:93], v43 offset:4096
    ds_read_b64_tr_b16 a[94:95], v43 offset:6144
    buffer_store_dwordx4 v[140:143], v17, s[16:19], s27 offen offset:3072 sc1
    v_exp_f32 v82, v82
    v_fma_f32 v83, v83, s20, v22
    v_add_f32 v20, v20, v81
    v_cvt_pk_bf16_f32 v80, v80, v81
    v_cvt_pk_bf16_f32 v216, v216, v217
    v_cvt_pk_bf16_f32 v217, v218, v219
    v_cvt_pk_bf16_f32 v218, v220, v221
    v_mfma_f32_32x32x16_bf16 v[96:111], a[72:75], a[20:23], v[96:111]
    s_waitcnt lgkmcnt(4)
    ds_read_b128 a[64:67], v32 offset:49152
    ds_read_b64_tr_b16 a[68:69], v40 offset:16384
    v_exp_f32 v83, v83
    v_fma_f32 v84, v84, s20, v22
    v_add_f32 v20, v20, v82
    v_cvt_pk_bf16_f32 v219, v222, v223
    s_nop 0
    v_permlane32_swap_b32 v216, v218
    v_mfma_f32_32x32x16_bf16 a[144:159], a[76:79], v[72:75], a[144:159]
    ds_read_b64_tr_b16 a[70:71], v40 offset:18432
    ds_read_b128 a[72:75], v33 offset:49152
    v_exp_f32 v84, v84
    v_fma_f32 v85, v85, s20, v22
    v_add_f32 v20, v20, v83
    v_cvt_pk_bf16_f32 v81, v82, v83
    v_permlane32_swap_b32 v217, v219
    v_xor_b32 v26, 128, v19
    v_mfma_f32_32x32x16_bf16 v[96:111], a[80:83], a[24:27], v[96:111]
    s_waitcnt lgkmcnt(4)
    ds_read_b64_tr_b16 a[76:77], v41 offset:16384
    ds_read_b64_tr_b16 a[78:79], v41 offset:18432
    buffer_store_dwordx4 v[144:147], v14, s[16:19], s70 offen offset:0 sc1
    ds_write_b128 v27, v[216:219]
    v_exp_f32 v85, v85
    v_fma_f32 v86, v86, s20, v22
    v_add_f32 v20, v20, v84
    v_mul_f32 v224, v224, v25
    v_mul_f32 v225, v225, v25
    v_mul_f32 v226, v226, v25
    v_mfma_f32_32x32x16_bf16 a[160:175], a[84:87], v[72:75], a[160:175]
    ds_read_b128 a[80:83], v34 offset:49152
    v_exp_f32 v86, v86
    v_fma_f32 v87, v87, s20, v22
    v_add_f32 v20, v20, v85
    v_cvt_pk_bf16_f32 v82, v84, v85
    v_mul_f32 v227, v227, v25
    v_mul_f32 v228, v228, v25
    v_mul_f32 v229, v229, v25
    v_mfma_f32_32x32x16_bf16 v[96:111], a[88:91], a[28:31], v[96:111]
    ds_read_b64_tr_b16 a[84:85], v42 offset:16384
    ds_read_b64_tr_b16 a[86:87], v42 offset:18432
    v_exp_f32 v87, v87
    v_fma_f32 v88, v88, s20, v22
    v_add_f32 v20, v20, v86
    v_mul_f32 v230, v230, v25
    v_mul_f32 v231, v231, v25
    v_cvt_pk_bf16_f32 v224, v224, v225
    v_mfma_f32_32x32x16_bf16 a[176:191], a[92:95], v[72:75], a[176:191]
    s_waitcnt lgkmcnt(3)
    s_waitcnt vmcnt(9)
    ds_read_b128 a[88:91], v35 offset:49152
    buffer_store_dwordx4 v[148:151], v15, s[16:19], s70 offen offset:1024 sc1
    v_exp_f32 v88, v88
    v_fma_f32 v89, v89, s20, v22
    v_add_f32 v20, v20, v87
    v_cvt_pk_bf16_f32 v83, v86, v87
    v_cvt_pk_bf16_f32 v225, v226, v227
    v_cvt_pk_bf16_f32 v226, v228, v229
    v_mfma_f32_32x32x16_bf16 v[112:127], a[64:67], a[0:3], 0
    s_barrier
    ds_read_b64_tr_b16 a[92:93], v43 offset:16384
    v_exp_f32 v89, v89
    v_fma_f32 v90, v90, s20, v22
    v_add_f32 v20, v20, v88
    v_cvt_pk_bf16_f32 v227, v230, v231
    s_nop 0
    v_permlane32_swap_b32 v224, v226
    v_mfma_f32_32x32x16_bf16 a[128:143], a[68:71], v[80:83], a[128:143]
    ds_read_b64_tr_b16 a[94:95], v43 offset:18432
    ds_read_b128 a[64:67], v36 offset:49152
    v_exp_f32 v90, v90
    v_fma_f32 v91, v91, s20, v22
    v_add_f32 v20, v20, v89
    v_cvt_pk_bf16_f32 v88, v88, v89
    v_permlane32_swap_b32 v225, v227
    v_xor_b32 v27, 160, v19
    v_mfma_f32_32x32x16_bf16 v[112:127], a[72:75], a[4:7], v[112:127]
    ds_read_b64_tr_b16 a[68:69], v40 offset:20480
    ds_read_b64_tr_b16 a[70:71], v40 offset:22528
    buffer_store_dwordx4 v[152:155], v16, s[16:19], s70 offen offset:2048 sc1
    ds_write_b128 v26, v[224:227]
    v_exp_f32 v91, v91
    v_fma_f32 v92, v92, s20, v22
    v_add_f32 v20, v20, v90
    v_mul_f32 v232, v232, v25
    v_mul_f32 v233, v233, v25
    v_mul_f32 v234, v234, v25
    v_mfma_f32_32x32x16_bf16 a[144:159], a[76:79], v[80:83], a[144:159]
    s_waitcnt lgkmcnt(5)
    ds_read_b128 a[72:75], v37 offset:49152
    v_exp_f32 v92, v92
    v_fma_f32 v93, v93, s20, v22
    v_add_f32 v20, v20, v91
    v_cvt_pk_bf16_f32 v89, v90, v91
    v_mul_f32 v235, v235, v25
    v_mul_f32 v236, v236, v25
    v_mul_f32 v237, v237, v25
    v_mfma_f32_32x32x16_bf16 v[112:127], a[80:83], a[8:11], v[112:127]
    ds_read_b64_tr_b16 a[76:77], v41 offset:20480
    ds_read_b64_tr_b16 a[78:79], v41 offset:22528
    v_exp_f32 v93, v93
    v_fma_f32 v94, v94, s20, v22
    v_add_f32 v20, v20, v92
    v_mul_f32 v238, v238, v25
    v_mul_f32 v239, v239, v25
    v_cvt_pk_bf16_f32 v232, v232, v233
    v_mfma_f32_32x32x16_bf16 a[160:175], a[84:87], v[80:83], a[160:175]
    ds_read_b128 a[80:83], v38 offset:49152
    buffer_store_dwordx4 v[156:159], v17, s[16:19], s70 offen offset:3072 sc1
    v_exp_f32 v94, v94
    v_fma_f32 v95, v95, s20, v22
    v_add_f32 v20, v20, v93
    v_cvt_pk_bf16_f32 v90, v92, v93
    v_cvt_pk_bf16_f32 v233, v234, v235
    v_cvt_pk_bf16_f32 v234, v236, v237
    v_cvt_pk_bf16_f32 v235, v238, v239
    v_mfma_f32_32x32x16_bf16 v[112:127], a[88:91], a[12:15], v[112:127]
    s_waitcnt lgkmcnt(3)
    ds_read_b64_tr_b16 a[84:85], v42 offset:20480
    ds_read_b64_tr_b16 a[86:87], v42 offset:22528
    v_exp_f32 v95, v95
    v_add_f32 v20, v20, v94
    v_add_f32 v20, v20, v95
    v_cvt_pk_bf16_f32 v91, v94, v95
    s_nop 0
    v_permlane32_swap_b32 v232, v234
    v_permlane32_swap_b32 v233, v235
    v_mfma_f32_32x32x16_bf16 a[176:191], a[92:95], v[80:83], a[176:191]
    ds_read_b128 a[88:91], v39 offset:49152
    v_fma_f32 v96, v96, s20, v22
    v_exp_f32 v96, v96
    v_fma_f32 v97, v97, s20, v22
    v_xor_b32 v26, 192, v19
    v_mul_f32 v240, v240, v25
    v_mfma_f32_32x32x16_bf16 v[112:127], a[64:67], a[16:19], v[112:127]
    ds_read_b64_tr_b16 a[92:93], v43 offset:20480
    ds_read_b64_tr_b16 a[94:95], v43 offset:22528
    ds_write_b128 v27, v[232:235]
    v_exp_f32 v97, v97
    v_fma_f32 v98, v98, s20, v22
    v_add_f32 v20, v20, v96
    v_mul_f32 v241, v241, v25
    v_mul_f32 v242, v242, v25
    v_mul_f32 v243, v243, v25
    v_mfma_f32_32x32x16_bf16 a[128:143], a[68:71], v[88:91], a[128:143]
    ds_read_b64_tr_b16 a[64:65], v40 offset:32768
    ds_read_b64_tr_b16 a[66:67], v40 offset:34816
    v_exp_f32 v98, v98
    v_fma_f32 v99, v99, s20, v22
    v_add_f32 v20, v20, v97
    v_cvt_pk_bf16_f32 v96, v96, v97
    v_mul_f32 v244, v244, v25
    v_mul_f32 v245, v245, v25
    v_mul_f32 v246, v246, v25
    v_mfma_f32_32x32x16_bf16 v[112:127], a[72:75], a[20:23], v[112:127]
    s_waitcnt lgkmcnt(5)
    ds_read_b64_tr_b16 a[68:69], v41 offset:32768
    ds_read_b64_tr_b16 a[70:71], v41 offset:34816
    v_exp_f32 v99, v99
    v_fma_f32 v100, v100, s20, v22
    v_add_f32 v20, v20, v98
    v_mul_f32 v247, v247, v25
    v_cvt_pk_bf16_f32 v240, v240, v241
    v_cvt_pk_bf16_f32 v241, v242, v243
    v_mfma_f32_32x32x16_bf16 a[144:159], a[76:79], v[88:91], a[144:159]
    ds_read_b64_tr_b16 a[72:73], v42 offset:32768
    ds_read_b64_tr_b16 a[74:75], v42 offset:34816
    v_exp_f32 v100, v100
    v_fma_f32 v101, v101, s20, v22
    v_add_f32 v20, v20, v99
    v_cvt_pk_bf16_f32 v97, v98, v99
    v_cvt_pk_bf16_f32 v242, v244, v245
    v_cvt_pk_bf16_f32 v243, v246, v247
    s_nop 0
    v_mfma_f32_32x32x16_bf16 v[112:127], a[80:83], a[24:27], v[112:127]
    ds_read_b64_tr_b16 a[76:77], v43 offset:32768
    ds_read_b64_tr_b16 a[78:79], v43 offset:34816
    v_exp_f32 v101, v101
    v_fma_f32 v102, v102, s20, v22
    v_add_f32 v20, v20, v100
    v_permlane32_swap_b32 v240, v242
    v_permlane32_swap_b32 v241, v243
    v_mfma_f32_32x32x16_bf16 a[160:175], a[84:87], v[88:91], a[160:175]
    ds_read_b64_tr_b16 a[80:81], v40 offset:36864
    ds_read_b64_tr_b16 a[82:83], v40 offset:38912
    ds_write_b128 v26, v[240:243]
    v_exp_f32 v102, v102
    v_fma_f32 v103, v103, s20, v22
    v_add_f32 v20, v20, v101
    v_cvt_pk_bf16_f32 v98, v100, v101
    v_exp_f32 v103, v103
    v_fma_f32 v104, v104, s20, v22
    v_add_f32 v20, v20, v102
    v_xor_b32 v27, 224, v19
    v_mul_f32 v248, v248, v25
    v_mul_f32 v249, v249, v25
    v_mfma_f32_32x32x16_bf16 v[112:127], a[88:91], a[28:31], v[112:127]
    s_waitcnt lgkmcnt(5)
    ds_read_b64_tr_b16 a[84:85], v41 offset:36864
    ds_read_b64_tr_b16 a[86:87], v41 offset:38912
    v_exp_f32 v104, v104
    v_fma_f32 v105, v105, s20, v22
    v_add_f32 v20, v20, v103
    v_cvt_pk_bf16_f32 v99, v102, v103
    v_mul_f32 v250, v250, v25
    v_mul_f32 v251, v251, v25
    v_mul_f32 v252, v252, v25
    v_mfma_f32_32x32x16_bf16 a[176:191], a[92:95], v[88:91], a[176:191]
    s_waitcnt vmcnt(6)
    ds_read_b64_tr_b16 a[88:89], v42 offset:36864
    v_exp_f32 v105, v105
    v_fma_f32 v106, v106, s20, v22
    v_add_f32 v20, v20, v104
    v_mul_f32 v253, v253, v25
    v_mul_f32 v254, v254, v25
    v_mul_f32 v255, v255, v25
    v_mfma_f32_32x32x16_bf16 a[128:143], a[64:67], v[96:99], a[128:143]
    s_barrier
    ds_read_b64_tr_b16 a[90:91], v42 offset:38912
    v_exp_f32 v106, v106
    v_fma_f32 v107, v107, s20, v22
    v_add_f32 v20, v20, v105
    v_cvt_pk_bf16_f32 v104, v104, v105
    v_cvt_pk_bf16_f32 v248, v248, v249
    v_cvt_pk_bf16_f32 v249, v250, v251
    v_cvt_pk_bf16_f32 v250, v252, v253
    v_mfma_f32_32x32x16_bf16 a[144:159], a[68:71], v[96:99], a[144:159]
    ds_read_b64_tr_b16 a[92:93], v43 offset:36864
    ds_read_b64_tr_b16 a[94:95], v43 offset:38912
    v_exp_f32 v107, v107
    v_fma_f32 v108, v108, s20, v22
    v_add_f32 v20, v20, v106
    v_exp_f32 v108, v108
    v_fma_f32 v109, v109, s20, v22
    v_add_f32 v20, v20, v107
    v_cvt_pk_bf16_f32 v105, v106, v107
    v_exp_f32 v109, v109
    v_fma_f32 v110, v110, s20, v22
    v_add_f32 v20, v20, v108
    v_exp_f32 v110, v110
    v_fma_f32 v111, v111, s20, v22
    v_add_f32 v20, v20, v109
    v_cvt_pk_bf16_f32 v106, v108, v109
    v_exp_f32 v111, v111
    v_add_f32 v20, v20, v110
    v_add_f32 v20, v20, v111
    v_cvt_pk_bf16_f32 v107, v110, v111
    v_cvt_pk_bf16_f32 v251, v254, v255
    s_nop 0
    v_permlane32_swap_b32 v248, v250
    v_mfma_f32_32x32x16_bf16 a[160:175], a[72:75], v[96:99], a[160:175]
    s_waitcnt lgkmcnt(3)
    ds_read_b64_tr_b16 a[64:65], v40 offset:49152
    ds_read_b64_tr_b16 a[66:67], v40 offset:51200
    v_fma_f32 v112, v112, s20, v22
    v_exp_f32 v112, v112
    v_fma_f32 v113, v113, s20, v22
    v_permlane32_swap_b32 v249, v251
    v_mfma_f32_32x32x16_bf16 a[176:191], a[76:79], v[96:99], a[176:191]
    ds_read_b64_tr_b16 a[68:69], v41 offset:49152
    ds_read_b64_tr_b16 a[70:71], v41 offset:51200
    ds_write_b128 v27, v[248:251]
    ds_read_b128 v[192:195], v0 offset:0
    ds_read_b128 v[196:199], v0 offset:1024
    v_exp_f32 v113, v113
    v_fma_f32 v114, v114, s20, v22
    v_add_f32 v20, v20, v112
    v_mfma_f32_32x32x16_bf16 a[128:143], a[80:83], v[104:107], a[128:143]
    ds_read_b64_tr_b16 a[72:73], v42 offset:49152
    ds_read_b64_tr_b16 a[74:75], v42 offset:51200
    ds_read_b128 v[200:203], v0 offset:2048
    ds_read_b128 v[204:207], v0 offset:3072
    v_exp_f32 v114, v114
    v_fma_f32 v115, v115, s20, v22
    v_add_f32 v20, v20, v113
    v_cvt_pk_bf16_f32 v112, v112, v113
    v_mfma_f32_32x32x16_bf16 a[144:159], a[84:87], v[104:107], a[144:159]
    s_waitcnt lgkmcnt(9)
    ds_read_b64_tr_b16 a[76:77], v43 offset:49152
    ds_read_b64_tr_b16 a[78:79], v43 offset:51200
    ds_read_b128 v[208:211], v0 offset:4096
    ds_read_b128 v[212:215], v0 offset:5120
    v_exp_f32 v115, v115
    v_fma_f32 v116, v116, s20, v22
    v_add_f32 v20, v20, v114
    v_exp_f32 v116, v116
    v_fma_f32 v117, v117, s20, v22
    v_add_f32 v20, v20, v115
    v_cvt_pk_bf16_f32 v113, v114, v115
    v_exp_f32 v117, v117
    v_fma_f32 v118, v118, s20, v22
    v_add_f32 v20, v20, v116
    v_exp_f32 v118, v118
    v_fma_f32 v119, v119, s20, v22
    v_add_f32 v20, v20, v117
    v_cvt_pk_bf16_f32 v114, v116, v117
    v_exp_f32 v119, v119
    v_fma_f32 v120, v120, s20, v22
    v_add_f32 v20, v20, v118
    v_mfma_f32_32x32x16_bf16 a[160:175], a[88:91], v[104:107], a[160:175]
    ds_read_b64_tr_b16 a[80:81], v40 offset:53248
    ds_read_b64_tr_b16 a[82:83], v40 offset:55296
    ds_read_b128 v[216:219], v0 offset:6144
    ds_read_b128 v[220:223], v0 offset:7168
    v_exp_f32 v120, v120
    v_fma_f32 v121, v121, s20, v22
    v_add_f32 v20, v20, v119
    v_cvt_pk_bf16_f32 v115, v118, v119
    v_mfma_f32_32x32x16_bf16 a[176:191], a[92:95], v[104:107], a[176:191]
    ds_read_b64_tr_b16 a[84:85], v41 offset:53248
    ds_read_b64_tr_b16 a[86:87], v41 offset:55296
    v_exp_f32 v121, v121
    v_fma_f32 v122, v122, s20, v22
    v_add_f32 v20, v20, v120
    v_mfma_f32_32x32x16_bf16 a[128:143], a[64:67], v[112:115], a[128:143]
    s_waitcnt lgkmcnt(6)
    ds_read_b64_tr_b16 a[88:89], v42 offset:53248
    ds_read_b64_tr_b16 a[90:91], v42 offset:55296
    v_exp_f32 v122, v122
    v_fma_f32 v123, v123, s20, v22
    v_add_f32 v20, v20, v121
    v_cvt_pk_bf16_f32 v120, v120, v121
    v_mfma_f32_32x32x16_bf16 a[144:159], a[68:71], v[112:115], a[144:159]
    ds_read_b64_tr_b16 a[92:93], v43 offset:53248
    ds_read_b64_tr_b16 a[94:95], v43 offset:55296
    v_exp_f32 v123, v123
    v_fma_f32 v124, v124, s20, v22
    v_add_f32 v20, v20, v122
    v_exp_f32 v124, v124
    v_fma_f32 v125, v125, s20, v22
    v_add_f32 v20, v20, v123
    v_cvt_pk_bf16_f32 v121, v122, v123
    v_exp_f32 v125, v125
    v_fma_f32 v126, v126, s20, v22
    v_add_f32 v20, v20, v124
    v_exp_f32 v126, v126
    v_fma_f32 v127, v127, s20, v22
    v_add_f32 v20, v20, v125
    v_cvt_pk_bf16_f32 v122, v124, v125
    v_exp_f32 v127, v127
    v_add_f32 v20, v20, v126
    v_add_f32 v20, v20, v127
    v_cvt_pk_bf16_f32 v123, v126, v127
    v_mfma_f32_32x32x16_bf16 a[160:175], a[72:75], v[112:115], a[160:175]
    v_mfma_f32_32x32x16_bf16 a[176:191], a[76:79], v[112:115], a[176:191]
    s_waitcnt lgkmcnt(2)
    v_mfma_f32_32x32x16_bf16 a[128:143], a[80:83], v[120:123], a[128:143]
    v_mfma_f32_32x32x16_bf16 a[144:159], a[84:87], v[120:123], a[144:159]
    v_mfma_f32_32x32x16_bf16 a[160:175], a[88:91], v[120:123], a[160:175]
    s_waitcnt lgkmcnt(0)
    buffer_store_dwordx4 v[192:195], v14, s[16:19], s28 offen offset:0 sc1
    v_mfma_f32_32x32x16_bf16 a[176:191], a[92:95], v[120:123], a[176:191]
    s_waitcnt lgkmcnt(0)
    buffer_store_dwordx4 v[196:199], v15, s[16:19], s28 offen offset:1024 sc1
    buffer_store_dwordx4 v[200:203], v16, s[16:19], s28 offen offset:2048 sc1
    buffer_store_dwordx4 v[204:207], v17, s[16:19], s28 offen offset:3072 sc1
    buffer_store_dwordx4 v[208:211], v14, s[16:19], s71 offen offset:0 sc1
    buffer_store_dwordx4 v[212:215], v15, s[16:19], s71 offen offset:1024 sc1
    buffer_store_dwordx4 v[216:219], v16, s[16:19], s71 offen offset:2048 sc1
    buffer_store_dwordx4 v[220:223], v17, s[16:19], s71 offen offset:3072 sc1
    s_nop 7
    s_nop 3
    v_mov_b32 v28, v20
    s_nop 1
    v_permlane32_swap_b32 v28, v20
    v_add_f32 v28, v28, v20
    v_mov_b32 v29, v22
    v_mbcnt_lo_u32_b32 v3, -1, 0
    v_mbcnt_hi_u32_b32 v3, -1, v3
    v_lshlrev_b32 v30, 3, v3
    s_lshl_b32 s34, s21, 9
    s_add_u32 s34, s34, 65536
    s_xor_b32 s35, s34, 512
    v_add_u32 v31, s35, v30
    v_add_u32 v30, s34, v30
    v_lshlrev_b32 v46, 4, v3
    s_lshl_b32 s34, s21, 13
    s_xor_b32 s35, s34, 8192
    v_add_u32 v47, s35, v46
    v_add_u32 v46, s34, v46
    ds_write_b64 v30, v[28:29]
    s_cmp_eq_u32 s31, 0
    s_cbranch_scc0 PAR1
    ds_write_b128 v46, a[160:163] offset:0
    ds_write_b128 v46, a[164:167] offset:1024
    ds_write_b128 v46, a[168:171] offset:2048
    ds_write_b128 v46, a[172:175] offset:3072
    ds_write_b128 v46, a[176:179] offset:4096
    ds_write_b128 v46, a[180:183] offset:5120
    ds_write_b128 v46, a[184:187] offset:6144
    ds_write_b128 v46, a[188:191] offset:7168
    v_accvgpr_read_b32 v96, a128
    v_accvgpr_read_b32 v97, a129
    v_accvgpr_read_b32 v98, a130
    v_accvgpr_read_b32 v99, a131
    v_accvgpr_read_b32 v100, a132
    v_accvgpr_read_b32 v101, a133
    v_accvgpr_read_b32 v102, a134
    v_accvgpr_read_b32 v103, a135
    v_accvgpr_read_b32 v104, a136
    v_accvgpr_read_b32 v105, a137
    v_accvgpr_read_b32 v106, a138
    v_accvgpr_read_b32 v107, a139
    v_accvgpr_read_b32 v108, a140
    v_accvgpr_read_b32 v109, a141
    v_accvgpr_read_b32 v110, a142
    v_accvgpr_read_b32 v111, a143
    v_accvgpr_read_b32 v112, a144
    v_accvgpr_read_b32 v113, a145
    v_accvgpr_read_b32 v114, a146
    v_accvgpr_read_b32 v115, a147
    v_accvgpr_read_b32 v116, a148
    v_accvgpr_read_b32 v117, a149
    v_accvgpr_read_b32 v118, a150
    v_accvgpr_read_b32 v119, a151
    v_accvgpr_read_b32 v120, a152
    v_accvgpr_read_b32 v121, a153
    v_accvgpr_read_b32 v122, a154
    v_accvgpr_read_b32 v123, a155
    v_accvgpr_read_b32 v124, a156
    v_accvgpr_read_b32 v125, a157
    v_accvgpr_read_b32 v126, a158
    v_accvgpr_read_b32 v127, a159
    s_branch PARJ
PAR1:
    ds_write_b128 v46, a[128:131] offset:0
    ds_write_b128 v46, a[132:135] offset:1024
    ds_write_b128 v46, a[136:139] offset:2048
    ds_write_b128 v46, a[140:143] offset:3072
    ds_write_b128 v46, a[144:147] offset:4096
    ds_write_b128 v46, a[148:151] offset:5120
    ds_write_b128 v46, a[152:155] offset:6144
    ds_write_b128 v46, a[156:159] offset:7168
    v_accvgpr_read_b32 v96, a160
    v_accvgpr_read_b32 v97, a161
    v_accvgpr_read_b32 v98, a162
    v_accvgpr_read_b32 v99, a163
    v_accvgpr_read_b32 v100, a164
    v_accvgpr_read_b32 v101, a165
    v_accvgpr_read_b32 v102, a166
    v_accvgpr_read_b32 v103, a167
    v_accvgpr_read_b32 v104, a168
    v_accvgpr_read_b32 v105, a169
    v_accvgpr_read_b32 v106, a170
    v_accvgpr_read_b32 v107, a171
    v_accvgpr_read_b32 v108, a172
    v_accvgpr_read_b32 v109, a173
    v_accvgpr_read_b32 v110, a174
    v_accvgpr_read_b32 v111, a175
    v_accvgpr_read_b32 v112, a176
    v_accvgpr_read_b32 v113, a177
    v_accvgpr_read_b32 v114, a178
    v_accvgpr_read_b32 v115, a179
    v_accvgpr_read_b32 v116, a180
    v_accvgpr_read_b32 v117, a181
    v_accvgpr_read_b32 v118, a182
    v_accvgpr_read_b32 v119, a183
    v_accvgpr_read_b32 v120, a184
    v_accvgpr_read_b32 v121, a185
    v_accvgpr_read_b32 v122, a186
    v_accvgpr_read_b32 v123, a187
    v_accvgpr_read_b32 v124, a188
    v_accvgpr_read_b32 v125, a189
    v_accvgpr_read_b32 v126, a190
    v_accvgpr_read_b32 v127, a191
PARJ:
    s_waitcnt lgkmcnt(0)
    s_barrier
    ds_read_b64 v[2:3], v31
    ds_read_b128 v[64:67], v47 offset:0
    ds_read_b128 v[68:71], v47 offset:1024
    ds_read_b128 v[72:75], v47 offset:2048
    ds_read_b128 v[76:79], v47 offset:3072
    ds_read_b128 v[80:83], v47 offset:4096
    ds_read_b128 v[84:87], v47 offset:5120
    ds_read_b128 v[88:91], v47 offset:6144
    ds_read_b128 v[92:95], v47 offset:7168
    s_waitcnt lgkmcnt(0)
    v_mov_b32 v9, 0x80000000
    v_cmp_nlt_f32_e64 s[48:49], v28, s30
    v_cmp_nlt_f32_e64 s[50:51], v2, s30
    v_min_f32 v4, v29, v3
    v_sub_f32 v5, v4, v29
    v_sub_f32 v6, v4, v3
    v_exp_f32 v5, v5
    v_exp_f32 v6, v6
    s_or_b64 s[48:49], s[48:49], s[50:51]
    v_mul_f32 v7, v28, v5
    v_fma_f32 v7, v2, v6, v7
    v_rcp_f32 v7, v7
    s_lshl_b32 s34, s31, 7
    v_add_u32 v8, s34, v1
    v_mul_f32 v5, v5, v7
    v_mul_f32 v6, v6, v7
    v_cndmask_b32_e64 v8, v8, v9, s[48:49]
    v_mul_f32 v96, v96, v5
    v_mul_f32 v97, v97, v5
    v_mul_f32 v98, v98, v5
    v_mul_f32 v99, v99, v5
    v_mul_f32 v100, v100, v5
    v_mul_f32 v101, v101, v5
    v_mul_f32 v102, v102, v5
    v_mul_f32 v103, v103, v5
    v_mul_f32 v104, v104, v5
    v_mul_f32 v105, v105, v5
    v_mul_f32 v106, v106, v5
    v_mul_f32 v107, v107, v5
    v_mul_f32 v108, v108, v5
    v_mul_f32 v109, v109, v5
    v_mul_f32 v110, v110, v5
    v_mul_f32 v111, v111, v5
    v_mul_f32 v112, v112, v5
    v_mul_f32 v113, v113, v5
    v_mul_f32 v114, v114, v5
    v_mul_f32 v115, v115, v5
    v_mul_f32 v116, v116, v5
    v_mul_f32 v117, v117, v5
    v_mul_f32 v118, v118, v5
    v_mul_f32 v119, v119, v5
    v_mul_f32 v120, v120, v5
    v_mul_f32 v121, v121, v5
    v_mul_f32 v122, v122, v5
    v_mul_f32 v123, v123, v5
    v_mul_f32 v124, v124, v5
    v_mul_f32 v125, v125, v5
    v_mul_f32 v126, v126, v5
    v_mul_f32 v127, v127, v5
    s_waitcnt lgkmcnt(0)
    v_fma_f32 v96, v64, v6, v96
    v_fma_f32 v97, v65, v6, v97
    v_fma_f32 v98, v66, v6, v98
    v_fma_f32 v99, v67, v6, v99
    v_fma_f32 v100, v68, v6, v100
    v_fma_f32 v101, v69, v6, v101
    v_fma_f32 v102, v70, v6, v102
    v_fma_f32 v103, v71, v6, v103
    v_fma_f32 v104, v72, v6, v104
    v_fma_f32 v105, v73, v6, v105
    v_fma_f32 v106, v74, v6, v106
    v_fma_f32 v107, v75, v6, v107
    v_fma_f32 v108, v76, v6, v108
    v_fma_f32 v109, v77, v6, v109
    v_fma_f32 v110, v78, v6, v110
    v_fma_f32 v111, v79, v6, v111
    v_fma_f32 v112, v80, v6, v112
    v_fma_f32 v113, v81, v6, v113
    v_fma_f32 v114, v82, v6, v114
    v_fma_f32 v115, v83, v6, v115
    v_fma_f32 v116, v84, v6, v116
    v_fma_f32 v117, v85, v6, v117
    v_fma_f32 v118, v86, v6, v118
    v_fma_f32 v119, v87, v6, v119
    v_fma_f32 v120, v88, v6, v120
    v_fma_f32 v121, v89, v6, v121
    v_fma_f32 v122, v90, v6, v122
    v_fma_f32 v123, v91, v6, v123
    v_fma_f32 v124, v92, v6, v124
    v_fma_f32 v125, v93, v6, v125
    v_fma_f32 v126, v94, v6, v126
    v_fma_f32 v127, v95, v6, v127
    v_cvt_pk_bf16_f32 v96, v96, v97
    v_cvt_pk_bf16_f32 v97, v98, v99
    v_cvt_pk_bf16_f32 v98, v100, v101
    v_cvt_pk_bf16_f32 v99, v102, v103
    s_nop 1
    v_permlane32_swap_b32 v96, v98
    v_permlane32_swap_b32 v97, v99
    buffer_store_dwordx4 v[96:99], v8, s[16:19], s29 offen offset:0 sc1
    v_cvt_pk_bf16_f32 v104, v104, v105
    v_cvt_pk_bf16_f32 v105, v106, v107
    v_cvt_pk_bf16_f32 v106, v108, v109
    v_cvt_pk_bf16_f32 v107, v110, v111
    s_nop 1
    v_permlane32_swap_b32 v104, v106
    v_permlane32_swap_b32 v105, v107
    buffer_store_dwordx4 v[104:107], v8, s[16:19], s29 offen offset:32 sc1
    v_cvt_pk_bf16_f32 v112, v112, v113
    v_cvt_pk_bf16_f32 v113, v114, v115
    v_cvt_pk_bf16_f32 v114, v116, v117
    v_cvt_pk_bf16_f32 v115, v118, v119
    s_nop 1
    v_permlane32_swap_b32 v112, v114
    v_permlane32_swap_b32 v113, v115
    buffer_store_dwordx4 v[112:115], v8, s[16:19], s29 offen offset:64 sc1
    v_cvt_pk_bf16_f32 v120, v120, v121
    v_cvt_pk_bf16_f32 v121, v122, v123
    v_cvt_pk_bf16_f32 v122, v124, v125
    v_cvt_pk_bf16_f32 v123, v126, v127
    s_nop 1
    v_permlane32_swap_b32 v120, v122
    v_permlane32_swap_b32 v121, v123
    buffer_store_dwordx4 v[120:123], v8, s[16:19], s29 offen offset:96 sc1
    s_cmp_eq_u32 s31, 0
    s_cbranch_scc1 KEEPM
    s_mov_b64 s[48:49], 0
KEEPM:
    s_or_b64 s[50:51], s[40:41], s[42:43]
    s_or_b64 s[50:51], s[50:51], s[44:45]
    s_or_b64 s[50:51], s[50:51], s[46:47]
    s_or_b64 s[50:51], s[50:51], s[48:49]
    s_cbranch_scc0 END
    s_waitcnt vmcnt(0)
    s_mov_b32 s56, 0
    v_mbcnt_lo_u32_b32 v3, -1, 0
    v_mbcnt_hi_u32_b32 v3, -1, v3
    v_and_b32 v4, 31, v3
    v_lshrrev_b32 v5, 5, v3
    v_lshlrev_b32 v4, 1, v4
    v_lshl_add_u32 v8, v5, 10, v4
SLOOP:
    s_cmp_eq_u64 s[40:41], 0
    s_cbranch_scc1 SNEXT
    buffer_load_dwordx4 v[128:131], v1, s[4:7], s25 offen offset:0
    buffer_load_dwordx4 v[132:135], v1, s[4:7], s25 offen offset:32
    buffer_load_dwordx4 v[136:139], v1, s[4:7], s25 offen offset:64
    buffer_load_dwordx4 v[140:143], v1, s[4:7], s25 offen offset:96
    buffer_load_dwordx4 v[144:147], v1, s[4:7], s25 offen offset:128
    buffer_load_dwordx4 v[148:151], v1, s[4:7], s25 offen offset:160
    buffer_load_dwordx4 v[152:155], v1, s[4:7], s25 offen offset:192
    buffer_load_dwordx4 v[156:159], v1, s[4:7], s25 offen offset:224
    v_mov_b32 v10, 0xff800000
    s_mov_b32 s57, 0
SMAX:
    buffer_load_dwordx4 v[160:163], v1, s[8:11], s57 offen offset:0
    buffer_load_dwordx4 v[164:167], v1, s[8:11], s57 offen offset:32
    buffer_load_dwordx4 v[168:171], v1, s[8:11], s57 offen offset:64
    buffer_load_dwordx4 v[172:175], v1, s[8:11], s57 offen offset:96
    buffer_load_dwordx4 v[176:179], v1, s[8:11], s57 offen offset:128
    buffer_load_dwordx4 v[180:183], v1, s[8:11], s57 offen offset:160
    buffer_load_dwordx4 v[184:187], v1, s[8:11], s57 offen offset:192
    buffer_load_dwordx4 v[188:191], v1, s[8:11], s57 offen offset:224
    s_waitcnt vmcnt(0)
    v_mfma_f32_32x32x16_bf16 v[64:79], v[160:163], v[128:131], 0
    v_mfma_f32_32x32x16_bf16 v[64:79], v[164:167], v[132:135], v[64:79]
    v_mfma_f32_32x32x16_bf16 v[64:79], v[168:171], v[136:139], v[64:79]
    v_mfma_f32_32x32x16_bf16 v[64:79], v[172:175], v[140:143], v[64:79]
    v_mfma_f32_32x32x16_bf16 v[64:79], v[176:179], v[144:147], v[64:79]
    v_mfma_f32_32x32x16_bf16 v[64:79], v[180:183], v[148:151], v[64:79]
    v_mfma_f32_32x32x16_bf16 v[64:79], v[184:187], v[152:155], v[64:79]
    v_mfma_f32_32x32x16_bf16 v[64:79], v[188:191], v[156:159], v[64:79]
    s_nop 7
    s_nop 7
    v_max_f32 v10, v10, v64
    v_max_f32 v10, v10, v65
    v_max_f32 v10, v10, v66
    v_max_f32 v10, v10, v67
    v_max_f32 v10, v10, v68
    v_max_f32 v10, v10, v69
    v_max_f32 v10, v10, v70
    v_max_f32 v10, v10, v71
    v_max_f32 v10, v10, v72
    v_max_f32 v10, v10, v73
    v_max_f32 v10, v10, v74
    v_max_f32 v10, v10, v75
    v_max_f32 v10, v10, v76
    v_max_f32 v10, v10, v77
    v_max_f32 v10, v10, v78
    v_max_f32 v10, v10, v79
    s_add_u32 s57, s57, 8192
    s_cmp_lt_u32 s57, 131072
    s_cbranch_scc1 SMAX
    v_mov_b32 v11, v10
    s_nop 1
    v_permlane32_swap_b32 v10, v11
    v_max_f32 v10, v10, v11
    v_mul_f32 v10, s32, v10
    v_mov_b32 v12, 0
    v_mov_b32 v192, 0
    v_mov_b32 v193, 0
    v_mov_b32 v194, 0
    v_mov_b32 v195, 0
    v_mov_b32 v196, 0
    v_mov_b32 v197, 0
    v_mov_b32 v198, 0
    v_mov_b32 v199, 0
    v_mov_b32 v200, 0
    v_mov_b32 v201, 0
    v_mov_b32 v202, 0
    v_mov_b32 v203, 0
    v_mov_b32 v204, 0
    v_mov_b32 v205, 0
    v_mov_b32 v206, 0
    v_mov_b32 v207, 0
    v_mov_b32 v208, 0
    v_mov_b32 v209, 0
    v_mov_b32 v210, 0
    v_mov_b32 v211, 0
    v_mov_b32 v212, 0
    v_mov_b32 v213, 0
    v_mov_b32 v214, 0
    v_mov_b32 v215, 0
    v_mov_b32 v216, 0
    v_mov_b32 v217, 0
    v_mov_b32 v218, 0
    v_mov_b32 v219, 0
    v_mov_b32 v220, 0
    v_mov_b32 v221, 0
    v_mov_b32 v222, 0
    v_mov_b32 v223, 0
    v_mov_b32 v224, 0
    v_mov_b32 v225, 0
    v_mov_b32 v226, 0
    v_mov_b32 v227, 0
    v_mov_b32 v228, 0
    v_mov_b32 v229, 0
    v_mov_b32 v230, 0
    v_mov_b32 v231, 0
    v_mov_b32 v232, 0
    v_mov_b32 v233, 0
    v_mov_b32 v234, 0
    v_mov_b32 v235, 0
    v_mov_b32 v236, 0
    v_mov_b32 v237, 0
    v_mov_b32 v238, 0
    v_mov_b32 v239, 0
    v_mov_b32 v240, 0
    v_mov_b32 v241, 0
    v_mov_b32 v242, 0
    v_mov_b32 v243, 0
    v_mov_b32 v244, 0
    v_mov_b32 v245, 0
    v_mov_b32 v246, 0
    v_mov_b32 v247, 0
    v_mov_b32 v248, 0
    v_mov_b32 v249, 0
    v_mov_b32 v250, 0
    v_mov_b32 v251, 0
    v_mov_b32 v252, 0
    v_mov_b32 v253, 0
    v_mov_b32 v254, 0
    v_mov_b32 v255, 0
    s_mov_b32 s57, 0
SPV:
    buffer_load_dwordx4 v[160:163], v1, s[8:11], s57 offen offset:0
    buffer_load_dwordx4 v[164:167], v1, s[8:11], s57 offen offset:32
    buffer_load_dwordx4 v[168:171], v1, s[8:11], s57 offen offset:64
    buffer_load_dwordx4 v[172:175], v1, s[8:11], s57 offen offset:96
    buffer_load_dwordx4 v[176:179], v1, s[8:11], s57 offen offset:128
    buffer_load_dwordx4 v[180:183], v1, s[8:11], s57 offen offset:160
    buffer_load_dwordx4 v[184:187], v1, s[8:11], s57 offen offset:192
    buffer_load_dwordx4 v[188:191], v1, s[8:11], s57 offen offset:224
    s_waitcnt vmcnt(0)
    v_mfma_f32_32x32x16_bf16 v[64:79], v[160:163], v[128:131], 0
    v_mfma_f32_32x32x16_bf16 v[64:79], v[164:167], v[132:135], v[64:79]
    v_mfma_f32_32x32x16_bf16 v[64:79], v[168:171], v[136:139], v[64:79]
    v_mfma_f32_32x32x16_bf16 v[64:79], v[172:175], v[140:143], v[64:79]
    v_mfma_f32_32x32x16_bf16 v[64:79], v[176:179], v[144:147], v[64:79]
    v_mfma_f32_32x32x16_bf16 v[64:79], v[180:183], v[148:151], v[64:79]
    v_mfma_f32_32x32x16_bf16 v[64:79], v[184:187], v[152:155], v[64:79]
    v_mfma_f32_32x32x16_bf16 v[64:79], v[188:191], v[156:159], v[64:79]
    s_nop 7
    s_nop 7
    v_fma_f32 v64, v64, s20, v10
    v_exp_f32 v64, v64
    s_nop 0
    v_add_f32 v12, v12, v64
    v_fma_f32 v65, v65, s20, v10
    v_exp_f32 v65, v65
    s_nop 0
    v_add_f32 v12, v12, v65
    v_fma_f32 v66, v66, s20, v10
    v_exp_f32 v66, v66
    s_nop 0
    v_add_f32 v12, v12, v66
    v_fma_f32 v67, v67, s20, v10
    v_exp_f32 v67, v67
    s_nop 0
    v_add_f32 v12, v12, v67
    v_fma_f32 v68, v68, s20, v10
    v_exp_f32 v68, v68
    s_nop 0
    v_add_f32 v12, v12, v68
    v_fma_f32 v69, v69, s20, v10
    v_exp_f32 v69, v69
    s_nop 0
    v_add_f32 v12, v12, v69
    v_fma_f32 v70, v70, s20, v10
    v_exp_f32 v70, v70
    s_nop 0
    v_add_f32 v12, v12, v70
    v_fma_f32 v71, v71, s20, v10
    v_exp_f32 v71, v71
    s_nop 0
    v_add_f32 v12, v12, v71
    v_fma_f32 v72, v72, s20, v10
    v_exp_f32 v72, v72
    s_nop 0
    v_add_f32 v12, v12, v72
    v_fma_f32 v73, v73, s20, v10
    v_exp_f32 v73, v73
    s_nop 0
    v_add_f32 v12, v12, v73
    v_fma_f32 v74, v74, s20, v10
    v_exp_f32 v74, v74
    s_nop 0
    v_add_f32 v12, v12, v74
    v_fma_f32 v75, v75, s20, v10
    v_exp_f32 v75, v75
    s_nop 0
    v_add_f32 v12, v12, v75
    v_fma_f32 v76, v76, s20, v10
    v_exp_f32 v76, v76
    s_nop 0
    v_add_f32 v12, v12, v76
    v_fma_f32 v77, v77, s20, v10
    v_exp_f32 v77, v77
    s_nop 0
    v_add_f32 v12, v12, v77
    v_fma_f32 v78, v78, s20, v10
    v_exp_f32 v78, v78
    s_nop 0
    v_add_f32 v12, v12, v78
    v_fma_f32 v79, v79, s20, v10
    v_exp_f32 v79, v79
    s_nop 0
    v_add_f32 v12, v12, v79
    v_cvt_pk_bf16_f32 v80, v64, v65
    v_cvt_pk_bf16_f32 v81, v66, v67
    v_cvt_pk_bf16_f32 v82, v68, v69
    v_cvt_pk_bf16_f32 v83, v70, v71
    v_cvt_pk_bf16_f32 v84, v72, v73
    v_cvt_pk_bf16_f32 v85, v74, v75
    v_cvt_pk_bf16_f32 v86, v76, v77
    v_cvt_pk_bf16_f32 v87, v78, v79
    s_add_u32 s58, s57, 0
    buffer_load_ushort v96, v8, s[12:15], s58 offen offset:0
    buffer_load_ushort v97, v8, s[12:15], s58 offen offset:256
    buffer_load_ushort v98, v8, s[12:15], s58 offen offset:512
    buffer_load_ushort v99, v8, s[12:15], s58 offen offset:768
    buffer_load_ushort v100, v8, s[12:15], s58 offen offset:2048
    buffer_load_ushort v101, v8, s[12:15], s58 offen offset:2304
    buffer_load_ushort v102, v8, s[12:15], s58 offen offset:2560
    buffer_load_ushort v103, v8, s[12:15], s58 offen offset:2816
    buffer_load_ushort v104, v8, s[12:15], s58 offen offset:64
    buffer_load_ushort v105, v8, s[12:15], s58 offen offset:320
    buffer_load_ushort v106, v8, s[12:15], s58 offen offset:576
    buffer_load_ushort v107, v8, s[12:15], s58 offen offset:832
    buffer_load_ushort v108, v8, s[12:15], s58 offen offset:2112
    buffer_load_ushort v109, v8, s[12:15], s58 offen offset:2368
    buffer_load_ushort v110, v8, s[12:15], s58 offen offset:2624
    buffer_load_ushort v111, v8, s[12:15], s58 offen offset:2880
    buffer_load_ushort v112, v8, s[12:15], s58 offen offset:128
    buffer_load_ushort v113, v8, s[12:15], s58 offen offset:384
    buffer_load_ushort v114, v8, s[12:15], s58 offen offset:640
    buffer_load_ushort v115, v8, s[12:15], s58 offen offset:896
    buffer_load_ushort v116, v8, s[12:15], s58 offen offset:2176
    buffer_load_ushort v117, v8, s[12:15], s58 offen offset:2432
    buffer_load_ushort v118, v8, s[12:15], s58 offen offset:2688
    buffer_load_ushort v119, v8, s[12:15], s58 offen offset:2944
    buffer_load_ushort v120, v8, s[12:15], s58 offen offset:192
    buffer_load_ushort v121, v8, s[12:15], s58 offen offset:448
    buffer_load_ushort v122, v8, s[12:15], s58 offen offset:704
    buffer_load_ushort v123, v8, s[12:15], s58 offen offset:960
    buffer_load_ushort v124, v8, s[12:15], s58 offen offset:2240
    buffer_load_ushort v125, v8, s[12:15], s58 offen offset:2496
    buffer_load_ushort v126, v8, s[12:15], s58 offen offset:2752
    buffer_load_ushort v127, v8, s[12:15], s58 offen offset:3008
    s_waitcnt vmcnt(0)
    v_lshl_or_b32 v160, v97, 16, v96
    v_lshl_or_b32 v161, v99, 16, v98
    v_lshl_or_b32 v162, v101, 16, v100
    v_lshl_or_b32 v163, v103, 16, v102
    v_lshl_or_b32 v164, v105, 16, v104
    v_lshl_or_b32 v165, v107, 16, v106
    v_lshl_or_b32 v166, v109, 16, v108
    v_lshl_or_b32 v167, v111, 16, v110
    v_lshl_or_b32 v168, v113, 16, v112
    v_lshl_or_b32 v169, v115, 16, v114
    v_lshl_or_b32 v170, v117, 16, v116
    v_lshl_or_b32 v171, v119, 16, v118
    v_lshl_or_b32 v172, v121, 16, v120
    v_lshl_or_b32 v173, v123, 16, v122
    v_lshl_or_b32 v174, v125, 16, v124
    v_lshl_or_b32 v175, v127, 16, v126
    s_nop 1
    v_mfma_f32_32x32x16_bf16 v[192:207], v[160:163], v[80:83], v[192:207]
    v_mfma_f32_32x32x16_bf16 v[208:223], v[164:167], v[80:83], v[208:223]
    v_mfma_f32_32x32x16_bf16 v[224:239], v[168:171], v[80:83], v[224:239]
    v_mfma_f32_32x32x16_bf16 v[240:255], v[172:175], v[80:83], v[240:255]
    s_nop 7
    s_nop 7
    s_add_u32 s58, s57, 4096
    buffer_load_ushort v96, v8, s[12:15], s58 offen offset:0
    buffer_load_ushort v97, v8, s[12:15], s58 offen offset:256
    buffer_load_ushort v98, v8, s[12:15], s58 offen offset:512
    buffer_load_ushort v99, v8, s[12:15], s58 offen offset:768
    buffer_load_ushort v100, v8, s[12:15], s58 offen offset:2048
    buffer_load_ushort v101, v8, s[12:15], s58 offen offset:2304
    buffer_load_ushort v102, v8, s[12:15], s58 offen offset:2560
    buffer_load_ushort v103, v8, s[12:15], s58 offen offset:2816
    buffer_load_ushort v104, v8, s[12:15], s58 offen offset:64
    buffer_load_ushort v105, v8, s[12:15], s58 offen offset:320
    buffer_load_ushort v106, v8, s[12:15], s58 offen offset:576
    buffer_load_ushort v107, v8, s[12:15], s58 offen offset:832
    buffer_load_ushort v108, v8, s[12:15], s58 offen offset:2112
    buffer_load_ushort v109, v8, s[12:15], s58 offen offset:2368
    buffer_load_ushort v110, v8, s[12:15], s58 offen offset:2624
    buffer_load_ushort v111, v8, s[12:15], s58 offen offset:2880
    buffer_load_ushort v112, v8, s[12:15], s58 offen offset:128
    buffer_load_ushort v113, v8, s[12:15], s58 offen offset:384
    buffer_load_ushort v114, v8, s[12:15], s58 offen offset:640
    buffer_load_ushort v115, v8, s[12:15], s58 offen offset:896
    buffer_load_ushort v116, v8, s[12:15], s58 offen offset:2176
    buffer_load_ushort v117, v8, s[12:15], s58 offen offset:2432
    buffer_load_ushort v118, v8, s[12:15], s58 offen offset:2688
    buffer_load_ushort v119, v8, s[12:15], s58 offen offset:2944
    buffer_load_ushort v120, v8, s[12:15], s58 offen offset:192
    buffer_load_ushort v121, v8, s[12:15], s58 offen offset:448
    buffer_load_ushort v122, v8, s[12:15], s58 offen offset:704
    buffer_load_ushort v123, v8, s[12:15], s58 offen offset:960
    buffer_load_ushort v124, v8, s[12:15], s58 offen offset:2240
    buffer_load_ushort v125, v8, s[12:15], s58 offen offset:2496
    buffer_load_ushort v126, v8, s[12:15], s58 offen offset:2752
    buffer_load_ushort v127, v8, s[12:15], s58 offen offset:3008
    s_waitcnt vmcnt(0)
    v_lshl_or_b32 v160, v97, 16, v96
    v_lshl_or_b32 v161, v99, 16, v98
    v_lshl_or_b32 v162, v101, 16, v100
    v_lshl_or_b32 v163, v103, 16, v102
    v_lshl_or_b32 v164, v105, 16, v104
    v_lshl_or_b32 v165, v107, 16, v106
    v_lshl_or_b32 v166, v109, 16, v108
    v_lshl_or_b32 v167, v111, 16, v110
    v_lshl_or_b32 v168, v113, 16, v112
    v_lshl_or_b32 v169, v115, 16, v114
    v_lshl_or_b32 v170, v117, 16, v116
    v_lshl_or_b32 v171, v119, 16, v118
    v_lshl_or_b32 v172, v121, 16, v120
    v_lshl_or_b32 v173, v123, 16, v122
    v_lshl_or_b32 v174, v125, 16, v124
    v_lshl_or_b32 v175, v127, 16, v126
    s_nop 1
    v_mfma_f32_32x32x16_bf16 v[192:207], v[160:163], v[84:87], v[192:207]
    v_mfma_f32_32x32x16_bf16 v[208:223], v[164:167], v[84:87], v[208:223]
    v_mfma_f32_32x32x16_bf16 v[224:239], v[168:171], v[84:87], v[224:239]
    v_mfma_f32_32x32x16_bf16 v[240:255], v[172:175], v[84:87], v[240:255]
    s_nop 7
    s_nop 7
    s_add_u32 s57, s57, 8192
    s_cmp_lt_u32 s57, 131072
    s_cbranch_scc1 SPV
    v_mov_b32 v11, v12
    s_nop 1
    v_permlane32_swap_b32 v11, v12
    v_add_f32 v11, v11, v12
    v_rcp_f32 v11, v11
    v_cndmask_b32_e64 v13, v9, v1, s[40:41]
    v_mul_f32 v192, v192, v11
    v_mul_f32 v193, v193, v11
    v_mul_f32 v194, v194, v11
    v_mul_f32 v195, v195, v11
    v_mul_f32 v196, v196, v11
    v_mul_f32 v197, v197, v11
    v_mul_f32 v198, v198, v11
    v_mul_f32 v199, v199, v11
    v_cvt_pk_bf16_f32 v192, v192, v193
    v_cvt_pk_bf16_f32 v193, v194, v195
    v_cvt_pk_bf16_f32 v194, v196, v197
    v_cvt_pk_bf16_f32 v195, v198, v199
    s_nop 1
    v_permlane32_swap_b32 v192, v194
    v_permlane32_swap_b32 v193, v195
    buffer_store_dwordx4 v[192:195], v13, s[16:19], s25 offen offset:0
    v_mul_f32 v200, v200, v11
    v_mul_f32 v201, v201, v11
    v_mul_f32 v202, v202, v11
    v_mul_f32 v203, v203, v11
    v_mul_f32 v204, v204, v11
    v_mul_f32 v205, v205, v11
    v_mul_f32 v206, v206, v11
    v_mul_f32 v207, v207, v11
    v_cvt_pk_bf16_f32 v200, v200, v201
    v_cvt_pk_bf16_f32 v201, v202, v203
    v_cvt_pk_bf16_f32 v202, v204, v205
    v_cvt_pk_bf16_f32 v203, v206, v207
    s_nop 1
    v_permlane32_swap_b32 v200, v202
    v_permlane32_swap_b32 v201, v203
    buffer_store_dwordx4 v[200:203], v13, s[16:19], s25 offen offset:32
    v_mul_f32 v208, v208, v11
    v_mul_f32 v209, v209, v11
    v_mul_f32 v210, v210, v11
    v_mul_f32 v211, v211, v11
    v_mul_f32 v212, v212, v11
    v_mul_f32 v213, v213, v11
    v_mul_f32 v214, v214, v11
    v_mul_f32 v215, v215, v11
    v_cvt_pk_bf16_f32 v208, v208, v209
    v_cvt_pk_bf16_f32 v209, v210, v211
    v_cvt_pk_bf16_f32 v210, v212, v213
    v_cvt_pk_bf16_f32 v211, v214, v215
    s_nop 1
    v_permlane32_swap_b32 v208, v210
    v_permlane32_swap_b32 v209, v211
    buffer_store_dwordx4 v[208:211], v13, s[16:19], s25 offen offset:64
    v_mul_f32 v216, v216, v11
    v_mul_f32 v217, v217, v11
    v_mul_f32 v218, v218, v11
    v_mul_f32 v219, v219, v11
    v_mul_f32 v220, v220, v11
    v_mul_f32 v221, v221, v11
    v_mul_f32 v222, v222, v11
    v_mul_f32 v223, v223, v11
    v_cvt_pk_bf16_f32 v216, v216, v217
    v_cvt_pk_bf16_f32 v217, v218, v219
    v_cvt_pk_bf16_f32 v218, v220, v221
    v_cvt_pk_bf16_f32 v219, v222, v223
    s_nop 1
    v_permlane32_swap_b32 v216, v218
    v_permlane32_swap_b32 v217, v219
    buffer_store_dwordx4 v[216:219], v13, s[16:19], s25 offen offset:96
    v_mul_f32 v224, v224, v11
    v_mul_f32 v225, v225, v11
    v_mul_f32 v226, v226, v11
    v_mul_f32 v227, v227, v11
    v_mul_f32 v228, v228, v11
    v_mul_f32 v229, v229, v11
    v_mul_f32 v230, v230, v11
    v_mul_f32 v231, v231, v11
    v_cvt_pk_bf16_f32 v224, v224, v225
    v_cvt_pk_bf16_f32 v225, v226, v227
    v_cvt_pk_bf16_f32 v226, v228, v229
    v_cvt_pk_bf16_f32 v227, v230, v231
    s_nop 1
    v_permlane32_swap_b32 v224, v226
    v_permlane32_swap_b32 v225, v227
    buffer_store_dwordx4 v[224:227], v13, s[16:19], s25 offen offset:128
    v_mul_f32 v232, v232, v11
    v_mul_f32 v233, v233, v11
    v_mul_f32 v234, v234, v11
    v_mul_f32 v235, v235, v11
    v_mul_f32 v236, v236, v11
    v_mul_f32 v237, v237, v11
    v_mul_f32 v238, v238, v11
    v_mul_f32 v239, v239, v11
    v_cvt_pk_bf16_f32 v232, v232, v233
    v_cvt_pk_bf16_f32 v233, v234, v235
    v_cvt_pk_bf16_f32 v234, v236, v237
    v_cvt_pk_bf16_f32 v235, v238, v239
    s_nop 1
    v_permlane32_swap_b32 v232, v234
    v_permlane32_swap_b32 v233, v235
    buffer_store_dwordx4 v[232:235], v13, s[16:19], s25 offen offset:160
    v_mul_f32 v240, v240, v11
    v_mul_f32 v241, v241, v11
    v_mul_f32 v242, v242, v11
    v_mul_f32 v243, v243, v11
    v_mul_f32 v244, v244, v11
    v_mul_f32 v245, v245, v11
    v_mul_f32 v246, v246, v11
    v_mul_f32 v247, v247, v11
    v_cvt_pk_bf16_f32 v240, v240, v241
    v_cvt_pk_bf16_f32 v241, v242, v243
    v_cvt_pk_bf16_f32 v242, v244, v245
    v_cvt_pk_bf16_f32 v243, v246, v247
    s_nop 1
    v_permlane32_swap_b32 v240, v242
    v_permlane32_swap_b32 v241, v243
    buffer_store_dwordx4 v[240:243], v13, s[16:19], s25 offen offset:192
    v_mul_f32 v248, v248, v11
    v_mul_f32 v249, v249, v11
    v_mul_f32 v250, v250, v11
    v_mul_f32 v251, v251, v11
    v_mul_f32 v252, v252, v11
    v_mul_f32 v253, v253, v11
    v_mul_f32 v254, v254, v11
    v_mul_f32 v255, v255, v11
    v_cvt_pk_bf16_f32 v248, v248, v249
    v_cvt_pk_bf16_f32 v249, v250, v251
    v_cvt_pk_bf16_f32 v250, v252, v253
    v_cvt_pk_bf16_f32 v251, v254, v255
    s_nop 1
    v_permlane32_swap_b32 v248, v250
    v_permlane32_swap_b32 v249, v251
    buffer_store_dwordx4 v[248:251], v13, s[16:19], s25 offen offset:224
    s_waitcnt vmcnt(0)
SNEXT:
    s_mov_b64 s[40:41], s[42:43]
    s_mov_b32 s25, s26
    s_mov_b64 s[42:43], s[44:45]
    s_mov_b32 s26, s27
    s_mov_b64 s[44:45], s[46:47]
    s_mov_b32 s27, s28
    s_mov_b64 s[46:47], s[48:49]
    s_mov_b32 s28, s29
    s_add_u32 s56, s56, 1
    s_cmp_lt_u32 s56, 5
    s_cbranch_scc1 SLOOP
END:
s_endpgm
.section .rodata,"a"
.p2align 6
.amdhsa_kernel standalone__gqa_softmax__near_ridge_kernel
  .amdhsa_next_free_vgpr 512
  .amdhsa_next_free_sgpr 102
  .amdhsa_accum_offset 256
  .amdhsa_group_segment_fixed_size 0
  .amdhsa_kernarg_size 48
  .amdhsa_user_sgpr_count 2
  .amdhsa_user_sgpr_kernarg_segment_ptr 1
  .amdhsa_system_sgpr_workgroup_id_x 1
.end_amdhsa_kernel
```
